```python
import torch

def _softmax(x, axis=-1):
    return torch.softmax(x, dim=axis)
def _gelu(x):
    return torch.nn.functional.gelu(x, approximate="tanh")
def _silu(x):
    return torch.nn.functional.silu(x)
def _sigmoid(x):
    return torch.sigmoid(x)
def _layernorm(x, axis=-1, eps=1e-5):
    m = x.mean(dim=axis, keepdim=True)
    v = x.var(dim=axis, keepdim=True, unbiased=False)
    return (x - m) / torch.sqrt(v + eps)
def _scatter_add(tgt, idx, src, axis=0):
    return tgt.clone().index_add_(axis, idx, src)
def _segment_sum(src, seg, n):
    out = torch.zeros((n,) + src.shape[1:], dtype=src.dtype)
    return out.index_add_(0, seg, src)
def _pad(x, pw):
    flat = tuple(v for pair in reversed(pw) for v in pair)
    return torch.nn.functional.pad(x, flat)

kernel_name = 'interleave_layers__linear_kernel_hedgehog__dense_activation_squared_relu__prompt'

def setup_inputs():

    _w = (lambda a: (lambda t: t.to(torch.bfloat16) if t.is_floating_point() else t)(torch.as_tensor(a)))
    def _A_setup():
        B, S, D, H = 1, 2048, 448, 16
        Dh = D // H
        return {
            "x": _w((lambda *s: torch.randn(*s, dtype=torch.bfloat16) * 0.05)(B, S, D)),
            "wqkv": _w((lambda *s: torch.randn(*s, dtype=torch.bfloat16) * 0.2)(D, 3 * D)),
            "w_phi": _w((lambda *s: torch.randn(*s, dtype=torch.bfloat16) * 0.2)(H, Dh, Dh) * (Dh ** -0.5)),
            "wo": _w((lambda *s: torch.randn(*s, dtype=torch.bfloat16) * 0.05)(D, D)),
        }
    _A_in = _A_setup()

    def _B_setup():
        B, S, D, F = 1, 2048, 448, 1792
        return {
            "x": _w((lambda *s: torch.randn(*s, dtype=torch.bfloat16) * 0.05)(B, S, D)),
            "w1": _w((lambda *s: torch.randn(*s, dtype=torch.bfloat16) * 0.05)(D, F)),
            "b1": _w((lambda *s: torch.randn(*s, dtype=torch.bfloat16) * 0.2)(F)),
            "w2": _w((lambda *s: torch.randn(*s, dtype=torch.bfloat16) * 0.05)(F, D)),
            "b2": _w((lambda *s: torch.randn(*s, dtype=torch.bfloat16) * 0.4)(D)),
        }
    _B_in = _B_setup()

    return {
        "A_x": _A_in["x"],
        "A_wqkv": _A_in["wqkv"],
        "A_w_phi": _A_in["w_phi"],
        "A_wo": _A_in["wo"],
        "B_x": _B_in["x"],
        "B_w1": _B_in["w1"],
        "B_b1": _B_in["b1"],
        "B_w2": _B_in["w2"],
        "B_b2": _B_in["b2"],
    }

def reference(A_x, A_wqkv, A_w_phi, A_wo, B_x, B_w1, B_b1, B_w2, B_b2):
    def _A_ref(x, wqkv, w_phi, wo):
        B, S, D = x.shape
        H = 16; Dh = D // H
        qkv = (lambda x, *d: x.permute(*d))((x @ wqkv).reshape(B, S, 3, H, Dh), 2, 0, 3, 1, 4)
        q, k, v = qkv[0], qkv[1], qkv[2]
        pq = torch.einsum("bhsd,hdf->bhsf", q, w_phi)
        pk = torch.einsum("bhsd,hdf->bhsf", k, w_phi)
        phi_q = torch.concatenate([_softmax(pq, axis=-1), _softmax(-pq, axis=-1)], axis=-1)
        phi_k = torch.concatenate([_softmax(pk, axis=-1), _softmax(-pk, axis=-1)], axis=-1)
        kv = torch.einsum("bhsf,bhsd->bhfd", phi_k, v)
        z  = torch.einsum("bhsf->bhf", phi_k)
        num = torch.einsum("bhqf,bhfd->bhqd", phi_q, kv)
        den = torch.einsum("bhqf,bhf->bhq", phi_q, z)[..., None] + 1e-6
        o = num / den
        return (lambda x, *d: x.permute(*d))(o, 0, 2, 1, 3).reshape(B, S, D) @ wo

    def _B_ref(x, w1, b1, w2, b2):
        h = torch.einsum("bsd,df->bsf", x, w1) + b1
        zero = torch.zeros_like(h)
        r = torch.where(h > zero, h, zero)
        h = r * r
        out = torch.einsum("bsf,fd->bsd", h, w2) + b2
        return out

    x = A_x
    x = x + _A_ref(_layernorm(x, axis=-1), A_wqkv, A_w_phi, A_wo)
    x = x + _B_ref(_layernorm(x, axis=-1), B_w1, B_b1, B_w2, B_b2)
    x = x + _A_ref(_layernorm(x, axis=-1), A_wqkv, A_w_phi, A_wo)
    x = x + _B_ref(_layernorm(x, axis=-1), B_w1, B_b1, B_w2, B_b2)
    return x
```

```asm
; @launch kernel=prep_kernel grid=(1256,1,1) block=(256,1,1) lds=0
; @launch kernel=k1l1_kernel grid=(256,1,1) block=(256,1,1) lds=32768
; @launch kernel=krl1_kernel grid=(128,1,1) block=(256,1,1) lds=0
; @launch kernel=k2l1_kernel grid=(256,1,1) block=(256,1,1) lds=16384
; @launch kernel=k3l1_kernel grid=(256,1,1) block=(256,1,1) lds=32768
; @launch kernel=k4l1_kernel grid=(224,1,1) block=(256,1,1) lds=131072
; @launch kernel=k1l2_kernel grid=(256,1,1) block=(256,1,1) lds=32768
; @launch kernel=krl2_kernel grid=(128,1,1) block=(256,1,1) lds=0
; @launch kernel=k2l2_kernel grid=(256,1,1) block=(256,1,1) lds=16384
; @launch kernel=k3l2_kernel grid=(256,1,1) block=(256,1,1) lds=32768
; @launch kernel=k4l2_kernel grid=(224,1,1) block=(256,1,1) lds=131072
.amdgcn_target "amdgcn-amd-amdhsa--gfx950"
.text
.globl prep_kernel
.p2align 8
.type prep_kernel,@function
prep_kernel:
    s_cmp_ge_u32 s2, 1256
    s_cbranch_scc1 prep_done
    s_load_dwordx2 s[4:5], s[0:1], 8
    s_load_dwordx2 s[6:7], s[0:1], 16
    s_load_dwordx2 s[8:9], s[0:1], 24
    s_load_dwordx2 s[10:11], s[0:1], 40
    s_load_dwordx2 s[12:13], s[0:1], 56
    s_load_dwordx2 s[14:15], s[0:1], 88
    v_lshrrev_b32 v1, 6, v0
    v_and_b32 v2, 63, v0
    v_readfirstlane_b32 s3, v1
    v_lshrrev_b32 v3, 4, v2
    v_and_b32 v4, 15, v2
    v_lshlrev_b32 v5, 4, v2
    v_mov_b32 v7, 0x80000000
    s_lshl_b32 s16, s2, 2
    s_add_u32 s16, s16, s3
    s_waitcnt lgkmcnt(0)
    s_cmp_ge_u32 s16, 1344
    s_cbranch_scc1 prep_wo
    s_mov_b32 s20, s4
    s_mov_b32 s21, s5
    s_mov_b32 s22, 0x126000
    s_mov_b32 s23, 0x00020000
    s_mov_b32 s24, s14
    s_mov_b32 s25, s15
    s_mov_b32 s26, 0x150000
    s_mov_b32 s27, 0x00020000
    s_mul_hi_u32 s28, s16, 0x30c30c4
    s_mul_i32 s29, s28, 84
    s_sub_u32 s29, s16, s29
    s_mul_hi_u32 s30, s29, 0x2aaaaaab
    s_mul_i32 s31, s30, 6
    s_sub_u32 s31, s29, s31
    s_lshr_b32 s32, s31, 1
    s_and_b32 s33, s31, 1
    s_mul_i32 s34, s32, 448
    s_mul_i32 s35, s28, 28
    s_add_u32 s34, s34, s35
    s_lshl_b32 s35, s33, 4
    s_add_u32 s34, s34, s35
    s_lshl_b32 s36, s30, 5
    v_lshlrev_b32 v6, 3, v3
    v_add_u32 v6, s36, v6
    v_mul_u32_u24 v6, 1344, v6
    v_add_u32 v6, s34, v6
    v_add_u32 v6, v6, v4
    v_lshlrev_b32 v6, 1, v6
    v_add_u32 v12, s35, v4
    v_cmp_gt_u32 vcc, 28, v12
    s_nop 1
    v_cndmask_b32 v6, v7, v6, vcc
    s_mov_b32 s17, 0
    buffer_load_ushort v16, v6, s[20:23], s17 offen
    s_mov_b32 s17, 2688
    buffer_load_ushort v17, v6, s[20:23], s17 offen
    s_mov_b32 s17, 5376
    buffer_load_ushort v18, v6, s[20:23], s17 offen
    s_mov_b32 s17, 8064
    buffer_load_ushort v19, v6, s[20:23], s17 offen
    s_mov_b32 s17, 10752
    buffer_load_ushort v20, v6, s[20:23], s17 offen
    s_mov_b32 s17, 13440
    buffer_load_ushort v21, v6, s[20:23], s17 offen
    s_mov_b32 s17, 16128
    buffer_load_ushort v22, v6, s[20:23], s17 offen
    s_mov_b32 s17, 18816
    buffer_load_ushort v23, v6, s[20:23], s17 offen
    s_lshl_b32 s18, s16, 10
    s_waitcnt vmcnt(0)
    v_lshl_or_b32 v8, v17, 16, v16
    v_lshl_or_b32 v9, v19, 16, v18
    v_lshl_or_b32 v10, v21, 16, v20
    v_lshl_or_b32 v11, v23, 16, v22
    buffer_store_dwordx4 v[8:11], v5, s[24:27], s18 offen
    s_branch prep_done
prep_wo:
    s_cmp_ge_u32 s16, 1856
    s_cbranch_scc1 prep_w1
    s_sub_u32 s19, s16, 1344
    s_mov_b32 s20, s8
    s_mov_b32 s21, s9
    s_mov_b32 s22, 0x62000
    s_mov_b32 s23, 0x00020000
    s_add_u32 s24, s14, 0x150000
    s_addc_u32 s25, s15, 0
    s_mov_b32 s26, 0x80000
    s_mov_b32 s27, 0x00020000
    s_lshr_b32 s28, s19, 5
    s_and_b32 s29, s19, 31
    s_mul_i32 s30, s28, 28
    s_lshl_b32 s31, s29, 4
    v_lshlrev_b32 v6, 3, v3
    v_add_u32 v6, s30, v6
    v_mul_u32_u24 v6, 448, v6
    v_add_u32 v6, s31, v6
    v_add_u32 v6, v6, v4
    v_lshlrev_b32 v6, 1, v6
    s_cmp_lt_u32 s29, 28
    s_cselect_b32 s32, 0, 0x80000000
    v_or_b32 v6, s32, v6
    v_cmp_gt_u32 vcc, 3, v3
    s_nop 1
    v_cndmask_b32 v13, v7, v6, vcc
    s_mov_b32 s17, 0
    buffer_load_ushort v16, v6, s[20:23], s17 offen
    s_mov_b32 s17, 896
    buffer_load_ushort v17, v6, s[20:23], s17 offen
    s_mov_b32 s17, 1792
    buffer_load_ushort v18, v6, s[20:23], s17 offen
    s_mov_b32 s17, 2688
    buffer_load_ushort v19, v6, s[20:23], s17 offen
    s_mov_b32 s17, 3584
    buffer_load_ushort v20, v13, s[20:23], s17 offen
    s_mov_b32 s17, 4480
    buffer_load_ushort v21, v13, s[20:23], s17 offen
    s_mov_b32 s17, 5376
    buffer_load_ushort v22, v13, s[20:23], s17 offen
    s_mov_b32 s17, 6272
    buffer_load_ushort v23, v13, s[20:23], s17 offen
    s_lshl_b32 s18, s19, 10
    s_waitcnt vmcnt(0)
    v_lshl_or_b32 v8, v17, 16, v16
    v_lshl_or_b32 v9, v19, 16, v18
    v_lshl_or_b32 v10, v21, 16, v20
    v_lshl_or_b32 v11, v23, 16, v22
    buffer_store_dwordx4 v[8:11], v5, s[24:27], s18 offen
    s_branch prep_done
prep_w1:
    s_cmp_ge_u32 s16, 3424
    s_cbranch_scc1 prep_w2
    s_sub_u32 s19, s16, 1856
    s_mov_b32 s20, s10
    s_mov_b32 s21, s11
    s_mov_b32 s22, 0x188000
    s_mov_b32 s23, 0x00020000
    s_add_u32 s24, s14, 0x1d0000
    s_addc_u32 s25, s15, 0
    s_mov_b32 s26, 0x188000
    s_mov_b32 s27, 0x00020000
    s_mul_hi_u32 s28, s19, 0x2492493
    s_mul_i32 s29, s28, 112
    s_sub_u32 s29, s19, s29
    s_lshl_b32 s30, s28, 5
    s_lshl_b32 s31, s29, 4
    v_lshlrev_b32 v6, 3, v3
    v_add_u32 v6, s30, v6
    v_mul_u32_u24 v6, 1792, v6
    v_add_u32 v6, s31, v6
    v_add_u32 v6, v6, v4
    v_lshlrev_b32 v6, 1, v6
    s_mov_b32 s17, 0
    buffer_load_ushort v16, v6, s[20:23], s17 offen
    s_mov_b32 s17, 3584
    buffer_load_ushort v17, v6, s[20:23], s17 offen
    s_mov_b32 s17, 7168
    buffer_load_ushort v18, v6, s[20:23], s17 offen
    s_mov_b32 s17, 10752
    buffer_load_ushort v19, v6, s[20:23], s17 offen
    s_mov_b32 s17, 14336
    buffer_load_ushort v20, v6, s[20:23], s17 offen
    s_mov_b32 s17, 17920
    buffer_load_ushort v21, v6, s[20:23], s17 offen
    s_mov_b32 s17, 21504
    buffer_load_ushort v22, v6, s[20:23], s17 offen
    s_mov_b32 s17, 25088
    buffer_load_ushort v23, v6, s[20:23], s17 offen
    s_lshl_b32 s18, s19, 10
    s_waitcnt vmcnt(0)
    v_lshl_or_b32 v8, v17, 16, v16
    v_lshl_or_b32 v9, v19, 16, v18
    v_lshl_or_b32 v10, v21, 16, v20
    v_lshl_or_b32 v11, v23, 16, v22
    buffer_store_dwordx4 v[8:11], v5, s[24:27], s18 offen
    s_branch prep_done
prep_w2:
    s_cmp_ge_u32 s16, 4992
    s_cbranch_scc1 prep_phi
    s_sub_u32 s19, s16, 3424
    s_mov_b32 s20, s12
    s_mov_b32 s21, s13
    s_mov_b32 s22, 0x188000
    s_mov_b32 s23, 0x00020000
    s_add_u32 s24, s14, 0x358000
    s_addc_u32 s25, s15, 0
    s_mov_b32 s26, 0x188000
    s_mov_b32 s27, 0x00020000
    s_mul_hi_u32 s28, s19, 0x924924a
    s_mul_i32 s29, s28, 28
    s_sub_u32 s29, s19, s29
    s_lshl_b32 s30, s28, 5
    s_lshl_b32 s31, s29, 4
    v_lshlrev_b32 v6, 3, v3
    v_add_u32 v6, s30, v6
    v_mul_u32_u24 v6, 448, v6
    v_add_u32 v6, s31, v6
    v_add_u32 v6, v6, v4
    v_lshlrev_b32 v6, 1, v6
    s_mov_b32 s17, 0
    buffer_load_ushort v16, v6, s[20:23], s17 offen
    s_mov_b32 s17, 896
    buffer_load_ushort v17, v6, s[20:23], s17 offen
    s_mov_b32 s17, 1792
    buffer_load_ushort v18, v6, s[20:23], s17 offen
    s_mov_b32 s17, 2688
    buffer_load_ushort v19, v6, s[20:23], s17 offen
    s_mov_b32 s17, 3584
    buffer_load_ushort v20, v6, s[20:23], s17 offen
    s_mov_b32 s17, 4480
    buffer_load_ushort v21, v6, s[20:23], s17 offen
    s_mov_b32 s17, 5376
    buffer_load_ushort v22, v6, s[20:23], s17 offen
    s_mov_b32 s17, 6272
    buffer_load_ushort v23, v6, s[20:23], s17 offen
    s_lshl_b32 s18, s19, 10
    s_waitcnt vmcnt(0)
    v_lshl_or_b32 v8, v17, 16, v16
    v_lshl_or_b32 v9, v19, 16, v18
    v_lshl_or_b32 v10, v21, 16, v20
    v_lshl_or_b32 v11, v23, 16, v22
    buffer_store_dwordx4 v[8:11], v5, s[24:27], s18 offen
    s_branch prep_done
prep_phi:
    s_cmp_ge_u32 s16, 5024
    s_cbranch_scc1 prep_zero
    s_sub_u32 s19, s16, 4992
    s_mov_b32 s20, s6
    s_mov_b32 s21, s7
    s_mov_b32 s22, 0x6200
    s_mov_b32 s23, 0x00020000
    s_add_u32 s24, s14, 0x4e0000
    s_addc_u32 s25, s15, 0
    s_mov_b32 s26, 0x8000
    s_mov_b32 s27, 0x00020000
    s_lshr_b32 s28, s19, 1
    s_and_b32 s29, s19, 1
    s_mul_i32 s30, s28, 784
    s_lshl_b32 s31, s29, 4
    s_add_u32 s30, s30, s31
    v_mul_u32_u24 v6, 112, v3
    v_add_u32 v6, s30, v6
    v_add_u32 v6, v6, v4
    v_lshlrev_b32 v6, 1, v6
    v_add_u32 v12, s31, v4
    v_cmp_gt_u32 vcc, 28, v12
    s_nop 1
    v_cndmask_b32 v6, v7, v6, vcc
    v_cmp_gt_u32 vcc, 3, v3
    s_nop 1
    v_cndmask_b32 v13, v7, v6, vcc
    s_mov_b32 s17, 0
    buffer_load_ushort v16, v6, s[20:23], s17 offen
    s_mov_b32 s17, 56
    buffer_load_ushort v17, v6, s[20:23], s17 offen
    s_mov_b32 s17, 112
    buffer_load_ushort v18, v6, s[20:23], s17 offen
    s_mov_b32 s17, 168
    buffer_load_ushort v19, v6, s[20:23], s17 offen
    s_mov_b32 s17, 896
    buffer_load_ushort v20, v13, s[20:23], s17 offen
    s_mov_b32 s17, 952
    buffer_load_ushort v21, v13, s[20:23], s17 offen
    s_mov_b32 s17, 1008
    buffer_load_ushort v22, v13, s[20:23], s17 offen
    s_mov_b32 s17, 1064
    buffer_load_ushort v23, v13, s[20:23], s17 offen
    s_lshl_b32 s18, s19, 10
    s_waitcnt vmcnt(0)
    v_lshl_or_b32 v8, v17, 16, v16
    v_lshl_or_b32 v9, v19, 16, v18
    v_lshl_or_b32 v10, v21, 16, v20
    v_lshl_or_b32 v11, v23, 16, v22
    buffer_store_dwordx4 v[8:11], v5, s[24:27], s18 offen
    s_branch prep_done
prep_zero:
    s_sub_u32 s19, s16, 5024
    s_add_u32 s24, s14, 0x4e8000
    s_addc_u32 s25, s15, 0
    s_mov_b32 s26, 0x40000
    s_mov_b32 s27, 0x00020000
    v_mov_b32 v8, 0
    v_mov_b32 v9, 0
    v_mov_b32 v10, 0
    v_mov_b32 v11, 0
    s_lshl_b32 s18, s19, 10
    buffer_store_dwordx4 v[8:11], v5, s[24:27], s18 offen
prep_done:
    s_endpgm
.globl k1l1_kernel
.p2align 8
.type k1l1_kernel,@function
k1l1_kernel:
    s_cmp_ge_u32 s2, 256
    s_cbranch_scc1 k1l1_kernel_done
    s_load_dwordx2 s[24:25], s[0:1], 88
    s_load_dwordx2 s[26:27], s[0:1], 0
    v_lshrrev_b32 v9, 6, v0
    v_and_b32 v1, 63, v0
    v_lshlrev_b32 v2, 4, v1
    v_and_b32 v3, 15, v1
    v_lshrrev_b32 v4, 4, v1
    v_readfirstlane_b32 s3, v9
    v_add_u32 v9, 0, v4
    v_xor_b32 v9, v9, v3
    v_lshlrev_b32 v9, 4, v9
    v_lshl_add_u32 v5, v3, 10, v9
    v_add_u32 v9, 4, v4
    v_xor_b32 v9, v9, v3
    v_lshlrev_b32 v9, 4, v9
    v_lshl_add_u32 v6, v3, 10, v9
    v_add_u32 v9, 8, v4
    v_xor_b32 v9, v9, v3
    v_lshlrev_b32 v9, 4, v9
    v_lshl_add_u32 v7, v3, 10, v9
    v_add_u32 v9, 12, v4
    v_xor_b32 v9, v9, v3
    v_lshlrev_b32 v9, 4, v9
    v_lshl_add_u32 v8, v3, 10, v9
    s_and_b32 s28, s2, 7
    s_lshl_b32 s28, s28, 3
    s_lshr_b32 s29, s2, 5
    s_add_u32 s28, s28, s29
    s_lshr_b32 s29, s2, 3
    s_and_b32 s29, s29, 3
    s_lshl_b32 s29, s29, 2
    s_add_u32 s29, s29, s3
    s_waitcnt lgkmcnt(0)
    s_mov_b32 s4, s26
    s_mov_b32 s5, s27
    s_mov_b32 s6, 0x1c0000
    s_mov_b32 s7, 0x00020000
    s_mov_b32 s8, s24
    s_mov_b32 s9, s25
    s_mov_b32 s10, 0x150000
    s_mov_b32 s11, 0x00020000
    s_add_u32 s12, s24, 0x4e0000
    s_addc_u32 s13, s25, 0
    s_mov_b32 s14, 0x8000
    s_mov_b32 s15, 0x00020000
    s_add_u32 s16, s24, 0x1278000
    s_addc_u32 s17, s25, 0
    s_mov_b32 s18, 0x400000
    s_mov_b32 s19, 0x00020000
    s_add_u32 s20, s24, 0x528000
    s_addc_u32 s21, s25, 0
    s_mov_b32 s22, 0x800000
    s_mov_b32 s23, 0x00020000
    s_mul_i32 s30, s28, 28672
    s_mul_i32 s31, s29, 86016
    v_lshrrev_b32 v9, 3, v0
    v_mul_u32_u24 v9, 896, v9
    v_and_b32 v10, 7, v0
    v_lshl_add_u32 v10, v10, 4, v9
    buffer_load_dwordx4 v[160:163], v10, s[4:7], s30 offen offset:0
    buffer_load_dwordx4 v[164:167], v10, s[4:7], s30 offen offset:128
    buffer_load_dwordx4 v[168:171], v10, s[4:7], s30 offen offset:256
    buffer_load_dwordx4 v[172:175], v10, s[4:7], s30 offen offset:384
    buffer_load_dwordx4 v[176:179], v10, s[4:7], s30 offen offset:512
    buffer_load_dwordx4 v[180:183], v10, s[4:7], s30 offen offset:640
    buffer_load_dwordx4 v[184:187], v10, s[4:7], s30 offen offset:768
    s_lshl_b32 s32, s29, 11
    buffer_load_dwordx4 v[152:155], v2, s[12:15], s32 offen
    buffer_load_dwordx4 v[156:159], v2, s[12:15], s32 offen offset:1024
    s_add_u32 s33, s31, 0x0
    buffer_load_dwordx4 a[0:3], v2, s[8:11], s33 offen offset:0
    buffer_load_dwordx4 a[4:7], v2, s[8:11], s33 offen offset:1024
    buffer_load_dwordx4 a[8:11], v2, s[8:11], s33 offen offset:2048
    buffer_load_dwordx4 a[12:15], v2, s[8:11], s33 offen offset:3072
    s_add_u32 s33, s31, 0x1000
    buffer_load_dwordx4 a[16:19], v2, s[8:11], s33 offen offset:0
    buffer_load_dwordx4 a[20:23], v2, s[8:11], s33 offen offset:1024
    s_add_u32 s33, s31, 0x1800
    buffer_load_dwordx4 a[24:27], v2, s[8:11], s33 offen offset:0
    buffer_load_dwordx4 a[28:31], v2, s[8:11], s33 offen offset:1024
    buffer_load_dwordx4 a[32:35], v2, s[8:11], s33 offen offset:2048
    buffer_load_dwordx4 a[36:39], v2, s[8:11], s33 offen offset:3072
    s_add_u32 s33, s31, 0x2800
    buffer_load_dwordx4 a[40:43], v2, s[8:11], s33 offen offset:0
    buffer_load_dwordx4 a[44:47], v2, s[8:11], s33 offen offset:1024
    s_add_u32 s33, s31, 0x3000
    buffer_load_dwordx4 a[48:51], v2, s[8:11], s33 offen offset:0
    buffer_load_dwordx4 a[52:55], v2, s[8:11], s33 offen offset:1024
    buffer_load_dwordx4 a[56:59], v2, s[8:11], s33 offen offset:2048
    buffer_load_dwordx4 a[60:63], v2, s[8:11], s33 offen offset:3072
    s_add_u32 s33, s31, 0x4000
    buffer_load_dwordx4 a[64:67], v2, s[8:11], s33 offen offset:0
    buffer_load_dwordx4 a[68:71], v2, s[8:11], s33 offen offset:1024
    s_add_u32 s33, s31, 0x4800
    buffer_load_dwordx4 a[72:75], v2, s[8:11], s33 offen offset:0
    buffer_load_dwordx4 a[76:79], v2, s[8:11], s33 offen offset:1024
    buffer_load_dwordx4 a[80:83], v2, s[8:11], s33 offen offset:2048
    buffer_load_dwordx4 a[84:87], v2, s[8:11], s33 offen offset:3072
    s_add_u32 s33, s31, 0x5800
    buffer_load_dwordx4 a[88:91], v2, s[8:11], s33 offen offset:0
    buffer_load_dwordx4 a[92:95], v2, s[8:11], s33 offen offset:1024
    s_add_u32 s33, s31, 0x6000
    buffer_load_dwordx4 a[96:99], v2, s[8:11], s33 offen offset:0
    buffer_load_dwordx4 a[100:103], v2, s[8:11], s33 offen offset:1024
    buffer_load_dwordx4 a[104:107], v2, s[8:11], s33 offen offset:2048
    buffer_load_dwordx4 a[108:111], v2, s[8:11], s33 offen offset:3072
    s_add_u32 s33, s31, 0x7000
    buffer_load_dwordx4 a[112:115], v2, s[8:11], s33 offen offset:0
    buffer_load_dwordx4 a[116:119], v2, s[8:11], s33 offen offset:1024
    s_add_u32 s33, s31, 0x7800
    buffer_load_dwordx4 a[120:123], v2, s[8:11], s33 offen offset:0
    buffer_load_dwordx4 a[124:127], v2, s[8:11], s33 offen offset:1024
    buffer_load_dwordx4 a[128:131], v2, s[8:11], s33 offen offset:2048
    buffer_load_dwordx4 a[132:135], v2, s[8:11], s33 offen offset:3072
    s_add_u32 s33, s31, 0x8800
    buffer_load_dwordx4 a[136:139], v2, s[8:11], s33 offen offset:0
    buffer_load_dwordx4 a[140:143], v2, s[8:11], s33 offen offset:1024
    s_add_u32 s33, s31, 0x9000
    buffer_load_dwordx4 a[144:147], v2, s[8:11], s33 offen offset:0
    buffer_load_dwordx4 a[148:151], v2, s[8:11], s33 offen offset:1024
    buffer_load_dwordx4 a[152:155], v2, s[8:11], s33 offen offset:2048
    buffer_load_dwordx4 a[156:159], v2, s[8:11], s33 offen offset:3072
    s_add_u32 s33, s31, 0xa000
    buffer_load_dwordx4 a[160:163], v2, s[8:11], s33 offen offset:0
    buffer_load_dwordx4 a[164:167], v2, s[8:11], s33 offen offset:1024
    s_add_u32 s33, s31, 0xa800
    buffer_load_dwordx4 a[168:171], v2, s[8:11], s33 offen offset:0
    buffer_load_dwordx4 a[172:175], v2, s[8:11], s33 offen offset:1024
    buffer_load_dwordx4 a[176:179], v2, s[8:11], s33 offen offset:2048
    buffer_load_dwordx4 a[180:183], v2, s[8:11], s33 offen offset:3072
    s_add_u32 s33, s31, 0xb800
    buffer_load_dwordx4 a[184:187], v2, s[8:11], s33 offen offset:0
    buffer_load_dwordx4 a[188:191], v2, s[8:11], s33 offen offset:1024
    s_add_u32 s33, s31, 0xc000
    buffer_load_dwordx4 a[192:195], v2, s[8:11], s33 offen offset:0
    buffer_load_dwordx4 a[196:199], v2, s[8:11], s33 offen offset:1024
    buffer_load_dwordx4 a[200:203], v2, s[8:11], s33 offen offset:2048
    buffer_load_dwordx4 a[204:207], v2, s[8:11], s33 offen offset:3072
    s_add_u32 s33, s31, 0xd000
    buffer_load_dwordx4 a[208:211], v2, s[8:11], s33 offen offset:0
    buffer_load_dwordx4 a[212:215], v2, s[8:11], s33 offen offset:1024
    s_waitcnt vmcnt(56)
    s_mov_b32 s34, 0x3f803f80
    v_mov_b32 v188, 0
    v_mov_b32 v189, 0
    v_mov_b32 v190, 0
    v_mov_b32 v191, 0
    v_dot2_f32_bf16 v188, v160, s34, v188
    v_dot2_f32_bf16 v190, v160, v160, v190
    v_dot2_f32_bf16 v189, v161, s34, v189
    v_dot2_f32_bf16 v191, v161, v161, v191
    v_dot2_f32_bf16 v188, v162, s34, v188
    v_dot2_f32_bf16 v190, v162, v162, v190
    v_dot2_f32_bf16 v189, v163, s34, v189
    v_dot2_f32_bf16 v191, v163, v163, v191
    v_dot2_f32_bf16 v188, v164, s34, v188
    v_dot2_f32_bf16 v190, v164, v164, v190
    v_dot2_f32_bf16 v189, v165, s34, v189
    v_dot2_f32_bf16 v191, v165, v165, v191
    v_dot2_f32_bf16 v188, v166, s34, v188
    v_dot2_f32_bf16 v190, v166, v166, v190
    v_dot2_f32_bf16 v189, v167, s34, v189
    v_dot2_f32_bf16 v191, v167, v167, v191
    v_dot2_f32_bf16 v188, v168, s34, v188
    v_dot2_f32_bf16 v190, v168, v168, v190
    v_dot2_f32_bf16 v189, v169, s34, v189
    v_dot2_f32_bf16 v191, v169, v169, v191
    v_dot2_f32_bf16 v188, v170, s34, v188
    v_dot2_f32_bf16 v190, v170, v170, v190
    v_dot2_f32_bf16 v189, v171, s34, v189
    v_dot2_f32_bf16 v191, v171, v171, v191
    v_dot2_f32_bf16 v188, v172, s34, v188
    v_dot2_f32_bf16 v190, v172, v172, v190
    v_dot2_f32_bf16 v189, v173, s34, v189
    v_dot2_f32_bf16 v191, v173, v173, v191
    v_dot2_f32_bf16 v188, v174, s34, v188
    v_dot2_f32_bf16 v190, v174, v174, v190
    v_dot2_f32_bf16 v189, v175, s34, v189
    v_dot2_f32_bf16 v191, v175, v175, v191
    v_dot2_f32_bf16 v188, v176, s34, v188
    v_dot2_f32_bf16 v190, v176, v176, v190
    v_dot2_f32_bf16 v189, v177, s34, v189
    v_dot2_f32_bf16 v191, v177, v177, v191
    v_dot2_f32_bf16 v188, v178, s34, v188
    v_dot2_f32_bf16 v190, v178, v178, v190
    v_dot2_f32_bf16 v189, v179, s34, v189
    v_dot2_f32_bf16 v191, v179, v179, v191
    v_dot2_f32_bf16 v188, v180, s34, v188
    v_dot2_f32_bf16 v190, v180, v180, v190
    v_dot2_f32_bf16 v189, v181, s34, v189
    v_dot2_f32_bf16 v191, v181, v181, v191
    v_dot2_f32_bf16 v188, v182, s34, v188
    v_dot2_f32_bf16 v190, v182, v182, v190
    v_dot2_f32_bf16 v189, v183, s34, v189
    v_dot2_f32_bf16 v191, v183, v183, v191
    v_dot2_f32_bf16 v188, v184, s34, v188
    v_dot2_f32_bf16 v190, v184, v184, v190
    v_dot2_f32_bf16 v189, v185, s34, v189
    v_dot2_f32_bf16 v191, v185, v185, v191
    v_dot2_f32_bf16 v188, v186, s34, v188
    v_dot2_f32_bf16 v190, v186, v186, v190
    v_dot2_f32_bf16 v189, v187, s34, v189
    v_dot2_f32_bf16 v191, v187, v187, v191
    s_nop 3
    v_add_f32 v188, v188, v189
    v_add_f32 v190, v190, v191
    s_nop 1
    v_add_f32_dpp v189, v188, v188 quad_perm:[1,0,3,2] row_mask:0xf bank_mask:0xf
    v_add_f32_dpp v191, v190, v190 quad_perm:[1,0,3,2] row_mask:0xf bank_mask:0xf
    v_mov_b32 v188, v189
    v_mov_b32 v190, v191
    s_nop 1
    v_add_f32_dpp v189, v188, v188 quad_perm:[2,3,0,1] row_mask:0xf bank_mask:0xf
    v_add_f32_dpp v191, v190, v190 quad_perm:[2,3,0,1] row_mask:0xf bank_mask:0xf
    v_mov_b32 v188, v189
    v_mov_b32 v190, v191
    s_nop 1
    v_add_f32_dpp v189, v188, v188 row_half_mirror row_mask:0xf bank_mask:0xf
    v_add_f32_dpp v191, v190, v190 row_half_mirror row_mask:0xf bank_mask:0xf
    v_mov_b32 v188, v189
    v_mov_b32 v190, v191
    s_mov_b32 s34, 0x3b124925
    v_mul_f32 v192, s34, v188
    v_mul_f32 v193, s34, v190
    v_fma_f32 v193, -v192, v192, v193
    v_max_f32 v193, 0, v193
    v_cvt_pk_bf16_f32 v194, v192, v193
    v_lshlrev_b32 v196, 16, v194
    v_sub_f32 v196, 0, v196
    v_mov_b32 v197, v196
    v_and_b32 v193, 0xffff0000, v194
    s_mov_b32 s34, 0x3727c5ac
    v_add_f32 v193, s34, v193
    v_cvt_pk_bf16_f32 v194, v193, v193
    v_lshlrev_b32 v193, 16, v194
    v_sqrt_f32 v193, v193
    s_nop 0
    v_cvt_pk_bf16_f32 v194, v193, v193
    v_lshlrev_b32 v193, 16, v194
    v_rcp_f32 v198, v193
    s_nop 0
    v_mov_b32 v199, v198
    v_lshlrev_b32 v200, 16, v160
    v_and_b32 v201, 0xffff0000, v160
    v_lshlrev_b32 v202, 16, v161
    v_and_b32 v203, 0xffff0000, v161
    v_lshlrev_b32 v204, 16, v162
    v_and_b32 v205, 0xffff0000, v162
    v_lshlrev_b32 v206, 16, v163
    v_and_b32 v207, 0xffff0000, v163
    v_pk_add_f32 v[200:201], v[200:201], v[196:197]
    v_pk_add_f32 v[202:203], v[202:203], v[196:197]
    v_pk_add_f32 v[204:205], v[204:205], v[196:197]
    v_pk_add_f32 v[206:207], v[206:207], v[196:197]
    v_cvt_pk_bf16_f32 v160, v200, v201
    v_cvt_pk_bf16_f32 v161, v202, v203
    v_cvt_pk_bf16_f32 v162, v204, v205
    v_cvt_pk_bf16_f32 v163, v206, v207
    v_lshlrev_b32 v200, 16, v160
    v_and_b32 v201, 0xffff0000, v160
    v_lshlrev_b32 v202, 16, v161
    v_and_b32 v203, 0xffff0000, v161
    v_lshlrev_b32 v204, 16, v162
    v_and_b32 v205, 0xffff0000, v162
    v_lshlrev_b32 v206, 16, v163
    v_and_b32 v207, 0xffff0000, v163
    v_pk_mul_f32 v[200:201], v[200:201], v[198:199]
    v_pk_mul_f32 v[202:203], v[202:203], v[198:199]
    v_pk_mul_f32 v[204:205], v[204:205], v[198:199]
    v_pk_mul_f32 v[206:207], v[206:207], v[198:199]
    v_cvt_pk_bf16_f32 v160, v200, v201
    v_cvt_pk_bf16_f32 v161, v202, v203
    v_cvt_pk_bf16_f32 v162, v204, v205
    v_cvt_pk_bf16_f32 v163, v206, v207
    v_lshlrev_b32 v200, 16, v164
    v_and_b32 v201, 0xffff0000, v164
    v_lshlrev_b32 v202, 16, v165
    v_and_b32 v203, 0xffff0000, v165
    v_lshlrev_b32 v204, 16, v166
    v_and_b32 v205, 0xffff0000, v166
    v_lshlrev_b32 v206, 16, v167
    v_and_b32 v207, 0xffff0000, v167
    v_pk_add_f32 v[200:201], v[200:201], v[196:197]
    v_pk_add_f32 v[202:203], v[202:203], v[196:197]
    v_pk_add_f32 v[204:205], v[204:205], v[196:197]
    v_pk_add_f32 v[206:207], v[206:207], v[196:197]
    v_cvt_pk_bf16_f32 v164, v200, v201
    v_cvt_pk_bf16_f32 v165, v202, v203
    v_cvt_pk_bf16_f32 v166, v204, v205
    v_cvt_pk_bf16_f32 v167, v206, v207
    v_lshlrev_b32 v200, 16, v164
    v_and_b32 v201, 0xffff0000, v164
    v_lshlrev_b32 v202, 16, v165
    v_and_b32 v203, 0xffff0000, v165
    v_lshlrev_b32 v204, 16, v166
    v_and_b32 v205, 0xffff0000, v166
    v_lshlrev_b32 v206, 16, v167
    v_and_b32 v207, 0xffff0000, v167
    v_pk_mul_f32 v[200:201], v[200:201], v[198:199]
    v_pk_mul_f32 v[202:203], v[202:203], v[198:199]
    v_pk_mul_f32 v[204:205], v[204:205], v[198:199]
    v_pk_mul_f32 v[206:207], v[206:207], v[198:199]
    v_cvt_pk_bf16_f32 v164, v200, v201
    v_cvt_pk_bf16_f32 v165, v202, v203
    v_cvt_pk_bf16_f32 v166, v204, v205
    v_cvt_pk_bf16_f32 v167, v206, v207
    v_lshlrev_b32 v200, 16, v168
    v_and_b32 v201, 0xffff0000, v168
    v_lshlrev_b32 v202, 16, v169
    v_and_b32 v203, 0xffff0000, v169
    v_lshlrev_b32 v204, 16, v170
    v_and_b32 v205, 0xffff0000, v170
    v_lshlrev_b32 v206, 16, v171
    v_and_b32 v207, 0xffff0000, v171
    v_pk_add_f32 v[200:201], v[200:201], v[196:197]
    v_pk_add_f32 v[202:203], v[202:203], v[196:197]
    v_pk_add_f32 v[204:205], v[204:205], v[196:197]
    v_pk_add_f32 v[206:207], v[206:207], v[196:197]
    v_cvt_pk_bf16_f32 v168, v200, v201
    v_cvt_pk_bf16_f32 v169, v202, v203
    v_cvt_pk_bf16_f32 v170, v204, v205
    v_cvt_pk_bf16_f32 v171, v206, v207
    v_lshlrev_b32 v200, 16, v168
    v_and_b32 v201, 0xffff0000, v168
    v_lshlrev_b32 v202, 16, v169
    v_and_b32 v203, 0xffff0000, v169
    v_lshlrev_b32 v204, 16, v170
    v_and_b32 v205, 0xffff0000, v170
    v_lshlrev_b32 v206, 16, v171
    v_and_b32 v207, 0xffff0000, v171
    v_pk_mul_f32 v[200:201], v[200:201], v[198:199]
    v_pk_mul_f32 v[202:203], v[202:203], v[198:199]
    v_pk_mul_f32 v[204:205], v[204:205], v[198:199]
    v_pk_mul_f32 v[206:207], v[206:207], v[198:199]
    v_cvt_pk_bf16_f32 v168, v200, v201
    v_cvt_pk_bf16_f32 v169, v202, v203
    v_cvt_pk_bf16_f32 v170, v204, v205
    v_cvt_pk_bf16_f32 v171, v206, v207
    v_lshlrev_b32 v200, 16, v172
    v_and_b32 v201, 0xffff0000, v172
    v_lshlrev_b32 v202, 16, v173
    v_and_b32 v203, 0xffff0000, v173
    v_lshlrev_b32 v204, 16, v174
    v_and_b32 v205, 0xffff0000, v174
    v_lshlrev_b32 v206, 16, v175
    v_and_b32 v207, 0xffff0000, v175
    v_pk_add_f32 v[200:201], v[200:201], v[196:197]
    v_pk_add_f32 v[202:203], v[202:203], v[196:197]
    v_pk_add_f32 v[204:205], v[204:205], v[196:197]
    v_pk_add_f32 v[206:207], v[206:207], v[196:197]
    v_cvt_pk_bf16_f32 v172, v200, v201
    v_cvt_pk_bf16_f32 v173, v202, v203
    v_cvt_pk_bf16_f32 v174, v204, v205
    v_cvt_pk_bf16_f32 v175, v206, v207
    v_lshlrev_b32 v200, 16, v172
    v_and_b32 v201, 0xffff0000, v172
    v_lshlrev_b32 v202, 16, v173
    v_and_b32 v203, 0xffff0000, v173
    v_lshlrev_b32 v204, 16, v174
    v_and_b32 v205, 0xffff0000, v174
    v_lshlrev_b32 v206, 16, v175
    v_and_b32 v207, 0xffff0000, v175
    v_pk_mul_f32 v[200:201], v[200:201], v[198:199]
    v_pk_mul_f32 v[202:203], v[202:203], v[198:199]
    v_pk_mul_f32 v[204:205], v[204:205], v[198:199]
    v_pk_mul_f32 v[206:207], v[206:207], v[198:199]
    v_cvt_pk_bf16_f32 v172, v200, v201
    v_cvt_pk_bf16_f32 v173, v202, v203
    v_cvt_pk_bf16_f32 v174, v204, v205
    v_cvt_pk_bf16_f32 v175, v206, v207
    v_lshlrev_b32 v200, 16, v176
    v_and_b32 v201, 0xffff0000, v176
    v_lshlrev_b32 v202, 16, v177
    v_and_b32 v203, 0xffff0000, v177
    v_lshlrev_b32 v204, 16, v178
    v_and_b32 v205, 0xffff0000, v178
    v_lshlrev_b32 v206, 16, v179
    v_and_b32 v207, 0xffff0000, v179
    v_pk_add_f32 v[200:201], v[200:201], v[196:197]
    v_pk_add_f32 v[202:203], v[202:203], v[196:197]
    v_pk_add_f32 v[204:205], v[204:205], v[196:197]
    v_pk_add_f32 v[206:207], v[206:207], v[196:197]
    v_cvt_pk_bf16_f32 v176, v200, v201
    v_cvt_pk_bf16_f32 v177, v202, v203
    v_cvt_pk_bf16_f32 v178, v204, v205
    v_cvt_pk_bf16_f32 v179, v206, v207
    v_lshlrev_b32 v200, 16, v176
    v_and_b32 v201, 0xffff0000, v176
    v_lshlrev_b32 v202, 16, v177
    v_and_b32 v203, 0xffff0000, v177
    v_lshlrev_b32 v204, 16, v178
    v_and_b32 v205, 0xffff0000, v178
    v_lshlrev_b32 v206, 16, v179
    v_and_b32 v207, 0xffff0000, v179
    v_pk_mul_f32 v[200:201], v[200:201], v[198:199]
    v_pk_mul_f32 v[202:203], v[202:203], v[198:199]
    v_pk_mul_f32 v[204:205], v[204:205], v[198:199]
    v_pk_mul_f32 v[206:207], v[206:207], v[198:199]
    v_cvt_pk_bf16_f32 v176, v200, v201
    v_cvt_pk_bf16_f32 v177, v202, v203
    v_cvt_pk_bf16_f32 v178, v204, v205
    v_cvt_pk_bf16_f32 v179, v206, v207
    v_lshlrev_b32 v200, 16, v180
    v_and_b32 v201, 0xffff0000, v180
    v_lshlrev_b32 v202, 16, v181
    v_and_b32 v203, 0xffff0000, v181
    v_lshlrev_b32 v204, 16, v182
    v_and_b32 v205, 0xffff0000, v182
    v_lshlrev_b32 v206, 16, v183
    v_and_b32 v207, 0xffff0000, v183
    v_pk_add_f32 v[200:201], v[200:201], v[196:197]
    v_pk_add_f32 v[202:203], v[202:203], v[196:197]
    v_pk_add_f32 v[204:205], v[204:205], v[196:197]
    v_pk_add_f32 v[206:207], v[206:207], v[196:197]
    v_cvt_pk_bf16_f32 v180, v200, v201
    v_cvt_pk_bf16_f32 v181, v202, v203
    v_cvt_pk_bf16_f32 v182, v204, v205
    v_cvt_pk_bf16_f32 v183, v206, v207
    v_lshlrev_b32 v200, 16, v180
    v_and_b32 v201, 0xffff0000, v180
    v_lshlrev_b32 v202, 16, v181
    v_and_b32 v203, 0xffff0000, v181
    v_lshlrev_b32 v204, 16, v182
    v_and_b32 v205, 0xffff0000, v182
    v_lshlrev_b32 v206, 16, v183
    v_and_b32 v207, 0xffff0000, v183
    v_pk_mul_f32 v[200:201], v[200:201], v[198:199]
    v_pk_mul_f32 v[202:203], v[202:203], v[198:199]
    v_pk_mul_f32 v[204:205], v[204:205], v[198:199]
    v_pk_mul_f32 v[206:207], v[206:207], v[198:199]
    v_cvt_pk_bf16_f32 v180, v200, v201
    v_cvt_pk_bf16_f32 v181, v202, v203
    v_cvt_pk_bf16_f32 v182, v204, v205
    v_cvt_pk_bf16_f32 v183, v206, v207
    v_lshlrev_b32 v200, 16, v184
    v_and_b32 v201, 0xffff0000, v184
    v_lshlrev_b32 v202, 16, v185
    v_and_b32 v203, 0xffff0000, v185
    v_lshlrev_b32 v204, 16, v186
    v_and_b32 v205, 0xffff0000, v186
    v_lshlrev_b32 v206, 16, v187
    v_and_b32 v207, 0xffff0000, v187
    v_pk_add_f32 v[200:201], v[200:201], v[196:197]
    v_pk_add_f32 v[202:203], v[202:203], v[196:197]
    v_pk_add_f32 v[204:205], v[204:205], v[196:197]
    v_pk_add_f32 v[206:207], v[206:207], v[196:197]
    v_cvt_pk_bf16_f32 v184, v200, v201
    v_cvt_pk_bf16_f32 v185, v202, v203
    v_cvt_pk_bf16_f32 v186, v204, v205
    v_cvt_pk_bf16_f32 v187, v206, v207
    v_lshlrev_b32 v200, 16, v184
    v_and_b32 v201, 0xffff0000, v184
    v_lshlrev_b32 v202, 16, v185
    v_and_b32 v203, 0xffff0000, v185
    v_lshlrev_b32 v204, 16, v186
    v_and_b32 v205, 0xffff0000, v186
    v_lshlrev_b32 v206, 16, v187
    v_and_b32 v207, 0xffff0000, v187
    v_pk_mul_f32 v[200:201], v[200:201], v[198:199]
    v_pk_mul_f32 v[202:203], v[202:203], v[198:199]
    v_pk_mul_f32 v[204:205], v[204:205], v[198:199]
    v_pk_mul_f32 v[206:207], v[206:207], v[198:199]
    v_cvt_pk_bf16_f32 v184, v200, v201
    v_cvt_pk_bf16_f32 v185, v202, v203
    v_cvt_pk_bf16_f32 v186, v204, v205
    v_cvt_pk_bf16_f32 v187, v206, v207
    v_lshrrev_b32 v188, 3, v0
    v_and_b32 v189, 7, v0
    v_and_b32 v190, 15, v188
    v_xor_b32 v191, v189, v190
    v_lshlrev_b32 v191, 4, v191
    v_add_u32 v189, 8, v189
    v_xor_b32 v190, v189, v190
    v_lshlrev_b32 v190, 4, v190
    v_lshlrev_b32 v188, 10, v188
    v_add_u32 v191, v191, v188
    v_add_u32 v190, v190, v188
    ds_write_b128 v191, v[160:163] offset:0
    ds_write_b128 v190, v[164:167] offset:0
    ds_write_b128 v191, v[168:171] offset:256
    ds_write_b128 v190, v[172:175] offset:256
    ds_write_b128 v191, v[176:179] offset:512
    ds_write_b128 v190, v[180:183] offset:512
    ds_write_b128 v191, v[184:187] offset:768
    s_waitcnt lgkmcnt(0)
    s_barrier
    ds_read_b128 v[136:139], v5 offset:0
    ds_read_b128 v[140:143], v5 offset:16384
    ds_read_b128 v[144:147], v6 offset:0
    ds_read_b128 v[148:151], v6 offset:16384
    s_waitcnt vmcnt(48)
    s_waitcnt lgkmcnt(2)
    v_mfma_f32_16x16x32_bf16 v[16:19], a[0:3], v[136:139], 0
    v_mfma_f32_16x16x32_bf16 v[20:23], a[0:3], v[140:143], 0
    v_mfma_f32_16x16x32_bf16 v[24:27], a[4:7], v[136:139], 0
    v_mfma_f32_16x16x32_bf16 v[28:31], a[4:7], v[140:143], 0
    v_mfma_f32_16x16x32_bf16 v[32:35], a[8:11], v[136:139], 0
    v_mfma_f32_16x16x32_bf16 v[36:39], a[8:11], v[140:143], 0
    v_mfma_f32_16x16x32_bf16 v[40:43], a[12:15], v[136:139], 0
    v_mfma_f32_16x16x32_bf16 v[44:47], a[12:15], v[140:143], 0
    v_mfma_f32_16x16x32_bf16 v[48:51], v[136:139], a[16:19], 0
    v_mfma_f32_16x16x32_bf16 v[52:55], v[140:143], a[16:19], 0
    v_mfma_f32_16x16x32_bf16 v[56:59], v[136:139], a[20:23], 0
    v_mfma_f32_16x16x32_bf16 v[60:63], v[140:143], a[20:23], 0
    s_add_u32 s33, s31, 0xd800
    buffer_load_dwordx4 a[0:3], v2, s[8:11], s33 offen offset:0
    buffer_load_dwordx4 a[4:7], v2, s[8:11], s33 offen offset:1024
    buffer_load_dwordx4 a[8:11], v2, s[8:11], s33 offen offset:2048
    buffer_load_dwordx4 a[12:15], v2, s[8:11], s33 offen offset:3072
    s_add_u32 s33, s31, 0xe800
    buffer_load_dwordx4 a[16:19], v2, s[8:11], s33 offen offset:0
    buffer_load_dwordx4 a[20:23], v2, s[8:11], s33 offen offset:1024
    ds_read_b128 v[136:139], v7 offset:0
    ds_read_b128 v[140:143], v7 offset:16384
    s_waitcnt vmcnt(48)
    s_waitcnt lgkmcnt(2)
    v_mfma_f32_16x16x32_bf16 v[16:19], a[24:27], v[144:147], v[16:19]
    v_mfma_f32_16x16x32_bf16 v[20:23], a[24:27], v[148:151], v[20:23]
    v_mfma_f32_16x16x32_bf16 v[24:27], a[28:31], v[144:147], v[24:27]
    v_mfma_f32_16x16x32_bf16 v[28:31], a[28:31], v[148:151], v[28:31]
    v_mfma_f32_16x16x32_bf16 v[32:35], a[32:35], v[144:147], v[32:35]
    v_mfma_f32_16x16x32_bf16 v[36:39], a[32:35], v[148:151], v[36:39]
    v_mfma_f32_16x16x32_bf16 v[40:43], a[36:39], v[144:147], v[40:43]
    v_mfma_f32_16x16x32_bf16 v[44:47], a[36:39], v[148:151], v[44:47]
    v_mfma_f32_16x16x32_bf16 v[48:51], v[144:147], a[40:43], v[48:51]
    v_mfma_f32_16x16x32_bf16 v[52:55], v[148:151], a[40:43], v[52:55]
    v_mfma_f32_16x16x32_bf16 v[56:59], v[144:147], a[44:47], v[56:59]
    v_mfma_f32_16x16x32_bf16 v[60:63], v[148:151], a[44:47], v[60:63]
    s_add_u32 s33, s31, 0xf000
    buffer_load_dwordx4 a[24:27], v2, s[8:11], s33 offen offset:0
    buffer_load_dwordx4 a[28:31], v2, s[8:11], s33 offen offset:1024
    buffer_load_dwordx4 a[32:35], v2, s[8:11], s33 offen offset:2048
    buffer_load_dwordx4 a[36:39], v2, s[8:11], s33 offen offset:3072
    s_add_u32 s33, s31, 0x10000
    buffer_load_dwordx4 a[40:43], v2, s[8:11], s33 offen offset:0
    buffer_load_dwordx4 a[44:47], v2, s[8:11], s33 offen offset:1024
    ds_read_b128 v[144:147], v8 offset:0
    ds_read_b128 v[148:151], v8 offset:16384
    s_waitcnt vmcnt(48)
    s_waitcnt lgkmcnt(2)
    v_mfma_f32_16x16x32_bf16 v[16:19], a[48:51], v[136:139], v[16:19]
    v_mfma_f32_16x16x32_bf16 v[20:23], a[48:51], v[140:143], v[20:23]
    v_mfma_f32_16x16x32_bf16 v[24:27], a[52:55], v[136:139], v[24:27]
    v_mfma_f32_16x16x32_bf16 v[28:31], a[52:55], v[140:143], v[28:31]
    v_mfma_f32_16x16x32_bf16 v[32:35], a[56:59], v[136:139], v[32:35]
    v_mfma_f32_16x16x32_bf16 v[36:39], a[56:59], v[140:143], v[36:39]
    v_mfma_f32_16x16x32_bf16 v[40:43], a[60:63], v[136:139], v[40:43]
    v_mfma_f32_16x16x32_bf16 v[44:47], a[60:63], v[140:143], v[44:47]
    v_mfma_f32_16x16x32_bf16 v[48:51], v[136:139], a[64:67], v[48:51]
    v_mfma_f32_16x16x32_bf16 v[52:55], v[140:143], a[64:67], v[52:55]
    v_mfma_f32_16x16x32_bf16 v[56:59], v[136:139], a[68:71], v[56:59]
    v_mfma_f32_16x16x32_bf16 v[60:63], v[140:143], a[68:71], v[60:63]
    s_add_u32 s33, s31, 0x10800
    buffer_load_dwordx4 a[48:51], v2, s[8:11], s33 offen offset:0
    buffer_load_dwordx4 a[52:55], v2, s[8:11], s33 offen offset:1024
    buffer_load_dwordx4 a[56:59], v2, s[8:11], s33 offen offset:2048
    buffer_load_dwordx4 a[60:63], v2, s[8:11], s33 offen offset:3072
    s_add_u32 s33, s31, 0x11800
    buffer_load_dwordx4 a[64:67], v2, s[8:11], s33 offen offset:0
    buffer_load_dwordx4 a[68:71], v2, s[8:11], s33 offen offset:1024
    ds_read_b128 v[136:139], v5 offset:256
    ds_read_b128 v[140:143], v5 offset:16640
    s_waitcnt vmcnt(48)
    s_waitcnt lgkmcnt(2)
    v_mfma_f32_16x16x32_bf16 v[16:19], a[72:75], v[144:147], v[16:19]
    v_mfma_f32_16x16x32_bf16 v[20:23], a[72:75], v[148:151], v[20:23]
    v_mfma_f32_16x16x32_bf16 v[24:27], a[76:79], v[144:147], v[24:27]
    v_mfma_f32_16x16x32_bf16 v[28:31], a[76:79], v[148:151], v[28:31]
    v_mfma_f32_16x16x32_bf16 v[32:35], a[80:83], v[144:147], v[32:35]
    v_mfma_f32_16x16x32_bf16 v[36:39], a[80:83], v[148:151], v[36:39]
    v_mfma_f32_16x16x32_bf16 v[40:43], a[84:87], v[144:147], v[40:43]
    v_mfma_f32_16x16x32_bf16 v[44:47], a[84:87], v[148:151], v[44:47]
    v_mfma_f32_16x16x32_bf16 v[48:51], v[144:147], a[88:91], v[48:51]
    v_mfma_f32_16x16x32_bf16 v[52:55], v[148:151], a[88:91], v[52:55]
    v_mfma_f32_16x16x32_bf16 v[56:59], v[144:147], a[92:95], v[56:59]
    v_mfma_f32_16x16x32_bf16 v[60:63], v[148:151], a[92:95], v[60:63]
    s_add_u32 s33, s31, 0x12000
    buffer_load_dwordx4 a[72:75], v2, s[8:11], s33 offen offset:0
    buffer_load_dwordx4 a[76:79], v2, s[8:11], s33 offen offset:1024
    buffer_load_dwordx4 a[80:83], v2, s[8:11], s33 offen offset:2048
    buffer_load_dwordx4 a[84:87], v2, s[8:11], s33 offen offset:3072
    s_add_u32 s33, s31, 0x13000
    buffer_load_dwordx4 a[88:91], v2, s[8:11], s33 offen offset:0
    buffer_load_dwordx4 a[92:95], v2, s[8:11], s33 offen offset:1024
    ds_read_b128 v[144:147], v6 offset:256
    ds_read_b128 v[148:151], v6 offset:16640
    s_waitcnt vmcnt(48)
    s_waitcnt lgkmcnt(2)
    v_mfma_f32_16x16x32_bf16 v[16:19], a[96:99], v[136:139], v[16:19]
    v_mfma_f32_16x16x32_bf16 v[20:23], a[96:99], v[140:143], v[20:23]
    v_mfma_f32_16x16x32_bf16 v[24:27], a[100:103], v[136:139], v[24:27]
    v_mfma_f32_16x16x32_bf16 v[28:31], a[100:103], v[140:143], v[28:31]
    v_mfma_f32_16x16x32_bf16 v[32:35], a[104:107], v[136:139], v[32:35]
    v_mfma_f32_16x16x32_bf16 v[36:39], a[104:107], v[140:143], v[36:39]
    v_mfma_f32_16x16x32_bf16 v[40:43], a[108:111], v[136:139], v[40:43]
    v_mfma_f32_16x16x32_bf16 v[44:47], a[108:111], v[140:143], v[44:47]
    v_mfma_f32_16x16x32_bf16 v[48:51], v[136:139], a[112:115], v[48:51]
    v_mfma_f32_16x16x32_bf16 v[52:55], v[140:143], a[112:115], v[52:55]
    v_mfma_f32_16x16x32_bf16 v[56:59], v[136:139], a[116:119], v[56:59]
    v_mfma_f32_16x16x32_bf16 v[60:63], v[140:143], a[116:119], v[60:63]
    s_add_u32 s33, s31, 0x13800
    buffer_load_dwordx4 a[96:99], v2, s[8:11], s33 offen offset:0
    buffer_load_dwordx4 a[100:103], v2, s[8:11], s33 offen offset:1024
    buffer_load_dwordx4 a[104:107], v2, s[8:11], s33 offen offset:2048
    buffer_load_dwordx4 a[108:111], v2, s[8:11], s33 offen offset:3072
    s_add_u32 s33, s31, 0x14800
    buffer_load_dwordx4 a[112:115], v2, s[8:11], s33 offen offset:0
    buffer_load_dwordx4 a[116:119], v2, s[8:11], s33 offen offset:1024
    ds_read_b128 v[136:139], v7 offset:256
    ds_read_b128 v[140:143], v7 offset:16640
    s_waitcnt vmcnt(48)
    s_waitcnt lgkmcnt(2)
    v_mfma_f32_16x16x32_bf16 v[16:19], a[120:123], v[144:147], v[16:19]
    v_mfma_f32_16x16x32_bf16 v[20:23], a[120:123], v[148:151], v[20:23]
    v_mfma_f32_16x16x32_bf16 v[24:27], a[124:127], v[144:147], v[24:27]
    v_mfma_f32_16x16x32_bf16 v[28:31], a[124:127], v[148:151], v[28:31]
    v_mfma_f32_16x16x32_bf16 v[32:35], a[128:131], v[144:147], v[32:35]
    v_mfma_f32_16x16x32_bf16 v[36:39], a[128:131], v[148:151], v[36:39]
    v_mfma_f32_16x16x32_bf16 v[40:43], a[132:135], v[144:147], v[40:43]
    v_mfma_f32_16x16x32_bf16 v[44:47], a[132:135], v[148:151], v[44:47]
    v_mfma_f32_16x16x32_bf16 v[48:51], v[144:147], a[136:139], v[48:51]
    v_mfma_f32_16x16x32_bf16 v[52:55], v[148:151], a[136:139], v[52:55]
    v_mfma_f32_16x16x32_bf16 v[56:59], v[144:147], a[140:143], v[56:59]
    v_mfma_f32_16x16x32_bf16 v[60:63], v[148:151], a[140:143], v[60:63]
    ds_read_b128 v[144:147], v8 offset:256
    ds_read_b128 v[148:151], v8 offset:16640
    s_waitcnt vmcnt(42)
    s_waitcnt lgkmcnt(2)
    v_mfma_f32_16x16x32_bf16 v[16:19], a[144:147], v[136:139], v[16:19]
    v_mfma_f32_16x16x32_bf16 v[20:23], a[144:147], v[140:143], v[20:23]
    v_mfma_f32_16x16x32_bf16 v[24:27], a[148:151], v[136:139], v[24:27]
    v_mfma_f32_16x16x32_bf16 v[28:31], a[148:151], v[140:143], v[28:31]
    v_mfma_f32_16x16x32_bf16 v[32:35], a[152:155], v[136:139], v[32:35]
    v_mfma_f32_16x16x32_bf16 v[36:39], a[152:155], v[140:143], v[36:39]
    v_mfma_f32_16x16x32_bf16 v[40:43], a[156:159], v[136:139], v[40:43]
    v_mfma_f32_16x16x32_bf16 v[44:47], a[156:159], v[140:143], v[44:47]
    v_mfma_f32_16x16x32_bf16 v[48:51], v[136:139], a[160:163], v[48:51]
    v_mfma_f32_16x16x32_bf16 v[52:55], v[140:143], a[160:163], v[52:55]
    v_mfma_f32_16x16x32_bf16 v[56:59], v[136:139], a[164:167], v[56:59]
    v_mfma_f32_16x16x32_bf16 v[60:63], v[140:143], a[164:167], v[60:63]
    ds_read_b128 v[136:139], v5 offset:512
    ds_read_b128 v[140:143], v5 offset:16896
    s_waitcnt vmcnt(36)
    s_waitcnt lgkmcnt(2)
    v_mfma_f32_16x16x32_bf16 v[16:19], a[168:171], v[144:147], v[16:19]
    v_mfma_f32_16x16x32_bf16 v[20:23], a[168:171], v[148:151], v[20:23]
    v_mfma_f32_16x16x32_bf16 v[24:27], a[172:175], v[144:147], v[24:27]
    v_mfma_f32_16x16x32_bf16 v[28:31], a[172:175], v[148:151], v[28:31]
    v_mfma_f32_16x16x32_bf16 v[32:35], a[176:179], v[144:147], v[32:35]
    v_mfma_f32_16x16x32_bf16 v[36:39], a[176:179], v[148:151], v[36:39]
    v_mfma_f32_16x16x32_bf16 v[40:43], a[180:183], v[144:147], v[40:43]
    v_mfma_f32_16x16x32_bf16 v[44:47], a[180:183], v[148:151], v[44:47]
    v_mfma_f32_16x16x32_bf16 v[48:51], v[144:147], a[184:187], v[48:51]
    v_mfma_f32_16x16x32_bf16 v[52:55], v[148:151], a[184:187], v[52:55]
    v_mfma_f32_16x16x32_bf16 v[56:59], v[144:147], a[188:191], v[56:59]
    v_mfma_f32_16x16x32_bf16 v[60:63], v[148:151], a[188:191], v[60:63]
    ds_read_b128 v[144:147], v6 offset:512
    ds_read_b128 v[148:151], v6 offset:16896
    s_waitcnt vmcnt(30)
    s_waitcnt lgkmcnt(2)
    v_mfma_f32_16x16x32_bf16 v[16:19], a[192:195], v[136:139], v[16:19]
    v_mfma_f32_16x16x32_bf16 v[20:23], a[192:195], v[140:143], v[20:23]
    v_mfma_f32_16x16x32_bf16 v[24:27], a[196:199], v[136:139], v[24:27]
    v_mfma_f32_16x16x32_bf16 v[28:31], a[196:199], v[140:143], v[28:31]
    v_mfma_f32_16x16x32_bf16 v[32:35], a[200:203], v[136:139], v[32:35]
    v_mfma_f32_16x16x32_bf16 v[36:39], a[200:203], v[140:143], v[36:39]
    v_mfma_f32_16x16x32_bf16 v[40:43], a[204:207], v[136:139], v[40:43]
    v_mfma_f32_16x16x32_bf16 v[44:47], a[204:207], v[140:143], v[44:47]
    v_mfma_f32_16x16x32_bf16 v[48:51], v[136:139], a[208:211], v[48:51]
    v_mfma_f32_16x16x32_bf16 v[52:55], v[140:143], a[208:211], v[52:55]
    v_mfma_f32_16x16x32_bf16 v[56:59], v[136:139], a[212:215], v[56:59]
    v_mfma_f32_16x16x32_bf16 v[60:63], v[140:143], a[212:215], v[60:63]
    ds_read_b128 v[136:139], v7 offset:512
    ds_read_b128 v[140:143], v7 offset:16896
    s_waitcnt vmcnt(24)
    s_waitcnt lgkmcnt(2)
    v_mfma_f32_16x16x32_bf16 v[16:19], a[0:3], v[144:147], v[16:19]
    v_mfma_f32_16x16x32_bf16 v[20:23], a[0:3], v[148:151], v[20:23]
    v_mfma_f32_16x16x32_bf16 v[24:27], a[4:7], v[144:147], v[24:27]
    v_mfma_f32_16x16x32_bf16 v[28:31], a[4:7], v[148:151], v[28:31]
    v_mfma_f32_16x16x32_bf16 v[32:35], a[8:11], v[144:147], v[32:35]
    v_mfma_f32_16x16x32_bf16 v[36:39], a[8:11], v[148:151], v[36:39]
    v_mfma_f32_16x16x32_bf16 v[40:43], a[12:15], v[144:147], v[40:43]
    v_mfma_f32_16x16x32_bf16 v[44:47], a[12:15], v[148:151], v[44:47]
    v_mfma_f32_16x16x32_bf16 v[48:51], v[144:147], a[16:19], v[48:51]
    v_mfma_f32_16x16x32_bf16 v[52:55], v[148:151], a[16:19], v[52:55]
    v_mfma_f32_16x16x32_bf16 v[56:59], v[144:147], a[20:23], v[56:59]
    v_mfma_f32_16x16x32_bf16 v[60:63], v[148:151], a[20:23], v[60:63]
    ds_read_b128 v[144:147], v8 offset:512
    ds_read_b128 v[148:151], v8 offset:16896
    s_waitcnt vmcnt(18)
    s_waitcnt lgkmcnt(2)
    v_mfma_f32_16x16x32_bf16 v[16:19], a[24:27], v[136:139], v[16:19]
    v_mfma_f32_16x16x32_bf16 v[20:23], a[24:27], v[140:143], v[20:23]
    v_mfma_f32_16x16x32_bf16 v[24:27], a[28:31], v[136:139], v[24:27]
    v_mfma_f32_16x16x32_bf16 v[28:31], a[28:31], v[140:143], v[28:31]
    v_mfma_f32_16x16x32_bf16 v[32:35], a[32:35], v[136:139], v[32:35]
    v_mfma_f32_16x16x32_bf16 v[36:39], a[32:35], v[140:143], v[36:39]
    v_mfma_f32_16x16x32_bf16 v[40:43], a[36:39], v[136:139], v[40:43]
    v_mfma_f32_16x16x32_bf16 v[44:47], a[36:39], v[140:143], v[44:47]
    v_mfma_f32_16x16x32_bf16 v[48:51], v[136:139], a[40:43], v[48:51]
    v_mfma_f32_16x16x32_bf16 v[52:55], v[140:143], a[40:43], v[52:55]
    v_mfma_f32_16x16x32_bf16 v[56:59], v[136:139], a[44:47], v[56:59]
    v_mfma_f32_16x16x32_bf16 v[60:63], v[140:143], a[44:47], v[60:63]
    ds_read_b128 v[136:139], v5 offset:768
    ds_read_b128 v[140:143], v5 offset:17152
    s_waitcnt vmcnt(12)
    s_waitcnt lgkmcnt(2)
    v_mfma_f32_16x16x32_bf16 v[16:19], a[48:51], v[144:147], v[16:19]
    v_mfma_f32_16x16x32_bf16 v[20:23], a[48:51], v[148:151], v[20:23]
    v_mfma_f32_16x16x32_bf16 v[24:27], a[52:55], v[144:147], v[24:27]
    v_mfma_f32_16x16x32_bf16 v[28:31], a[52:55], v[148:151], v[28:31]
    v_mfma_f32_16x16x32_bf16 v[32:35], a[56:59], v[144:147], v[32:35]
    v_mfma_f32_16x16x32_bf16 v[36:39], a[56:59], v[148:151], v[36:39]
    v_mfma_f32_16x16x32_bf16 v[40:43], a[60:63], v[144:147], v[40:43]
    v_mfma_f32_16x16x32_bf16 v[44:47], a[60:63], v[148:151], v[44:47]
    v_mfma_f32_16x16x32_bf16 v[48:51], v[144:147], a[64:67], v[48:51]
    v_mfma_f32_16x16x32_bf16 v[52:55], v[148:151], a[64:67], v[52:55]
    v_mfma_f32_16x16x32_bf16 v[56:59], v[144:147], a[68:71], v[56:59]
    v_mfma_f32_16x16x32_bf16 v[60:63], v[148:151], a[68:71], v[60:63]
    ds_read_b128 v[144:147], v6 offset:768
    ds_read_b128 v[148:151], v6 offset:17152
    s_waitcnt vmcnt(6)
    s_waitcnt lgkmcnt(2)
    v_mfma_f32_16x16x32_bf16 v[16:19], a[72:75], v[136:139], v[16:19]
    v_mfma_f32_16x16x32_bf16 v[20:23], a[72:75], v[140:143], v[20:23]
    v_mfma_f32_16x16x32_bf16 v[24:27], a[76:79], v[136:139], v[24:27]
    v_mfma_f32_16x16x32_bf16 v[28:31], a[76:79], v[140:143], v[28:31]
    v_mfma_f32_16x16x32_bf16 v[32:35], a[80:83], v[136:139], v[32:35]
    v_mfma_f32_16x16x32_bf16 v[36:39], a[80:83], v[140:143], v[36:39]
    v_mfma_f32_16x16x32_bf16 v[40:43], a[84:87], v[136:139], v[40:43]
    v_mfma_f32_16x16x32_bf16 v[44:47], a[84:87], v[140:143], v[44:47]
    v_mfma_f32_16x16x32_bf16 v[48:51], v[136:139], a[88:91], v[48:51]
    v_mfma_f32_16x16x32_bf16 v[52:55], v[140:143], a[88:91], v[52:55]
    v_mfma_f32_16x16x32_bf16 v[56:59], v[136:139], a[92:95], v[56:59]
    v_mfma_f32_16x16x32_bf16 v[60:63], v[140:143], a[92:95], v[60:63]
    s_waitcnt vmcnt(0)
    s_waitcnt lgkmcnt(0)
    v_mfma_f32_16x16x32_bf16 v[16:19], a[96:99], v[144:147], v[16:19]
    v_mfma_f32_16x16x32_bf16 v[20:23], a[96:99], v[148:151], v[20:23]
    v_mfma_f32_16x16x32_bf16 v[24:27], a[100:103], v[144:147], v[24:27]
    v_mfma_f32_16x16x32_bf16 v[28:31], a[100:103], v[148:151], v[28:31]
    v_mfma_f32_16x16x32_bf16 v[32:35], a[104:107], v[144:147], v[32:35]
    v_mfma_f32_16x16x32_bf16 v[36:39], a[104:107], v[148:151], v[36:39]
    v_mfma_f32_16x16x32_bf16 v[40:43], a[108:111], v[144:147], v[40:43]
    v_mfma_f32_16x16x32_bf16 v[44:47], a[108:111], v[148:151], v[44:47]
    v_mfma_f32_16x16x32_bf16 v[48:51], v[144:147], a[112:115], v[48:51]
    v_mfma_f32_16x16x32_bf16 v[52:55], v[148:151], a[112:115], v[52:55]
    v_mfma_f32_16x16x32_bf16 v[56:59], v[144:147], a[116:119], v[56:59]
    v_mfma_f32_16x16x32_bf16 v[60:63], v[148:151], a[116:119], v[60:63]
    s_mov_b32 s36, 0
    s_mov_b32 s37, 0xffff0000
    s_mov_b32 s38, 0xf000f000
    s_mov_b32 s39, 0xf000f000
    s_mov_b32 s40, 0x10001000
    s_mov_b32 s41, 0x10001000
    s_mov_b32 s42, 0x3fb8aa3b
    s_nop 7
    s_nop 3
    v_cvt_pk_bf16_f32 v64, v16, v17
    v_cvt_pk_bf16_f32 v65, v18, v19
    v_cvt_pk_bf16_f32 v66, v24, v25
    v_cvt_pk_bf16_f32 v67, v26, v27
    v_cvt_pk_bf16_f32 v68, v20, v21
    v_cvt_pk_bf16_f32 v69, v22, v23
    v_cvt_pk_bf16_f32 v70, v28, v29
    v_cvt_pk_bf16_f32 v71, v30, v31
    v_cvt_pk_bf16_f32 v72, v32, v33
    v_cvt_pk_bf16_f32 v73, v34, v35
    v_cvt_pk_bf16_f32 v74, v40, v41
    v_cvt_pk_bf16_f32 v75, v42, v43
    v_cvt_pk_bf16_f32 v76, v36, v37
    v_cvt_pk_bf16_f32 v77, v38, v39
    v_cvt_pk_bf16_f32 v78, v44, v45
    v_cvt_pk_bf16_f32 v79, v46, v47
    s_nop 1
    v_mfma_f32_16x16x32_bf16 v[80:83], v[152:155], v[64:67], 0
    v_mfma_f32_16x16x32_bf16 v[84:87], v[156:159], v[64:67], 0
    v_mfma_f32_16x16x32_bf16 v[88:91], v[152:155], v[68:71], 0
    v_mfma_f32_16x16x32_bf16 v[92:95], v[156:159], v[68:71], 0
    v_mfma_f32_16x16x32_bf16 v[96:99], v[72:75], v[152:155], 0
    v_mfma_f32_16x16x32_bf16 v[100:103], v[72:75], v[156:159], 0
    v_mfma_f32_16x16x32_bf16 v[104:107], v[76:79], v[152:155], 0
    v_mfma_f32_16x16x32_bf16 v[108:111], v[76:79], v[156:159], 0
    s_nop 7
    s_nop 3
    v_cvt_pk_bf16_f32 v112, v80, v81
    v_lshlrev_b32 v80, 16, v112
    v_and_b32 v81, 0xffff0000, v112
    v_cvt_pk_bf16_f32 v112, v82, v83
    v_lshlrev_b32 v82, 16, v112
    v_and_b32 v83, 0xffff0000, v112
    v_cvt_pk_bf16_f32 v112, v84, v85
    v_lshlrev_b32 v84, 16, v112
    v_and_b32 v85, 0xffff0000, v112
    v_cvt_pk_bf16_f32 v112, v86, v87
    v_lshlrev_b32 v86, 16, v112
    v_and_b32 v87, 0xffff0000, v112
    v_cvt_pk_bf16_f32 v112, v88, v89
    v_lshlrev_b32 v88, 16, v112
    v_and_b32 v89, 0xffff0000, v112
    v_cvt_pk_bf16_f32 v112, v90, v91
    v_lshlrev_b32 v90, 16, v112
    v_and_b32 v91, 0xffff0000, v112
    v_cvt_pk_bf16_f32 v112, v92, v93
    v_lshlrev_b32 v92, 16, v112
    v_and_b32 v93, 0xffff0000, v112
    v_cvt_pk_bf16_f32 v112, v94, v95
    v_lshlrev_b32 v94, 16, v112
    v_and_b32 v95, 0xffff0000, v112
    v_cvt_pk_bf16_f32 v112, v96, v97
    v_lshlrev_b32 v96, 16, v112
    v_and_b32 v97, 0xffff0000, v112
    v_cvt_pk_bf16_f32 v112, v98, v99
    v_lshlrev_b32 v98, 16, v112
    v_and_b32 v99, 0xffff0000, v112
    v_cvt_pk_bf16_f32 v112, v100, v101
    v_lshlrev_b32 v100, 16, v112
    v_and_b32 v101, 0xffff0000, v112
    v_cvt_pk_bf16_f32 v112, v102, v103
    v_lshlrev_b32 v102, 16, v112
    v_and_b32 v103, 0xffff0000, v112
    v_cvt_pk_bf16_f32 v112, v104, v105
    v_lshlrev_b32 v104, 16, v112
    v_and_b32 v105, 0xffff0000, v112
    v_cvt_pk_bf16_f32 v112, v106, v107
    v_lshlrev_b32 v106, 16, v112
    v_and_b32 v107, 0xffff0000, v112
    v_cvt_pk_bf16_f32 v112, v108, v109
    v_lshlrev_b32 v108, 16, v112
    v_and_b32 v109, 0xffff0000, v112
    v_cvt_pk_bf16_f32 v112, v110, v111
    v_lshlrev_b32 v110, 16, v112
    v_and_b32 v111, 0xffff0000, v112
    v_cndmask_b32_e64 v84, v84, v80, s[36:37]
    v_cndmask_b32_e64 v85, v85, v81, s[36:37]
    v_cndmask_b32_e64 v86, v86, v82, s[36:37]
    v_cndmask_b32_e64 v87, v87, v83, s[36:37]
    v_max3_f32 v112, v80, v81, v82
    v_max3_f32 v112, v112, v83, v84
    v_max3_f32 v112, v112, v85, v86
    v_max_f32 v112, v112, v87
    v_min3_f32 v113, v80, v81, v82
    v_min3_f32 v113, v113, v83, v84
    v_min3_f32 v113, v113, v85, v86
    v_min_f32 v113, v113, v87
    v_mov_b32 v114, v112
    s_nop 1
    v_permlane16_swap_b32 v112, v114
    v_max_f32 v112, v112, v114
    v_mov_b32 v114, v112
    s_nop 1
    v_permlane32_swap_b32 v112, v114
    v_max_f32 v112, v112, v114
    v_mov_b32 v114, v113
    s_nop 1
    v_permlane16_swap_b32 v113, v114
    v_min_f32 v113, v113, v114
    v_mov_b32 v114, v113
    s_nop 1
    v_permlane32_swap_b32 v113, v114
    v_min_f32 v113, v113, v114
    v_mul_f32 v112, s42, v112
    v_mul_f32 v113, s42, v113
    v_fma_f32 v116, v80, s42, -v112
    v_fma_f32 v80, -v80, s42, v113
    v_fma_f32 v117, v81, s42, -v112
    v_fma_f32 v81, -v81, s42, v113
    v_fma_f32 v118, v82, s42, -v112
    v_fma_f32 v82, -v82, s42, v113
    v_fma_f32 v119, v83, s42, -v112
    v_fma_f32 v83, -v83, s42, v113
    v_fma_f32 v120, v84, s42, -v112
    v_fma_f32 v84, -v84, s42, v113
    v_fma_f32 v121, v85, s42, -v112
    v_fma_f32 v85, -v85, s42, v113
    v_fma_f32 v122, v86, s42, -v112
    v_fma_f32 v86, -v86, s42, v113
    v_fma_f32 v123, v87, s42, -v112
    v_fma_f32 v87, -v87, s42, v113
    v_exp_f32 v116, v116
    v_exp_f32 v80, v80
    v_exp_f32 v117, v117
    v_exp_f32 v81, v81
    v_exp_f32 v118, v118
    v_exp_f32 v82, v82
    v_exp_f32 v119, v119
    v_exp_f32 v83, v83
    v_exp_f32 v120, v120
    v_exp_f32 v84, v84
    v_exp_f32 v121, v121
    v_exp_f32 v85, v85
    v_exp_f32 v122, v122
    v_exp_f32 v86, v86
    v_exp_f32 v123, v123
    v_exp_f32 v87, v87
    s_nop 0
    v_cndmask_b32_e64 v120, v120, 0, s[36:37]
    v_cndmask_b32_e64 v84, v84, 0, s[36:37]
    v_cndmask_b32_e64 v121, v121, 0, s[36:37]
    v_cndmask_b32_e64 v85, v85, 0, s[36:37]
    v_cndmask_b32_e64 v122, v122, 0, s[36:37]
    v_cndmask_b32_e64 v86, v86, 0, s[36:37]
    v_cndmask_b32_e64 v123, v123, 0, s[36:37]
    v_cndmask_b32_e64 v87, v87, 0, s[36:37]
    v_add_f32 v112, v116, v117
    v_add_f32 v113, v80, v81
    v_add_f32 v112, v112, v118
    v_add_f32 v113, v113, v82
    v_add_f32 v112, v112, v119
    v_add_f32 v113, v113, v83
    v_add_f32 v112, v112, v120
    v_add_f32 v113, v113, v84
    v_add_f32 v112, v112, v121
    v_add_f32 v113, v113, v85
    v_add_f32 v112, v112, v122
    v_add_f32 v113, v113, v86
    v_add_f32 v112, v112, v123
    v_add_f32 v113, v113, v87
    v_mov_b32 v114, v112
    s_nop 1
    v_permlane16_swap_b32 v112, v114
    v_add_f32 v112, v112, v114
    v_mov_b32 v114, v112
    s_nop 1
    v_permlane32_swap_b32 v112, v114
    v_add_f32 v112, v112, v114
    v_mov_b32 v114, v113
    s_nop 1
    v_permlane16_swap_b32 v113, v114
    v_add_f32 v113, v113, v114
    v_mov_b32 v114, v113
    s_nop 1
    v_permlane32_swap_b32 v113, v114
    v_add_f32 v113, v113, v114
    v_rcp_f32 v112, v112
    v_rcp_f32 v113, v113
    s_nop 0
    v_mul_f32 v116, v116, v112
    v_mul_f32 v80, v80, v113
    v_mul_f32 v117, v117, v112
    v_mul_f32 v81, v81, v113
    v_mul_f32 v118, v118, v112
    v_mul_f32 v82, v82, v113
    v_mul_f32 v119, v119, v112
    v_mul_f32 v83, v83, v113
    v_mul_f32 v120, v120, v112
    v_mul_f32 v84, v84, v113
    v_mul_f32 v121, v121, v112
    v_mul_f32 v85, v85, v113
    v_mul_f32 v122, v122, v112
    v_mul_f32 v86, v86, v113
    v_mul_f32 v123, v123, v112
    v_mul_f32 v87, v87, v113
    v_cvt_pk_bf16_f32 v124, v116, v117
    v_cvt_pk_bf16_f32 v125, v118, v119
    v_cvt_pk_bf16_f32 v126, v120, v121
    v_cvt_pk_bf16_f32 v127, v122, v123
    v_cvt_pk_bf16_f32 v128, v80, v81
    v_cvt_pk_bf16_f32 v129, v82, v83
    v_cvt_pk_bf16_f32 v130, v84, v85
    v_cvt_pk_bf16_f32 v131, v86, v87
    s_lshl_b32 s43, s28, 5
    s_add_u32 s43, s43, 0
    s_add_u32 s43, s43, s29
    s_lshl_b32 s43, s43, 11
    buffer_store_dwordx4 v[124:127], v2, s[16:19], s43 offen
    buffer_store_dwordx4 v[128:131], v2, s[16:19], s43 offen offset:1024
    s_nop 1
    v_cndmask_b32_e64 v92, v92, v88, s[36:37]
    v_cndmask_b32_e64 v93, v93, v89, s[36:37]
    v_cndmask_b32_e64 v94, v94, v90, s[36:37]
    v_cndmask_b32_e64 v95, v95, v91, s[36:37]
    v_max3_f32 v112, v88, v89, v90
    v_max3_f32 v112, v112, v91, v92
    v_max3_f32 v112, v112, v93, v94
    v_max_f32 v112, v112, v95
    v_min3_f32 v113, v88, v89, v90
    v_min3_f32 v113, v113, v91, v92
    v_min3_f32 v113, v113, v93, v94
    v_min_f32 v113, v113, v95
    v_mov_b32 v114, v112
    s_nop 1
    v_permlane16_swap_b32 v112, v114
    v_max_f32 v112, v112, v114
    v_mov_b32 v114, v112
    s_nop 1
    v_permlane32_swap_b32 v112, v114
    v_max_f32 v112, v112, v114
    v_mov_b32 v114, v113
    s_nop 1
    v_permlane16_swap_b32 v113, v114
    v_min_f32 v113, v113, v114
    v_mov_b32 v114, v113
    s_nop 1
    v_permlane32_swap_b32 v113, v114
    v_min_f32 v113, v113, v114
    v_mul_f32 v112, s42, v112
    v_mul_f32 v113, s42, v113
    v_fma_f32 v116, v88, s42, -v112
    v_fma_f32 v88, -v88, s42, v113
    v_fma_f32 v117, v89, s42, -v112
    v_fma_f32 v89, -v89, s42, v113
    v_fma_f32 v118, v90, s42, -v112
    v_fma_f32 v90, -v90, s42, v113
    v_fma_f32 v119, v91, s42, -v112
    v_fma_f32 v91, -v91, s42, v113
    v_fma_f32 v120, v92, s42, -v112
    v_fma_f32 v92, -v92, s42, v113
    v_fma_f32 v121, v93, s42, -v112
    v_fma_f32 v93, -v93, s42, v113
    v_fma_f32 v122, v94, s42, -v112
    v_fma_f32 v94, -v94, s42, v113
    v_fma_f32 v123, v95, s42, -v112
    v_fma_f32 v95, -v95, s42, v113
    v_exp_f32 v116, v116
    v_exp_f32 v88, v88
    v_exp_f32 v117, v117
    v_exp_f32 v89, v89
    v_exp_f32 v118, v118
    v_exp_f32 v90, v90
    v_exp_f32 v119, v119
    v_exp_f32 v91, v91
    v_exp_f32 v120, v120
    v_exp_f32 v92, v92
    v_exp_f32 v121, v121
    v_exp_f32 v93, v93
    v_exp_f32 v122, v122
    v_exp_f32 v94, v94
    v_exp_f32 v123, v123
    v_exp_f32 v95, v95
    s_nop 0
    v_cndmask_b32_e64 v120, v120, 0, s[36:37]
    v_cndmask_b32_e64 v92, v92, 0, s[36:37]
    v_cndmask_b32_e64 v121, v121, 0, s[36:37]
    v_cndmask_b32_e64 v93, v93, 0, s[36:37]
    v_cndmask_b32_e64 v122, v122, 0, s[36:37]
    v_cndmask_b32_e64 v94, v94, 0, s[36:37]
    v_cndmask_b32_e64 v123, v123, 0, s[36:37]
    v_cndmask_b32_e64 v95, v95, 0, s[36:37]
    v_add_f32 v112, v116, v117
    v_add_f32 v113, v88, v89
    v_add_f32 v112, v112, v118
    v_add_f32 v113, v113, v90
    v_add_f32 v112, v112, v119
    v_add_f32 v113, v113, v91
    v_add_f32 v112, v112, v120
    v_add_f32 v113, v113, v92
    v_add_f32 v112, v112, v121
    v_add_f32 v113, v113, v93
    v_add_f32 v112, v112, v122
    v_add_f32 v113, v113, v94
    v_add_f32 v112, v112, v123
    v_add_f32 v113, v113, v95
    v_mov_b32 v114, v112
    s_nop 1
    v_permlane16_swap_b32 v112, v114
    v_add_f32 v112, v112, v114
    v_mov_b32 v114, v112
    s_nop 1
    v_permlane32_swap_b32 v112, v114
    v_add_f32 v112, v112, v114
    v_mov_b32 v114, v113
    s_nop 1
    v_permlane16_swap_b32 v113, v114
    v_add_f32 v113, v113, v114
    v_mov_b32 v114, v113
    s_nop 1
    v_permlane32_swap_b32 v113, v114
    v_add_f32 v113, v113, v114
    v_rcp_f32 v112, v112
    v_rcp_f32 v113, v113
    s_nop 0
    v_mul_f32 v116, v116, v112
    v_mul_f32 v88, v88, v113
    v_mul_f32 v117, v117, v112
    v_mul_f32 v89, v89, v113
    v_mul_f32 v118, v118, v112
    v_mul_f32 v90, v90, v113
    v_mul_f32 v119, v119, v112
    v_mul_f32 v91, v91, v113
    v_mul_f32 v120, v120, v112
    v_mul_f32 v92, v92, v113
    v_mul_f32 v121, v121, v112
    v_mul_f32 v93, v93, v113
    v_mul_f32 v122, v122, v112
    v_mul_f32 v94, v94, v113
    v_mul_f32 v123, v123, v112
    v_mul_f32 v95, v95, v113
    v_cvt_pk_bf16_f32 v124, v116, v117
    v_cvt_pk_bf16_f32 v125, v118, v119
    v_cvt_pk_bf16_f32 v126, v120, v121
    v_cvt_pk_bf16_f32 v127, v122, v123
    v_cvt_pk_bf16_f32 v128, v88, v89
    v_cvt_pk_bf16_f32 v129, v90, v91
    v_cvt_pk_bf16_f32 v130, v92, v93
    v_cvt_pk_bf16_f32 v131, v94, v95
    s_lshl_b32 s43, s28, 5
    s_add_u32 s43, s43, 16
    s_add_u32 s43, s43, s29
    s_lshl_b32 s43, s43, 11
    buffer_store_dwordx4 v[124:127], v2, s[16:19], s43 offen
    buffer_store_dwordx4 v[128:131], v2, s[16:19], s43 offen offset:1024
    s_nop 1
    v_cndmask_b32_e64 v100, v100, v96, s[38:39]
    v_cndmask_b32_e64 v101, v101, v97, s[38:39]
    v_cndmask_b32_e64 v102, v102, v98, s[38:39]
    v_cndmask_b32_e64 v103, v103, v99, s[38:39]
    v_max_f32 v112, v96, v100
    v_min_f32 v116, v96, v100
    v_max_f32 v113, v97, v101
    v_min_f32 v117, v97, v101
    v_max_f32 v114, v98, v102
    v_min_f32 v118, v98, v102
    v_max_f32 v115, v99, v103
    v_min_f32 v119, v99, v103
    s_nop 0
    v_max_f32_dpp v112, v112, v112 row_ror:8 row_mask:0xf bank_mask:0xf
    v_min_f32_dpp v116, v116, v116 row_ror:8 row_mask:0xf bank_mask:0xf
    v_max_f32_dpp v113, v113, v113 row_ror:8 row_mask:0xf bank_mask:0xf
    v_min_f32_dpp v117, v117, v117 row_ror:8 row_mask:0xf bank_mask:0xf
    v_max_f32_dpp v114, v114, v114 row_ror:8 row_mask:0xf bank_mask:0xf
    v_min_f32_dpp v118, v118, v118 row_ror:8 row_mask:0xf bank_mask:0xf
    v_max_f32_dpp v115, v115, v115 row_ror:8 row_mask:0xf bank_mask:0xf
    v_min_f32_dpp v119, v119, v119 row_ror:8 row_mask:0xf bank_mask:0xf
    v_max_f32_dpp v112, v112, v112 row_ror:4 row_mask:0xf bank_mask:0xf
    v_min_f32_dpp v116, v116, v116 row_ror:4 row_mask:0xf bank_mask:0xf
    v_max_f32_dpp v113, v113, v113 row_ror:4 row_mask:0xf bank_mask:0xf
    v_min_f32_dpp v117, v117, v117 row_ror:4 row_mask:0xf bank_mask:0xf
    v_max_f32_dpp v114, v114, v114 row_ror:4 row_mask:0xf bank_mask:0xf
    v_min_f32_dpp v118, v118, v118 row_ror:4 row_mask:0xf bank_mask:0xf
    v_max_f32_dpp v115, v115, v115 row_ror:4 row_mask:0xf bank_mask:0xf
    v_min_f32_dpp v119, v119, v119 row_ror:4 row_mask:0xf bank_mask:0xf
    v_max_f32_dpp v112, v112, v112 row_ror:2 row_mask:0xf bank_mask:0xf
    v_min_f32_dpp v116, v116, v116 row_ror:2 row_mask:0xf bank_mask:0xf
    v_max_f32_dpp v113, v113, v113 row_ror:2 row_mask:0xf bank_mask:0xf
    v_min_f32_dpp v117, v117, v117 row_ror:2 row_mask:0xf bank_mask:0xf
    v_max_f32_dpp v114, v114, v114 row_ror:2 row_mask:0xf bank_mask:0xf
    v_min_f32_dpp v118, v118, v118 row_ror:2 row_mask:0xf bank_mask:0xf
    v_max_f32_dpp v115, v115, v115 row_ror:2 row_mask:0xf bank_mask:0xf
    v_min_f32_dpp v119, v119, v119 row_ror:2 row_mask:0xf bank_mask:0xf
    v_max_f32_dpp v112, v112, v112 row_ror:1 row_mask:0xf bank_mask:0xf
    v_min_f32_dpp v116, v116, v116 row_ror:1 row_mask:0xf bank_mask:0xf
    v_max_f32_dpp v113, v113, v113 row_ror:1 row_mask:0xf bank_mask:0xf
    v_min_f32_dpp v117, v117, v117 row_ror:1 row_mask:0xf bank_mask:0xf
    v_max_f32_dpp v114, v114, v114 row_ror:1 row_mask:0xf bank_mask:0xf
    v_min_f32_dpp v118, v118, v118 row_ror:1 row_mask:0xf bank_mask:0xf
    v_max_f32_dpp v115, v115, v115 row_ror:1 row_mask:0xf bank_mask:0xf
    v_min_f32_dpp v119, v119, v119 row_ror:1 row_mask:0xf bank_mask:0xf
    v_mul_f32 v112, s42, v112
    v_mul_f32 v116, s42, v116
    v_mul_f32 v113, s42, v113
    v_mul_f32 v117, s42, v117
    v_mul_f32 v114, s42, v114
    v_mul_f32 v118, s42, v118
    v_mul_f32 v115, s42, v115
    v_mul_f32 v119, s42, v119
    v_fma_f32 v120, v96, s42, -v112
    v_fma_f32 v96, -v96, s42, v116
    v_fma_f32 v121, v97, s42, -v113
    v_fma_f32 v97, -v97, s42, v117
    v_fma_f32 v122, v98, s42, -v114
    v_fma_f32 v98, -v98, s42, v118
    v_fma_f32 v123, v99, s42, -v115
    v_fma_f32 v99, -v99, s42, v119
    v_fma_f32 v124, v100, s42, -v112
    v_fma_f32 v100, -v100, s42, v116
    v_fma_f32 v125, v101, s42, -v113
    v_fma_f32 v101, -v101, s42, v117
    v_fma_f32 v126, v102, s42, -v114
    v_fma_f32 v102, -v102, s42, v118
    v_fma_f32 v127, v103, s42, -v115
    v_fma_f32 v103, -v103, s42, v119
    v_exp_f32 v120, v120
    v_exp_f32 v96, v96
    v_exp_f32 v121, v121
    v_exp_f32 v97, v97
    v_exp_f32 v122, v122
    v_exp_f32 v98, v98
    v_exp_f32 v123, v123
    v_exp_f32 v99, v99
    v_exp_f32 v124, v124
    v_exp_f32 v100, v100
    v_exp_f32 v125, v125
    v_exp_f32 v101, v101
    v_exp_f32 v126, v126
    v_exp_f32 v102, v102
    v_exp_f32 v127, v127
    v_exp_f32 v103, v103
    s_nop 0
    v_cndmask_b32_e64 v124, v124, 0, s[38:39]
    v_cndmask_b32_e64 v100, v100, 0, s[38:39]
    v_cndmask_b32_e64 v125, v125, 0, s[38:39]
    v_cndmask_b32_e64 v101, v101, 0, s[38:39]
    v_cndmask_b32_e64 v126, v126, 0, s[38:39]
    v_cndmask_b32_e64 v102, v102, 0, s[38:39]
    v_cndmask_b32_e64 v127, v127, 0, s[38:39]
    v_cndmask_b32_e64 v103, v103, 0, s[38:39]
    v_add_f32 v112, v120, v124
    v_add_f32 v116, v96, v100
    v_add_f32 v113, v121, v125
    v_add_f32 v117, v97, v101
    v_add_f32 v114, v122, v126
    v_add_f32 v118, v98, v102
    v_add_f32 v115, v123, v127
    v_add_f32 v119, v99, v103
    s_nop 0
    v_add_f32_dpp v112, v112, v112 row_ror:8 row_mask:0xf bank_mask:0xf
    v_add_f32_dpp v116, v116, v116 row_ror:8 row_mask:0xf bank_mask:0xf
    v_add_f32_dpp v113, v113, v113 row_ror:8 row_mask:0xf bank_mask:0xf
    v_add_f32_dpp v117, v117, v117 row_ror:8 row_mask:0xf bank_mask:0xf
    v_add_f32_dpp v114, v114, v114 row_ror:8 row_mask:0xf bank_mask:0xf
    v_add_f32_dpp v118, v118, v118 row_ror:8 row_mask:0xf bank_mask:0xf
    v_add_f32_dpp v115, v115, v115 row_ror:8 row_mask:0xf bank_mask:0xf
    v_add_f32_dpp v119, v119, v119 row_ror:8 row_mask:0xf bank_mask:0xf
    v_add_f32_dpp v112, v112, v112 row_ror:4 row_mask:0xf bank_mask:0xf
    v_add_f32_dpp v116, v116, v116 row_ror:4 row_mask:0xf bank_mask:0xf
    v_add_f32_dpp v113, v113, v113 row_ror:4 row_mask:0xf bank_mask:0xf
    v_add_f32_dpp v117, v117, v117 row_ror:4 row_mask:0xf bank_mask:0xf
    v_add_f32_dpp v114, v114, v114 row_ror:4 row_mask:0xf bank_mask:0xf
    v_add_f32_dpp v118, v118, v118 row_ror:4 row_mask:0xf bank_mask:0xf
    v_add_f32_dpp v115, v115, v115 row_ror:4 row_mask:0xf bank_mask:0xf
    v_add_f32_dpp v119, v119, v119 row_ror:4 row_mask:0xf bank_mask:0xf
    v_add_f32_dpp v112, v112, v112 row_ror:2 row_mask:0xf bank_mask:0xf
    v_add_f32_dpp v116, v116, v116 row_ror:2 row_mask:0xf bank_mask:0xf
    v_add_f32_dpp v113, v113, v113 row_ror:2 row_mask:0xf bank_mask:0xf
    v_add_f32_dpp v117, v117, v117 row_ror:2 row_mask:0xf bank_mask:0xf
    v_add_f32_dpp v114, v114, v114 row_ror:2 row_mask:0xf bank_mask:0xf
    v_add_f32_dpp v118, v118, v118 row_ror:2 row_mask:0xf bank_mask:0xf
    v_add_f32_dpp v115, v115, v115 row_ror:2 row_mask:0xf bank_mask:0xf
    v_add_f32_dpp v119, v119, v119 row_ror:2 row_mask:0xf bank_mask:0xf
    v_add_f32_dpp v112, v112, v112 row_ror:1 row_mask:0xf bank_mask:0xf
    v_add_f32_dpp v116, v116, v116 row_ror:1 row_mask:0xf bank_mask:0xf
    v_add_f32_dpp v113, v113, v113 row_ror:1 row_mask:0xf bank_mask:0xf
    v_add_f32_dpp v117, v117, v117 row_ror:1 row_mask:0xf bank_mask:0xf
    v_add_f32_dpp v114, v114, v114 row_ror:1 row_mask:0xf bank_mask:0xf
    v_add_f32_dpp v118, v118, v118 row_ror:1 row_mask:0xf bank_mask:0xf
    v_add_f32_dpp v115, v115, v115 row_ror:1 row_mask:0xf bank_mask:0xf
    v_add_f32_dpp v119, v119, v119 row_ror:1 row_mask:0xf bank_mask:0xf
    v_rcp_f32 v112, v112
    v_rcp_f32 v116, v116
    v_rcp_f32 v113, v113
    v_rcp_f32 v117, v117
    v_rcp_f32 v114, v114
    v_rcp_f32 v118, v118
    v_rcp_f32 v115, v115
    v_rcp_f32 v119, v119
    s_nop 0
    v_mul_f32 v120, v120, v112
    v_mul_f32 v96, v96, v116
    v_mul_f32 v121, v121, v113
    v_mul_f32 v97, v97, v117
    v_mul_f32 v122, v122, v114
    v_mul_f32 v98, v98, v118
    v_mul_f32 v123, v123, v115
    v_mul_f32 v99, v99, v119
    v_mul_f32 v124, v124, v112
    v_mul_f32 v100, v100, v116
    v_mul_f32 v125, v125, v113
    v_mul_f32 v101, v101, v117
    v_mul_f32 v126, v126, v114
    v_mul_f32 v102, v102, v118
    v_mul_f32 v127, v127, v115
    v_mul_f32 v103, v103, v119
    v_cvt_pk_bf16_f32 v16, v120, v121
    v_cvt_pk_bf16_f32 v24, v96, v97
    v_cvt_pk_bf16_f32 v17, v122, v123
    v_cvt_pk_bf16_f32 v25, v98, v99
    v_cvt_pk_bf16_f32 v20, v124, v125
    v_cvt_pk_bf16_f32 v28, v100, v101
    v_cvt_pk_bf16_f32 v21, v126, v127
    v_cvt_pk_bf16_f32 v29, v102, v103
    v_cndmask_b32_e64 v108, v108, v104, s[38:39]
    v_cndmask_b32_e64 v109, v109, v105, s[38:39]
    v_cndmask_b32_e64 v110, v110, v106, s[38:39]
    v_cndmask_b32_e64 v111, v111, v107, s[38:39]
    v_max_f32 v112, v104, v108
    v_min_f32 v116, v104, v108
    v_max_f32 v113, v105, v109
    v_min_f32 v117, v105, v109
    v_max_f32 v114, v106, v110
    v_min_f32 v118, v106, v110
    v_max_f32 v115, v107, v111
    v_min_f32 v119, v107, v111
    s_nop 0
    v_max_f32_dpp v112, v112, v112 row_ror:8 row_mask:0xf bank_mask:0xf
    v_min_f32_dpp v116, v116, v116 row_ror:8 row_mask:0xf bank_mask:0xf
    v_max_f32_dpp v113, v113, v113 row_ror:8 row_mask:0xf bank_mask:0xf
    v_min_f32_dpp v117, v117, v117 row_ror:8 row_mask:0xf bank_mask:0xf
    v_max_f32_dpp v114, v114, v114 row_ror:8 row_mask:0xf bank_mask:0xf
    v_min_f32_dpp v118, v118, v118 row_ror:8 row_mask:0xf bank_mask:0xf
    v_max_f32_dpp v115, v115, v115 row_ror:8 row_mask:0xf bank_mask:0xf
    v_min_f32_dpp v119, v119, v119 row_ror:8 row_mask:0xf bank_mask:0xf
    v_max_f32_dpp v112, v112, v112 row_ror:4 row_mask:0xf bank_mask:0xf
    v_min_f32_dpp v116, v116, v116 row_ror:4 row_mask:0xf bank_mask:0xf
    v_max_f32_dpp v113, v113, v113 row_ror:4 row_mask:0xf bank_mask:0xf
    v_min_f32_dpp v117, v117, v117 row_ror:4 row_mask:0xf bank_mask:0xf
    v_max_f32_dpp v114, v114, v114 row_ror:4 row_mask:0xf bank_mask:0xf
    v_min_f32_dpp v118, v118, v118 row_ror:4 row_mask:0xf bank_mask:0xf
    v_max_f32_dpp v115, v115, v115 row_ror:4 row_mask:0xf bank_mask:0xf
    v_min_f32_dpp v119, v119, v119 row_ror:4 row_mask:0xf bank_mask:0xf
    v_max_f32_dpp v112, v112, v112 row_ror:2 row_mask:0xf bank_mask:0xf
    v_min_f32_dpp v116, v116, v116 row_ror:2 row_mask:0xf bank_mask:0xf
    v_max_f32_dpp v113, v113, v113 row_ror:2 row_mask:0xf bank_mask:0xf
    v_min_f32_dpp v117, v117, v117 row_ror:2 row_mask:0xf bank_mask:0xf
    v_max_f32_dpp v114, v114, v114 row_ror:2 row_mask:0xf bank_mask:0xf
    v_min_f32_dpp v118, v118, v118 row_ror:2 row_mask:0xf bank_mask:0xf
    v_max_f32_dpp v115, v115, v115 row_ror:2 row_mask:0xf bank_mask:0xf
    v_min_f32_dpp v119, v119, v119 row_ror:2 row_mask:0xf bank_mask:0xf
    v_max_f32_dpp v112, v112, v112 row_ror:1 row_mask:0xf bank_mask:0xf
    v_min_f32_dpp v116, v116, v116 row_ror:1 row_mask:0xf bank_mask:0xf
    v_max_f32_dpp v113, v113, v113 row_ror:1 row_mask:0xf bank_mask:0xf
    v_min_f32_dpp v117, v117, v117 row_ror:1 row_mask:0xf bank_mask:0xf
    v_max_f32_dpp v114, v114, v114 row_ror:1 row_mask:0xf bank_mask:0xf
    v_min_f32_dpp v118, v118, v118 row_ror:1 row_mask:0xf bank_mask:0xf
    v_max_f32_dpp v115, v115, v115 row_ror:1 row_mask:0xf bank_mask:0xf
    v_min_f32_dpp v119, v119, v119 row_ror:1 row_mask:0xf bank_mask:0xf
    v_mul_f32 v112, s42, v112
    v_mul_f32 v116, s42, v116
    v_mul_f32 v113, s42, v113
    v_mul_f32 v117, s42, v117
    v_mul_f32 v114, s42, v114
    v_mul_f32 v118, s42, v118
    v_mul_f32 v115, s42, v115
    v_mul_f32 v119, s42, v119
    v_fma_f32 v120, v104, s42, -v112
    v_fma_f32 v104, -v104, s42, v116
    v_fma_f32 v121, v105, s42, -v113
    v_fma_f32 v105, -v105, s42, v117
    v_fma_f32 v122, v106, s42, -v114
    v_fma_f32 v106, -v106, s42, v118
    v_fma_f32 v123, v107, s42, -v115
    v_fma_f32 v107, -v107, s42, v119
    v_fma_f32 v124, v108, s42, -v112
    v_fma_f32 v108, -v108, s42, v116
    v_fma_f32 v125, v109, s42, -v113
    v_fma_f32 v109, -v109, s42, v117
    v_fma_f32 v126, v110, s42, -v114
    v_fma_f32 v110, -v110, s42, v118
    v_fma_f32 v127, v111, s42, -v115
    v_fma_f32 v111, -v111, s42, v119
    v_exp_f32 v120, v120
    v_exp_f32 v104, v104
    v_exp_f32 v121, v121
    v_exp_f32 v105, v105
    v_exp_f32 v122, v122
    v_exp_f32 v106, v106
    v_exp_f32 v123, v123
    v_exp_f32 v107, v107
    v_exp_f32 v124, v124
    v_exp_f32 v108, v108
    v_exp_f32 v125, v125
    v_exp_f32 v109, v109
    v_exp_f32 v126, v126
    v_exp_f32 v110, v110
    v_exp_f32 v127, v127
    v_exp_f32 v111, v111
    s_nop 0
    v_cndmask_b32_e64 v124, v124, 0, s[38:39]
    v_cndmask_b32_e64 v108, v108, 0, s[38:39]
    v_cndmask_b32_e64 v125, v125, 0, s[38:39]
    v_cndmask_b32_e64 v109, v109, 0, s[38:39]
    v_cndmask_b32_e64 v126, v126, 0, s[38:39]
    v_cndmask_b32_e64 v110, v110, 0, s[38:39]
    v_cndmask_b32_e64 v127, v127, 0, s[38:39]
    v_cndmask_b32_e64 v111, v111, 0, s[38:39]
    v_add_f32 v112, v120, v124
    v_add_f32 v116, v104, v108
    v_add_f32 v113, v121, v125
    v_add_f32 v117, v105, v109
    v_add_f32 v114, v122, v126
    v_add_f32 v118, v106, v110
    v_add_f32 v115, v123, v127
    v_add_f32 v119, v107, v111
    s_nop 0
    v_add_f32_dpp v112, v112, v112 row_ror:8 row_mask:0xf bank_mask:0xf
    v_add_f32_dpp v116, v116, v116 row_ror:8 row_mask:0xf bank_mask:0xf
    v_add_f32_dpp v113, v113, v113 row_ror:8 row_mask:0xf bank_mask:0xf
    v_add_f32_dpp v117, v117, v117 row_ror:8 row_mask:0xf bank_mask:0xf
    v_add_f32_dpp v114, v114, v114 row_ror:8 row_mask:0xf bank_mask:0xf
    v_add_f32_dpp v118, v118, v118 row_ror:8 row_mask:0xf bank_mask:0xf
    v_add_f32_dpp v115, v115, v115 row_ror:8 row_mask:0xf bank_mask:0xf
    v_add_f32_dpp v119, v119, v119 row_ror:8 row_mask:0xf bank_mask:0xf
    v_add_f32_dpp v112, v112, v112 row_ror:4 row_mask:0xf bank_mask:0xf
    v_add_f32_dpp v116, v116, v116 row_ror:4 row_mask:0xf bank_mask:0xf
    v_add_f32_dpp v113, v113, v113 row_ror:4 row_mask:0xf bank_mask:0xf
    v_add_f32_dpp v117, v117, v117 row_ror:4 row_mask:0xf bank_mask:0xf
    v_add_f32_dpp v114, v114, v114 row_ror:4 row_mask:0xf bank_mask:0xf
    v_add_f32_dpp v118, v118, v118 row_ror:4 row_mask:0xf bank_mask:0xf
    v_add_f32_dpp v115, v115, v115 row_ror:4 row_mask:0xf bank_mask:0xf
    v_add_f32_dpp v119, v119, v119 row_ror:4 row_mask:0xf bank_mask:0xf
    v_add_f32_dpp v112, v112, v112 row_ror:2 row_mask:0xf bank_mask:0xf
    v_add_f32_dpp v116, v116, v116 row_ror:2 row_mask:0xf bank_mask:0xf
    v_add_f32_dpp v113, v113, v113 row_ror:2 row_mask:0xf bank_mask:0xf
    v_add_f32_dpp v117, v117, v117 row_ror:2 row_mask:0xf bank_mask:0xf
    v_add_f32_dpp v114, v114, v114 row_ror:2 row_mask:0xf bank_mask:0xf
    v_add_f32_dpp v118, v118, v118 row_ror:2 row_mask:0xf bank_mask:0xf
    v_add_f32_dpp v115, v115, v115 row_ror:2 row_mask:0xf bank_mask:0xf
    v_add_f32_dpp v119, v119, v119 row_ror:2 row_mask:0xf bank_mask:0xf
    v_add_f32_dpp v112, v112, v112 row_ror:1 row_mask:0xf bank_mask:0xf
    v_add_f32_dpp v116, v116, v116 row_ror:1 row_mask:0xf bank_mask:0xf
    v_add_f32_dpp v113, v113, v113 row_ror:1 row_mask:0xf bank_mask:0xf
    v_add_f32_dpp v117, v117, v117 row_ror:1 row_mask:0xf bank_mask:0xf
    v_add_f32_dpp v114, v114, v114 row_ror:1 row_mask:0xf bank_mask:0xf
    v_add_f32_dpp v118, v118, v118 row_ror:1 row_mask:0xf bank_mask:0xf
    v_add_f32_dpp v115, v115, v115 row_ror:1 row_mask:0xf bank_mask:0xf
    v_add_f32_dpp v119, v119, v119 row_ror:1 row_mask:0xf bank_mask:0xf
    v_rcp_f32 v112, v112
    v_rcp_f32 v116, v116
    v_rcp_f32 v113, v113
    v_rcp_f32 v117, v117
    v_rcp_f32 v114, v114
    v_rcp_f32 v118, v118
    v_rcp_f32 v115, v115
    v_rcp_f32 v119, v119
    s_nop 0
    v_mul_f32 v120, v120, v112
    v_mul_f32 v104, v104, v116
    v_mul_f32 v121, v121, v113
    v_mul_f32 v105, v105, v117
    v_mul_f32 v122, v122, v114
    v_mul_f32 v106, v106, v118
    v_mul_f32 v123, v123, v115
    v_mul_f32 v107, v107, v119
    v_mul_f32 v124, v124, v112
    v_mul_f32 v108, v108, v116
    v_mul_f32 v125, v125, v113
    v_mul_f32 v109, v109, v117
    v_mul_f32 v126, v126, v114
    v_mul_f32 v110, v110, v118
    v_mul_f32 v127, v127, v115
    v_mul_f32 v111, v111, v119
    v_cvt_pk_bf16_f32 v18, v120, v121
    v_cvt_pk_bf16_f32 v26, v104, v105
    v_cvt_pk_bf16_f32 v19, v122, v123
    v_cvt_pk_bf16_f32 v27, v106, v107
    v_cvt_pk_bf16_f32 v22, v124, v125
    v_cvt_pk_bf16_f32 v30, v108, v109
    v_cvt_pk_bf16_f32 v23, v126, v127
    v_cvt_pk_bf16_f32 v31, v110, v111
    v_cndmask_b32_e64 v56, v56, 1.0, s[40:41]
    v_cndmask_b32_e64 v57, v57, 1.0, s[40:41]
    v_cndmask_b32_e64 v58, v58, 1.0, s[40:41]
    v_cndmask_b32_e64 v59, v59, 1.0, s[40:41]
    v_cndmask_b32_e64 v60, v60, 1.0, s[40:41]
    v_cndmask_b32_e64 v61, v61, 1.0, s[40:41]
    v_cndmask_b32_e64 v62, v62, 1.0, s[40:41]
    v_cndmask_b32_e64 v63, v63, 1.0, s[40:41]
    v_cvt_pk_bf16_f32 v32, v48, v49
    v_cvt_pk_bf16_f32 v33, v50, v51
    v_cvt_pk_bf16_f32 v34, v52, v53
    v_cvt_pk_bf16_f32 v35, v54, v55
    v_cvt_pk_bf16_f32 v36, v56, v57
    v_cvt_pk_bf16_f32 v37, v58, v59
    v_cvt_pk_bf16_f32 v38, v60, v61
    v_cvt_pk_bf16_f32 v39, v62, v63
    s_nop 1
    v_mfma_f32_16x16x32_bf16 v[64:67], v[16:19], v[32:35], 0
    v_mfma_f32_16x16x32_bf16 v[68:71], v[16:19], v[36:39], 0
    v_mfma_f32_16x16x32_bf16 v[72:75], v[20:23], v[32:35], 0
    v_mfma_f32_16x16x32_bf16 v[76:79], v[20:23], v[36:39], 0
    v_mfma_f32_16x16x32_bf16 v[80:83], v[24:27], v[32:35], 0
    v_mfma_f32_16x16x32_bf16 v[84:87], v[24:27], v[36:39], 0
    v_mfma_f32_16x16x32_bf16 v[88:91], v[28:31], v[32:35], 0
    v_mfma_f32_16x16x32_bf16 v[92:95], v[28:31], v[36:39], 0
    v_lshlrev_b32 v9, 2, v1
    s_lshl_b32 s43, s28, 4
    s_add_u32 s43, s43, s29
    s_lshl_b32 s43, s43, 13
    s_add_u32 s44, s43, 4096
    s_nop 7
    s_nop 3
    buffer_store_dword v64, v9, s[20:23], s43 offen offset:0
    buffer_store_dword v65, v9, s[20:23], s43 offen offset:256
    buffer_store_dword v66, v9, s[20:23], s43 offen offset:512
    buffer_store_dword v67, v9, s[20:23], s43 offen offset:768
    buffer_store_dword v68, v9, s[20:23], s43 offen offset:1024
    buffer_store_dword v69, v9, s[20:23], s43 offen offset:1280
    buffer_store_dword v70, v9, s[20:23], s43 offen offset:1536
    buffer_store_dword v71, v9, s[20:23], s43 offen offset:1792
    buffer_store_dword v72, v9, s[20:23], s43 offen offset:2048
    buffer_store_dword v73, v9, s[20:23], s43 offen offset:2304
    buffer_store_dword v74, v9, s[20:23], s43 offen offset:2560
    buffer_store_dword v75, v9, s[20:23], s43 offen offset:2816
    buffer_store_dword v76, v9, s[20:23], s43 offen offset:3072
    buffer_store_dword v77, v9, s[20:23], s43 offen offset:3328
    buffer_store_dword v78, v9, s[20:23], s43 offen offset:3584
    buffer_store_dword v79, v9, s[20:23], s43 offen offset:3840
    buffer_store_dword v80, v9, s[20:23], s44 offen offset:0
    buffer_store_dword v81, v9, s[20:23], s44 offen offset:256
    buffer_store_dword v82, v9, s[20:23], s44 offen offset:512
    buffer_store_dword v83, v9, s[20:23], s44 offen offset:768
    buffer_store_dword v84, v9, s[20:23], s44 offen offset:1024
    buffer_store_dword v85, v9, s[20:23], s44 offen offset:1280
    buffer_store_dword v86, v9, s[20:23], s44 offen offset:1536
    buffer_store_dword v87, v9, s[20:23], s44 offen offset:1792
    buffer_store_dword v88, v9, s[20:23], s44 offen offset:2048
    buffer_store_dword v89, v9, s[20:23], s44 offen offset:2304
    buffer_store_dword v90, v9, s[20:23], s44 offen offset:2560
    buffer_store_dword v91, v9, s[20:23], s44 offen offset:2816
    buffer_store_dword v92, v9, s[20:23], s44 offen offset:3072
    buffer_store_dword v93, v9, s[20:23], s44 offen offset:3328
    buffer_store_dword v94, v9, s[20:23], s44 offen offset:3584
    buffer_store_dword v95, v9, s[20:23], s44 offen offset:3840
k1l1_kernel_done:
    s_endpgm
.globl krl1_kernel
.p2align 8
.type krl1_kernel,@function
krl1_kernel:
    s_cmp_ge_u32 s2, 128
    s_cbranch_scc1 krl1_kernel_done
    s_load_dwordx2 s[4:5], s[0:1], 88
    s_lshl_b32 s3, s2, 8
    v_add_u32 v1, s3, v0
    v_lshlrev_b32 v2, 2, v1
    s_waitcnt lgkmcnt(0)
    s_add_u32 s8, s4, 0x528000
    s_addc_u32 s9, s5, 0
    s_mov_b32 s10, 0x800000
    s_mov_b32 s11, 0x00020000
    s_add_u32 s12, s4, 0xd28000
    s_addc_u32 s13, s5, 0
    s_mov_b32 s14, 0x10000
    s_mov_b32 s15, 0x00020000
    s_mov_b32 s16, 0x0
    buffer_load_dword v8, v2, s[8:11], s16 offen
    s_mov_b32 s16, 0x20000
    buffer_load_dword v9, v2, s[8:11], s16 offen
    s_mov_b32 s16, 0x40000
    buffer_load_dword v10, v2, s[8:11], s16 offen
    s_mov_b32 s16, 0x60000
    buffer_load_dword v11, v2, s[8:11], s16 offen
    s_mov_b32 s16, 0x80000
    buffer_load_dword v12, v2, s[8:11], s16 offen
    s_mov_b32 s16, 0xa0000
    buffer_load_dword v13, v2, s[8:11], s16 offen
    s_mov_b32 s16, 0xc0000
    buffer_load_dword v14, v2, s[8:11], s16 offen
    s_mov_b32 s16, 0xe0000
    buffer_load_dword v15, v2, s[8:11], s16 offen
    s_mov_b32 s16, 0x100000
    buffer_load_dword v16, v2, s[8:11], s16 offen
    s_mov_b32 s16, 0x120000
    buffer_load_dword v17, v2, s[8:11], s16 offen
    s_mov_b32 s16, 0x140000
    buffer_load_dword v18, v2, s[8:11], s16 offen
    s_mov_b32 s16, 0x160000
    buffer_load_dword v19, v2, s[8:11], s16 offen
    s_mov_b32 s16, 0x180000
    buffer_load_dword v20, v2, s[8:11], s16 offen
    s_mov_b32 s16, 0x1a0000
    buffer_load_dword v21, v2, s[8:11], s16 offen
    s_mov_b32 s16, 0x1c0000
    buffer_load_dword v22, v2, s[8:11], s16 offen
    s_mov_b32 s16, 0x1e0000
    buffer_load_dword v23, v2, s[8:11], s16 offen
    s_mov_b32 s16, 0x200000
    buffer_load_dword v24, v2, s[8:11], s16 offen
    s_mov_b32 s16, 0x220000
    buffer_load_dword v25, v2, s[8:11], s16 offen
    s_mov_b32 s16, 0x240000
    buffer_load_dword v26, v2, s[8:11], s16 offen
    s_mov_b32 s16, 0x260000
    buffer_load_dword v27, v2, s[8:11], s16 offen
    s_mov_b32 s16, 0x280000
    buffer_load_dword v28, v2, s[8:11], s16 offen
    s_mov_b32 s16, 0x2a0000
    buffer_load_dword v29, v2, s[8:11], s16 offen
    s_mov_b32 s16, 0x2c0000
    buffer_load_dword v30, v2, s[8:11], s16 offen
    s_mov_b32 s16, 0x2e0000
    buffer_load_dword v31, v2, s[8:11], s16 offen
    s_mov_b32 s16, 0x300000
    buffer_load_dword v32, v2, s[8:11], s16 offen
    s_mov_b32 s16, 0x320000
    buffer_load_dword v33, v2, s[8:11], s16 offen
    s_mov_b32 s16, 0x340000
    buffer_load_dword v34, v2, s[8:11], s16 offen
    s_mov_b32 s16, 0x360000
    buffer_load_dword v35, v2, s[8:11], s16 offen
    s_mov_b32 s16, 0x380000
    buffer_load_dword v36, v2, s[8:11], s16 offen
    s_mov_b32 s16, 0x3a0000
    buffer_load_dword v37, v2, s[8:11], s16 offen
    s_mov_b32 s16, 0x3c0000
    buffer_load_dword v38, v2, s[8:11], s16 offen
    s_mov_b32 s16, 0x3e0000
    buffer_load_dword v39, v2, s[8:11], s16 offen
    s_mov_b32 s16, 0x400000
    buffer_load_dword v40, v2, s[8:11], s16 offen
    s_mov_b32 s16, 0x420000
    buffer_load_dword v41, v2, s[8:11], s16 offen
    s_mov_b32 s16, 0x440000
    buffer_load_dword v42, v2, s[8:11], s16 offen
    s_mov_b32 s16, 0x460000
    buffer_load_dword v43, v2, s[8:11], s16 offen
    s_mov_b32 s16, 0x480000
    buffer_load_dword v44, v2, s[8:11], s16 offen
    s_mov_b32 s16, 0x4a0000
    buffer_load_dword v45, v2, s[8:11], s16 offen
    s_mov_b32 s16, 0x4c0000
    buffer_load_dword v46, v2, s[8:11], s16 offen
    s_mov_b32 s16, 0x4e0000
    buffer_load_dword v47, v2, s[8:11], s16 offen
    s_mov_b32 s16, 0x500000
    buffer_load_dword v48, v2, s[8:11], s16 offen
    s_mov_b32 s16, 0x520000
    buffer_load_dword v49, v2, s[8:11], s16 offen
    s_mov_b32 s16, 0x540000
    buffer_load_dword v50, v2, s[8:11], s16 offen
    s_mov_b32 s16, 0x560000
    buffer_load_dword v51, v2, s[8:11], s16 offen
    s_mov_b32 s16, 0x580000
    buffer_load_dword v52, v2, s[8:11], s16 offen
    s_mov_b32 s16, 0x5a0000
    buffer_load_dword v53, v2, s[8:11], s16 offen
    s_mov_b32 s16, 0x5c0000
    buffer_load_dword v54, v2, s[8:11], s16 offen
    s_mov_b32 s16, 0x5e0000
    buffer_load_dword v55, v2, s[8:11], s16 offen
    s_mov_b32 s16, 0x600000
    buffer_load_dword v56, v2, s[8:11], s16 offen
    s_mov_b32 s16, 0x620000
    buffer_load_dword v57, v2, s[8:11], s16 offen
    s_mov_b32 s16, 0x640000
    buffer_load_dword v58, v2, s[8:11], s16 offen
    s_mov_b32 s16, 0x660000
    buffer_load_dword v59, v2, s[8:11], s16 offen
    s_mov_b32 s16, 0x680000
    buffer_load_dword v60, v2, s[8:11], s16 offen
    s_mov_b32 s16, 0x6a0000
    buffer_load_dword v61, v2, s[8:11], s16 offen
    s_mov_b32 s16, 0x6c0000
    buffer_load_dword v62, v2, s[8:11], s16 offen
    s_mov_b32 s16, 0x6e0000
    buffer_load_dword v63, v2, s[8:11], s16 offen
    s_mov_b32 s16, 0x700000
    buffer_load_dword v64, v2, s[8:11], s16 offen
    s_mov_b32 s16, 0x720000
    buffer_load_dword v65, v2, s[8:11], s16 offen
    s_mov_b32 s16, 0x740000
    buffer_load_dword v66, v2, s[8:11], s16 offen
    s_mov_b32 s16, 0x760000
    buffer_load_dword v67, v2, s[8:11], s16 offen
    s_mov_b32 s16, 0x780000
    buffer_load_dword v68, v2, s[8:11], s16 offen
    s_mov_b32 s16, 0x7a0000
    buffer_load_dword v69, v2, s[8:11], s16 offen
    s_mov_b32 s16, 0x7c0000
    buffer_load_dword v70, v2, s[8:11], s16 offen
    s_mov_b32 s16, 0x7e0000
    buffer_load_dword v71, v2, s[8:11], s16 offen
    v_and_b32 v3, 63, v1
    v_bfe_u32 v4, v1, 6, 2
    v_bfe_u32 v5, v1, 8, 1
    v_bfe_u32 v6, v1, 9, 1
    v_bfe_u32 v7, v1, 10, 1
    v_lshrrev_b32 v72, 11, v1
    v_lshl_add_u32 v72, v72, 1, v7
    v_lshl_add_u32 v72, v72, 1, v5
    v_lshl_add_u32 v72, v72, 6, v3
    v_lshlrev_b32 v72, 4, v72
    v_lshl_add_u32 v4, v6, 2, v4
    v_lshl_add_u32 v72, v4, 1, v72
    s_waitcnt vmcnt(0)
    v_add_f32 v8, v8, v40
    v_add_f32 v9, v9, v41
    v_add_f32 v10, v10, v42
    v_add_f32 v11, v11, v43
    v_add_f32 v12, v12, v44
    v_add_f32 v13, v13, v45
    v_add_f32 v14, v14, v46
    v_add_f32 v15, v15, v47
    v_add_f32 v16, v16, v48
    v_add_f32 v17, v17, v49
    v_add_f32 v18, v18, v50
    v_add_f32 v19, v19, v51
    v_add_f32 v20, v20, v52
    v_add_f32 v21, v21, v53
    v_add_f32 v22, v22, v54
    v_add_f32 v23, v23, v55
    v_add_f32 v24, v24, v56
    v_add_f32 v25, v25, v57
    v_add_f32 v26, v26, v58
    v_add_f32 v27, v27, v59
    v_add_f32 v28, v28, v60
    v_add_f32 v29, v29, v61
    v_add_f32 v30, v30, v62
    v_add_f32 v31, v31, v63
    v_add_f32 v32, v32, v64
    v_add_f32 v33, v33, v65
    v_add_f32 v34, v34, v66
    v_add_f32 v35, v35, v67
    v_add_f32 v36, v36, v68
    v_add_f32 v37, v37, v69
    v_add_f32 v38, v38, v70
    v_add_f32 v39, v39, v71
    v_add_f32 v8, v8, v24
    v_add_f32 v9, v9, v25
    v_add_f32 v10, v10, v26
    v_add_f32 v11, v11, v27
    v_add_f32 v12, v12, v28
    v_add_f32 v13, v13, v29
    v_add_f32 v14, v14, v30
    v_add_f32 v15, v15, v31
    v_add_f32 v16, v16, v32
    v_add_f32 v17, v17, v33
    v_add_f32 v18, v18, v34
    v_add_f32 v19, v19, v35
    v_add_f32 v20, v20, v36
    v_add_f32 v21, v21, v37
    v_add_f32 v22, v22, v38
    v_add_f32 v23, v23, v39
    v_add_f32 v8, v8, v16
    v_add_f32 v9, v9, v17
    v_add_f32 v10, v10, v18
    v_add_f32 v11, v11, v19
    v_add_f32 v12, v12, v20
    v_add_f32 v13, v13, v21
    v_add_f32 v14, v14, v22
    v_add_f32 v15, v15, v23
    v_add_f32 v8, v8, v12
    v_add_f32 v9, v9, v13
    v_add_f32 v10, v10, v14
    v_add_f32 v11, v11, v15
    v_add_f32 v8, v8, v10
    v_add_f32 v9, v9, v11
    v_add_f32 v8, v8, v9
    v_cvt_pk_bf16_f32 v8, v8, v8
    buffer_store_short v8, v72, s[12:15], 0 offen
krl1_kernel_done:
    s_endpgm
.globl k2l1_kernel
.p2align 8
.type k2l1_kernel,@function
k2l1_kernel:
    s_cmp_ge_u32 s2, 256
    s_cbranch_scc1 k2l1_kernel_done
    s_load_dwordx2 s[24:25], s[0:1], 88
    s_load_dwordx2 s[26:27], s[0:1], 0
    v_lshrrev_b32 v9, 6, v0
    v_and_b32 v1, 63, v0
    v_lshlrev_b32 v2, 4, v1
    v_and_b32 v3, 15, v1
    v_lshrrev_b32 v4, 4, v1
    v_readfirstlane_b32 s3, v9
    v_add_u32 v9, 0, v4
    v_xor_b32 v9, v9, v3
    v_lshlrev_b32 v9, 4, v9
    v_lshl_add_u32 v5, v3, 10, v9
    v_add_u32 v9, 4, v4
    v_xor_b32 v9, v9, v3
    v_lshlrev_b32 v9, 4, v9
    v_lshl_add_u32 v6, v3, 10, v9
    v_add_u32 v9, 8, v4
    v_xor_b32 v9, v9, v3
    v_lshlrev_b32 v9, 4, v9
    v_lshl_add_u32 v7, v3, 10, v9
    v_add_u32 v9, 12, v4
    v_xor_b32 v9, v9, v3
    v_lshlrev_b32 v9, 4, v9
    v_lshl_add_u32 v8, v3, 10, v9
    s_and_b32 s28, s2, 7
    s_lshl_b32 s28, s28, 4
    s_lshr_b32 s29, s2, 4
    s_add_u32 s28, s28, s29
    s_lshr_b32 s29, s2, 3
    s_and_b32 s29, s29, 1
    s_lshl_b32 s30, s29, 4
    s_lshl_b32 s31, s3, 2
    s_add_u32 s30, s30, s31
    s_lshl_b32 s31, s30, 10
    s_waitcnt lgkmcnt(0)
    s_mov_b32 s4, s26
    s_mov_b32 s5, s27
    s_mov_b32 s6, 0x1c0000
    s_mov_b32 s7, 0x00020000
    s_add_u32 s8, s24, 0x150000
    s_addc_u32 s9, s25, 0
    s_mov_b32 s10, 0x80000
    s_mov_b32 s11, 0x00020000
    s_add_u32 s12, s24, 0x1278000
    s_addc_u32 s13, s25, 0
    s_mov_b32 s14, 0x400000
    s_mov_b32 s15, 0x00020000
    s_add_u32 s16, s24, 0xd28000
    s_addc_u32 s17, s25, 0
    s_mov_b32 s18, 0x10000
    s_mov_b32 s19, 0x00020000
    s_add_u32 s20, s24, 0xd38000
    s_addc_u32 s21, s25, 0
    s_mov_b32 s22, 0x1c0000
    s_mov_b32 s23, 0x00020000
    v_lshlrev_b32 v10, 2, v1
    s_lshl_b32 s33, s3, 2
    s_add_u32 s33, s33, 0
    s_lshl_b32 s34, s28, 4
    s_add_u32 s34, s34, s33
    s_lshl_b32 s34, s34, 11
    buffer_load_dwordx4 v[104:107], v2, s[12:15], s34 offen
    buffer_load_dwordx4 v[108:111], v2, s[12:15], s34 offen offset:1024
    s_lshl_b32 s34, s33, 12
    buffer_load_dwordx4 v[112:115], v2, s[16:19], s34 offen offset:0
    buffer_load_dwordx4 v[116:119], v2, s[16:19], s34 offen offset:1024
    buffer_load_dwordx4 v[120:123], v2, s[16:19], s34 offen offset:2048
    buffer_load_dwordx4 v[124:127], v2, s[16:19], s34 offen offset:3072
    s_lshl_b32 s33, s3, 2
    s_add_u32 s33, s33, 1
    s_lshl_b32 s34, s28, 4
    s_add_u32 s34, s34, s33
    s_lshl_b32 s34, s34, 11
    buffer_load_dwordx4 v[128:131], v2, s[12:15], s34 offen
    buffer_load_dwordx4 v[132:135], v2, s[12:15], s34 offen offset:1024
    s_lshl_b32 s34, s33, 12
    buffer_load_dwordx4 v[136:139], v2, s[16:19], s34 offen offset:0
    buffer_load_dwordx4 v[140:143], v2, s[16:19], s34 offen offset:1024
    buffer_load_dwordx4 v[144:147], v2, s[16:19], s34 offen offset:2048
    buffer_load_dwordx4 v[148:151], v2, s[16:19], s34 offen offset:3072
    s_lshl_b32 s33, s3, 2
    s_add_u32 s33, s33, 2
    s_lshl_b32 s34, s28, 4
    s_add_u32 s34, s34, s33
    s_lshl_b32 s34, s34, 11
    buffer_load_dwordx4 v[152:155], v2, s[12:15], s34 offen
    buffer_load_dwordx4 v[156:159], v2, s[12:15], s34 offen offset:1024
    s_lshl_b32 s34, s33, 12
    buffer_load_dwordx4 v[160:163], v2, s[16:19], s34 offen offset:0
    buffer_load_dwordx4 v[164:167], v2, s[16:19], s34 offen offset:1024
    buffer_load_dwordx4 v[168:171], v2, s[16:19], s34 offen offset:2048
    buffer_load_dwordx4 v[172:175], v2, s[16:19], s34 offen offset:3072
    s_lshl_b32 s33, s3, 2
    s_add_u32 s33, s33, 3
    s_lshl_b32 s34, s28, 4
    s_add_u32 s34, s34, s33
    s_lshl_b32 s34, s34, 11
    buffer_load_dwordx4 v[176:179], v2, s[12:15], s34 offen
    buffer_load_dwordx4 v[180:183], v2, s[12:15], s34 offen offset:1024
    s_lshl_b32 s34, s33, 12
    buffer_load_dwordx4 v[184:187], v2, s[16:19], s34 offen offset:0
    buffer_load_dwordx4 v[188:191], v2, s[16:19], s34 offen offset:1024
    buffer_load_dwordx4 v[192:195], v2, s[16:19], s34 offen offset:2048
    buffer_load_dwordx4 v[196:199], v2, s[16:19], s34 offen offset:3072
    s_add_u32 s32, s31, 0x0
    buffer_load_dwordx4 a[0:3], v2, s[8:11], s32 offen offset:0
    buffer_load_dwordx4 a[4:7], v2, s[8:11], s32 offen offset:1024
    buffer_load_dwordx4 a[8:11], v2, s[8:11], s32 offen offset:2048
    buffer_load_dwordx4 a[12:15], v2, s[8:11], s32 offen offset:3072
    s_add_u32 s32, s31, 0x8000
    buffer_load_dwordx4 a[16:19], v2, s[8:11], s32 offen offset:0
    buffer_load_dwordx4 a[20:23], v2, s[8:11], s32 offen offset:1024
    buffer_load_dwordx4 a[24:27], v2, s[8:11], s32 offen offset:2048
    buffer_load_dwordx4 a[28:31], v2, s[8:11], s32 offen offset:3072
    s_add_u32 s32, s31, 0x10000
    buffer_load_dwordx4 a[32:35], v2, s[8:11], s32 offen offset:0
    buffer_load_dwordx4 a[36:39], v2, s[8:11], s32 offen offset:1024
    buffer_load_dwordx4 a[40:43], v2, s[8:11], s32 offen offset:2048
    buffer_load_dwordx4 a[44:47], v2, s[8:11], s32 offen offset:3072
    s_add_u32 s32, s31, 0x18000
    buffer_load_dwordx4 a[48:51], v2, s[8:11], s32 offen offset:0
    buffer_load_dwordx4 a[52:55], v2, s[8:11], s32 offen offset:1024
    buffer_load_dwordx4 a[56:59], v2, s[8:11], s32 offen offset:2048
    buffer_load_dwordx4 a[60:63], v2, s[8:11], s32 offen offset:3072
    s_add_u32 s32, s31, 0x20000
    buffer_load_dwordx4 a[64:67], v2, s[8:11], s32 offen offset:0
    buffer_load_dwordx4 a[68:71], v2, s[8:11], s32 offen offset:1024
    buffer_load_dwordx4 a[72:75], v2, s[8:11], s32 offen offset:2048
    buffer_load_dwordx4 a[76:79], v2, s[8:11], s32 offen offset:3072
    s_add_u32 s32, s31, 0x28000
    buffer_load_dwordx4 a[80:83], v2, s[8:11], s32 offen offset:0
    buffer_load_dwordx4 a[84:87], v2, s[8:11], s32 offen offset:1024
    buffer_load_dwordx4 a[88:91], v2, s[8:11], s32 offen offset:2048
    buffer_load_dwordx4 a[92:95], v2, s[8:11], s32 offen offset:3072
    s_add_u32 s32, s31, 0x30000
    buffer_load_dwordx4 a[96:99], v2, s[8:11], s32 offen offset:0
    buffer_load_dwordx4 a[100:103], v2, s[8:11], s32 offen offset:1024
    buffer_load_dwordx4 a[104:107], v2, s[8:11], s32 offen offset:2048
    buffer_load_dwordx4 a[108:111], v2, s[8:11], s32 offen offset:3072
    s_add_u32 s32, s31, 0x38000
    buffer_load_dwordx4 a[112:115], v2, s[8:11], s32 offen offset:0
    buffer_load_dwordx4 a[116:119], v2, s[8:11], s32 offen offset:1024
    buffer_load_dwordx4 a[120:123], v2, s[8:11], s32 offen offset:2048
    buffer_load_dwordx4 a[124:127], v2, s[8:11], s32 offen offset:3072
    v_lshlrev_b32 v11, 2, v3
    v_add_u32 v11, 192, v11
    s_mov_b32 s36, 0
    s_mov_b32 s37, 0xffff0000
    s_mov_b32 s38, 0x358637bd
    s_waitcnt vmcnt(50)
    v_mfma_f32_16x16x32_bf16 v[200:203], v[112:115], v[104:107], 0
    v_mfma_f32_16x16x32_bf16 v[204:207], v[116:119], v[104:107], 0
    v_mfma_f32_16x16x32_bf16 v[200:203], v[120:123], v[108:111], v[200:203]
    v_mfma_f32_16x16x32_bf16 v[204:207], v[124:127], v[108:111], v[204:207]
    s_nop 7
    s_nop 3
    ds_bpermute_b32 v208, v11, v204
    v_cvt_pk_bf16_f32 v209, v200, v201
    v_lshlrev_b32 v200, 16, v209
    v_and_b32 v201, 0xffff0000, v209
    v_cvt_pk_bf16_f32 v209, v202, v203
    v_lshlrev_b32 v202, 16, v209
    v_and_b32 v203, 0xffff0000, v209
    v_cvt_pk_bf16_f32 v209, v204, v205
    v_lshlrev_b32 v204, 16, v209
    v_and_b32 v205, 0xffff0000, v209
    v_cvt_pk_bf16_f32 v209, v206, v207
    v_lshlrev_b32 v206, 16, v209
    v_and_b32 v207, 0xffff0000, v209
    s_waitcnt lgkmcnt(0)
    v_cvt_pk_bf16_f32 v208, v208, v208
    v_lshlrev_b32 v208, 16, v208
    v_add_f32 v208, s38, v208
    v_cvt_pk_bf16_f32 v208, v208, v208
    v_lshlrev_b32 v208, 16, v208
    v_rcp_f32 v208, v208
    s_nop 0
    v_mul_f32 v200, v200, v208
    v_mul_f32 v201, v201, v208
    v_mul_f32 v202, v202, v208
    v_mul_f32 v203, v203, v208
    v_mul_f32 v204, v204, v208
    v_mul_f32 v205, v205, v208
    v_mul_f32 v206, v206, v208
    v_mul_f32 v207, v207, v208
    v_cvt_pk_bf16_f32 v210, v200, v201
    v_cvt_pk_bf16_f32 v211, v202, v203
    v_cvt_pk_bf16_f32 v212, v204, v205
    v_cvt_pk_bf16_f32 v213, v206, v207
    v_cndmask_b32_e64 v212, v212, 0, s[36:37]
    v_cndmask_b32_e64 v213, v213, 0, s[36:37]
    v_lshrrev_b32 v12, 1, v4
    v_add_u32 v12, 0, v12
    v_xor_b32 v12, v12, v3
    v_lshlrev_b32 v12, 4, v12
    v_lshl_add_u32 v12, v3, 10, v12
    v_and_b32 v13, 1, v4
    v_lshl_add_u32 v12, v13, 3, v12
    s_lshl_b32 s39, s3, 8
    v_add_u32 v12, s39, v12
    ds_write_b64 v12, v[210:211]
    v_lshrrev_b32 v12, 1, v4
    v_add_u32 v12, 2, v12
    v_xor_b32 v12, v12, v3
    v_lshlrev_b32 v12, 4, v12
    v_lshl_add_u32 v12, v3, 10, v12
    v_and_b32 v13, 1, v4
    v_lshl_add_u32 v12, v13, 3, v12
    s_lshl_b32 s39, s3, 8
    v_add_u32 v12, s39, v12
    ds_write_b64 v12, v[212:213]
    s_waitcnt vmcnt(44)
    v_mfma_f32_16x16x32_bf16 v[200:203], v[136:139], v[128:131], 0
    v_mfma_f32_16x16x32_bf16 v[204:207], v[140:143], v[128:131], 0
    v_mfma_f32_16x16x32_bf16 v[200:203], v[144:147], v[132:135], v[200:203]
    v_mfma_f32_16x16x32_bf16 v[204:207], v[148:151], v[132:135], v[204:207]
    s_nop 7
    s_nop 3
    ds_bpermute_b32 v208, v11, v204
    v_cvt_pk_bf16_f32 v209, v200, v201
    v_lshlrev_b32 v200, 16, v209
    v_and_b32 v201, 0xffff0000, v209
    v_cvt_pk_bf16_f32 v209, v202, v203
    v_lshlrev_b32 v202, 16, v209
    v_and_b32 v203, 0xffff0000, v209
    v_cvt_pk_bf16_f32 v209, v204, v205
    v_lshlrev_b32 v204, 16, v209
    v_and_b32 v205, 0xffff0000, v209
    v_cvt_pk_bf16_f32 v209, v206, v207
    v_lshlrev_b32 v206, 16, v209
    v_and_b32 v207, 0xffff0000, v209
    s_waitcnt lgkmcnt(0)
    v_cvt_pk_bf16_f32 v208, v208, v208
    v_lshlrev_b32 v208, 16, v208
    v_add_f32 v208, s38, v208
    v_cvt_pk_bf16_f32 v208, v208, v208
    v_lshlrev_b32 v208, 16, v208
    v_rcp_f32 v208, v208
    s_nop 0
    v_mul_f32 v200, v200, v208
    v_mul_f32 v201, v201, v208
    v_mul_f32 v202, v202, v208
    v_mul_f32 v203, v203, v208
    v_mul_f32 v204, v204, v208
    v_mul_f32 v205, v205, v208
    v_mul_f32 v206, v206, v208
    v_mul_f32 v207, v207, v208
    v_cvt_pk_bf16_f32 v210, v200, v201
    v_cvt_pk_bf16_f32 v211, v202, v203
    v_cvt_pk_bf16_f32 v212, v204, v205
    v_cvt_pk_bf16_f32 v213, v206, v207
    v_cndmask_b32_e64 v212, v212, 0, s[36:37]
    v_cndmask_b32_e64 v213, v213, 0, s[36:37]
    v_lshrrev_b32 v12, 1, v4
    v_add_u32 v12, 4, v12
    v_xor_b32 v12, v12, v3
    v_lshlrev_b32 v12, 4, v12
    v_lshl_add_u32 v12, v3, 10, v12
    v_and_b32 v13, 1, v4
    v_lshl_add_u32 v12, v13, 3, v12
    s_lshl_b32 s39, s3, 8
    v_add_u32 v12, s39, v12
    ds_write_b64 v12, v[210:211]
    v_lshrrev_b32 v12, 1, v4
    v_add_u32 v12, 6, v12
    v_xor_b32 v12, v12, v3
    v_lshlrev_b32 v12, 4, v12
    v_lshl_add_u32 v12, v3, 10, v12
    v_and_b32 v13, 1, v4
    v_lshl_add_u32 v12, v13, 3, v12
    s_lshl_b32 s39, s3, 8
    v_add_u32 v12, s39, v12
    ds_write_b64 v12, v[212:213]
    s_waitcnt vmcnt(38)
    v_mfma_f32_16x16x32_bf16 v[200:203], v[160:163], v[152:155], 0
    v_mfma_f32_16x16x32_bf16 v[204:207], v[164:167], v[152:155], 0
    v_mfma_f32_16x16x32_bf16 v[200:203], v[168:171], v[156:159], v[200:203]
    v_mfma_f32_16x16x32_bf16 v[204:207], v[172:175], v[156:159], v[204:207]
    s_nop 7
    s_nop 3
    ds_bpermute_b32 v208, v11, v204
    v_cvt_pk_bf16_f32 v209, v200, v201
    v_lshlrev_b32 v200, 16, v209
    v_and_b32 v201, 0xffff0000, v209
    v_cvt_pk_bf16_f32 v209, v202, v203
    v_lshlrev_b32 v202, 16, v209
    v_and_b32 v203, 0xffff0000, v209
    v_cvt_pk_bf16_f32 v209, v204, v205
    v_lshlrev_b32 v204, 16, v209
    v_and_b32 v205, 0xffff0000, v209
    v_cvt_pk_bf16_f32 v209, v206, v207
    v_lshlrev_b32 v206, 16, v209
    v_and_b32 v207, 0xffff0000, v209
    s_waitcnt lgkmcnt(0)
    v_cvt_pk_bf16_f32 v208, v208, v208
    v_lshlrev_b32 v208, 16, v208
    v_add_f32 v208, s38, v208
    v_cvt_pk_bf16_f32 v208, v208, v208
    v_lshlrev_b32 v208, 16, v208
    v_rcp_f32 v208, v208
    s_nop 0
    v_mul_f32 v200, v200, v208
    v_mul_f32 v201, v201, v208
    v_mul_f32 v202, v202, v208
    v_mul_f32 v203, v203, v208
    v_mul_f32 v204, v204, v208
    v_mul_f32 v205, v205, v208
    v_mul_f32 v206, v206, v208
    v_mul_f32 v207, v207, v208
    v_cvt_pk_bf16_f32 v210, v200, v201
    v_cvt_pk_bf16_f32 v211, v202, v203
    v_cvt_pk_bf16_f32 v212, v204, v205
    v_cvt_pk_bf16_f32 v213, v206, v207
    v_cndmask_b32_e64 v212, v212, 0, s[36:37]
    v_cndmask_b32_e64 v213, v213, 0, s[36:37]
    v_lshrrev_b32 v12, 1, v4
    v_add_u32 v12, 8, v12
    v_xor_b32 v12, v12, v3
    v_lshlrev_b32 v12, 4, v12
    v_lshl_add_u32 v12, v3, 10, v12
    v_and_b32 v13, 1, v4
    v_lshl_add_u32 v12, v13, 3, v12
    s_lshl_b32 s39, s3, 8
    v_add_u32 v12, s39, v12
    ds_write_b64 v12, v[210:211]
    v_lshrrev_b32 v12, 1, v4
    v_add_u32 v12, 10, v12
    v_xor_b32 v12, v12, v3
    v_lshlrev_b32 v12, 4, v12
    v_lshl_add_u32 v12, v3, 10, v12
    v_and_b32 v13, 1, v4
    v_lshl_add_u32 v12, v13, 3, v12
    s_lshl_b32 s39, s3, 8
    v_add_u32 v12, s39, v12
    ds_write_b64 v12, v[212:213]
    s_waitcnt vmcnt(32)
    v_mfma_f32_16x16x32_bf16 v[200:203], v[184:187], v[176:179], 0
    v_mfma_f32_16x16x32_bf16 v[204:207], v[188:191], v[176:179], 0
    v_mfma_f32_16x16x32_bf16 v[200:203], v[192:195], v[180:183], v[200:203]
    v_mfma_f32_16x16x32_bf16 v[204:207], v[196:199], v[180:183], v[204:207]
    s_nop 7
    s_nop 3
    ds_bpermute_b32 v208, v11, v204
    v_cvt_pk_bf16_f32 v209, v200, v201
    v_lshlrev_b32 v200, 16, v209
    v_and_b32 v201, 0xffff0000, v209
    v_cvt_pk_bf16_f32 v209, v202, v203
    v_lshlrev_b32 v202, 16, v209
    v_and_b32 v203, 0xffff0000, v209
    v_cvt_pk_bf16_f32 v209, v204, v205
    v_lshlrev_b32 v204, 16, v209
    v_and_b32 v205, 0xffff0000, v209
    v_cvt_pk_bf16_f32 v209, v206, v207
    v_lshlrev_b32 v206, 16, v209
    v_and_b32 v207, 0xffff0000, v209
    s_waitcnt lgkmcnt(0)
    v_cvt_pk_bf16_f32 v208, v208, v208
    v_lshlrev_b32 v208, 16, v208
    v_add_f32 v208, s38, v208
    v_cvt_pk_bf16_f32 v208, v208, v208
    v_lshlrev_b32 v208, 16, v208
    v_rcp_f32 v208, v208
    s_nop 0
    v_mul_f32 v200, v200, v208
    v_mul_f32 v201, v201, v208
    v_mul_f32 v202, v202, v208
    v_mul_f32 v203, v203, v208
    v_mul_f32 v204, v204, v208
    v_mul_f32 v205, v205, v208
    v_mul_f32 v206, v206, v208
    v_mul_f32 v207, v207, v208
    v_cvt_pk_bf16_f32 v210, v200, v201
    v_cvt_pk_bf16_f32 v211, v202, v203
    v_cvt_pk_bf16_f32 v212, v204, v205
    v_cvt_pk_bf16_f32 v213, v206, v207
    v_cndmask_b32_e64 v212, v212, 0, s[36:37]
    v_cndmask_b32_e64 v213, v213, 0, s[36:37]
    v_lshrrev_b32 v12, 1, v4
    v_add_u32 v12, 12, v12
    v_xor_b32 v12, v12, v3
    v_lshlrev_b32 v12, 4, v12
    v_lshl_add_u32 v12, v3, 10, v12
    v_and_b32 v13, 1, v4
    v_lshl_add_u32 v12, v13, 3, v12
    s_lshl_b32 s39, s3, 8
    v_add_u32 v12, s39, v12
    ds_write_b64 v12, v[210:211]
    v_lshrrev_b32 v12, 1, v4
    v_add_u32 v12, 14, v12
    v_xor_b32 v12, v12, v3
    v_lshlrev_b32 v12, 4, v12
    v_lshl_add_u32 v12, v3, 10, v12
    v_and_b32 v13, 1, v4
    v_lshl_add_u32 v12, v13, 3, v12
    s_lshl_b32 s39, s3, 8
    v_add_u32 v12, s39, v12
    ds_write_b64 v12, v[212:213]
    s_waitcnt lgkmcnt(0)
    s_barrier
    ds_read_b128 v[96:99], v5 offset:0
    ds_read_b128 v[100:103], v6 offset:0
    s_waitcnt vmcnt(28)
    s_waitcnt lgkmcnt(1)
    v_mfma_f32_16x16x32_bf16 v[16:19], a[0:3], v[96:99], 0
    v_mfma_f32_16x16x32_bf16 v[20:23], a[4:7], v[96:99], 0
    v_mfma_f32_16x16x32_bf16 v[24:27], a[8:11], v[96:99], 0
    v_mfma_f32_16x16x32_bf16 v[28:31], a[12:15], v[96:99], 0
    s_add_u32 s32, s31, 0x40000
    buffer_load_dwordx4 a[0:3], v2, s[8:11], s32 offen offset:0
    buffer_load_dwordx4 a[4:7], v2, s[8:11], s32 offen offset:1024
    buffer_load_dwordx4 a[8:11], v2, s[8:11], s32 offen offset:2048
    buffer_load_dwordx4 a[12:15], v2, s[8:11], s32 offen offset:3072
    ds_read_b128 v[96:99], v7 offset:0
    s_waitcnt vmcnt(28)
    s_waitcnt lgkmcnt(1)
    v_mfma_f32_16x16x32_bf16 v[16:19], a[16:19], v[100:103], v[16:19]
    v_mfma_f32_16x16x32_bf16 v[20:23], a[20:23], v[100:103], v[20:23]
    v_mfma_f32_16x16x32_bf16 v[24:27], a[24:27], v[100:103], v[24:27]
    v_mfma_f32_16x16x32_bf16 v[28:31], a[28:31], v[100:103], v[28:31]
    s_add_u32 s32, s31, 0x48000
    buffer_load_dwordx4 a[16:19], v2, s[8:11], s32 offen offset:0
    buffer_load_dwordx4 a[20:23], v2, s[8:11], s32 offen offset:1024
    buffer_load_dwordx4 a[24:27], v2, s[8:11], s32 offen offset:2048
    buffer_load_dwordx4 a[28:31], v2, s[8:11], s32 offen offset:3072
    ds_read_b128 v[100:103], v8 offset:0
    s_waitcnt vmcnt(28)
    s_waitcnt lgkmcnt(1)
    v_mfma_f32_16x16x32_bf16 v[16:19], a[32:35], v[96:99], v[16:19]
    v_mfma_f32_16x16x32_bf16 v[20:23], a[36:39], v[96:99], v[20:23]
    v_mfma_f32_16x16x32_bf16 v[24:27], a[40:43], v[96:99], v[24:27]
    v_mfma_f32_16x16x32_bf16 v[28:31], a[44:47], v[96:99], v[28:31]
    s_add_u32 s32, s31, 0x50000
    buffer_load_dwordx4 a[32:35], v2, s[8:11], s32 offen offset:0
    buffer_load_dwordx4 a[36:39], v2, s[8:11], s32 offen offset:1024
    buffer_load_dwordx4 a[40:43], v2, s[8:11], s32 offen offset:2048
    buffer_load_dwordx4 a[44:47], v2, s[8:11], s32 offen offset:3072
    ds_read_b128 v[96:99], v5 offset:256
    s_waitcnt vmcnt(28)
    s_waitcnt lgkmcnt(1)
    v_mfma_f32_16x16x32_bf16 v[16:19], a[48:51], v[100:103], v[16:19]
    v_mfma_f32_16x16x32_bf16 v[20:23], a[52:55], v[100:103], v[20:23]
    v_mfma_f32_16x16x32_bf16 v[24:27], a[56:59], v[100:103], v[24:27]
    v_mfma_f32_16x16x32_bf16 v[28:31], a[60:63], v[100:103], v[28:31]
    s_add_u32 s32, s31, 0x58000
    buffer_load_dwordx4 a[48:51], v2, s[8:11], s32 offen offset:0
    buffer_load_dwordx4 a[52:55], v2, s[8:11], s32 offen offset:1024
    buffer_load_dwordx4 a[56:59], v2, s[8:11], s32 offen offset:2048
    buffer_load_dwordx4 a[60:63], v2, s[8:11], s32 offen offset:3072
    ds_read_b128 v[100:103], v6 offset:256
    s_waitcnt vmcnt(28)
    s_waitcnt lgkmcnt(1)
    v_mfma_f32_16x16x32_bf16 v[16:19], a[64:67], v[96:99], v[16:19]
    v_mfma_f32_16x16x32_bf16 v[20:23], a[68:71], v[96:99], v[20:23]
    v_mfma_f32_16x16x32_bf16 v[24:27], a[72:75], v[96:99], v[24:27]
    v_mfma_f32_16x16x32_bf16 v[28:31], a[76:79], v[96:99], v[28:31]
    s_add_u32 s32, s31, 0x60000
    buffer_load_dwordx4 a[64:67], v2, s[8:11], s32 offen offset:0
    buffer_load_dwordx4 a[68:71], v2, s[8:11], s32 offen offset:1024
    buffer_load_dwordx4 a[72:75], v2, s[8:11], s32 offen offset:2048
    buffer_load_dwordx4 a[76:79], v2, s[8:11], s32 offen offset:3072
    ds_read_b128 v[96:99], v7 offset:256
    s_waitcnt vmcnt(28)
    s_waitcnt lgkmcnt(1)
    v_mfma_f32_16x16x32_bf16 v[16:19], a[80:83], v[100:103], v[16:19]
    v_mfma_f32_16x16x32_bf16 v[20:23], a[84:87], v[100:103], v[20:23]
    v_mfma_f32_16x16x32_bf16 v[24:27], a[88:91], v[100:103], v[24:27]
    v_mfma_f32_16x16x32_bf16 v[28:31], a[92:95], v[100:103], v[28:31]
    s_add_u32 s32, s31, 0x68000
    buffer_load_dwordx4 a[80:83], v2, s[8:11], s32 offen offset:0
    buffer_load_dwordx4 a[84:87], v2, s[8:11], s32 offen offset:1024
    buffer_load_dwordx4 a[88:91], v2, s[8:11], s32 offen offset:2048
    buffer_load_dwordx4 a[92:95], v2, s[8:11], s32 offen offset:3072
    ds_read_b128 v[100:103], v8 offset:256
    s_waitcnt vmcnt(28)
    s_waitcnt lgkmcnt(1)
    v_mfma_f32_16x16x32_bf16 v[16:19], a[96:99], v[96:99], v[16:19]
    v_mfma_f32_16x16x32_bf16 v[20:23], a[100:103], v[96:99], v[20:23]
    v_mfma_f32_16x16x32_bf16 v[24:27], a[104:107], v[96:99], v[24:27]
    v_mfma_f32_16x16x32_bf16 v[28:31], a[108:111], v[96:99], v[28:31]
    s_add_u32 s32, s31, 0x70000
    buffer_load_dwordx4 a[96:99], v2, s[8:11], s32 offen offset:0
    buffer_load_dwordx4 a[100:103], v2, s[8:11], s32 offen offset:1024
    buffer_load_dwordx4 a[104:107], v2, s[8:11], s32 offen offset:2048
    buffer_load_dwordx4 a[108:111], v2, s[8:11], s32 offen offset:3072
    ds_read_b128 v[96:99], v5 offset:512
    s_waitcnt vmcnt(28)
    s_waitcnt lgkmcnt(1)
    v_mfma_f32_16x16x32_bf16 v[16:19], a[112:115], v[100:103], v[16:19]
    v_mfma_f32_16x16x32_bf16 v[20:23], a[116:119], v[100:103], v[20:23]
    v_mfma_f32_16x16x32_bf16 v[24:27], a[120:123], v[100:103], v[24:27]
    v_mfma_f32_16x16x32_bf16 v[28:31], a[124:127], v[100:103], v[28:31]
    s_add_u32 s32, s31, 0x78000
    buffer_load_dwordx4 a[112:115], v2, s[8:11], s32 offen offset:0
    buffer_load_dwordx4 a[116:119], v2, s[8:11], s32 offen offset:1024
    buffer_load_dwordx4 a[120:123], v2, s[8:11], s32 offen offset:2048
    buffer_load_dwordx4 a[124:127], v2, s[8:11], s32 offen offset:3072
    ds_read_b128 v[100:103], v6 offset:512
    s_waitcnt vmcnt(28)
    s_waitcnt lgkmcnt(1)
    v_mfma_f32_16x16x32_bf16 v[16:19], a[0:3], v[96:99], v[16:19]
    v_mfma_f32_16x16x32_bf16 v[20:23], a[4:7], v[96:99], v[20:23]
    v_mfma_f32_16x16x32_bf16 v[24:27], a[8:11], v[96:99], v[24:27]
    v_mfma_f32_16x16x32_bf16 v[28:31], a[12:15], v[96:99], v[28:31]
    ds_read_b128 v[96:99], v7 offset:512
    s_waitcnt vmcnt(24)
    s_waitcnt lgkmcnt(1)
    v_mfma_f32_16x16x32_bf16 v[16:19], a[16:19], v[100:103], v[16:19]
    v_mfma_f32_16x16x32_bf16 v[20:23], a[20:23], v[100:103], v[20:23]
    v_mfma_f32_16x16x32_bf16 v[24:27], a[24:27], v[100:103], v[24:27]
    v_mfma_f32_16x16x32_bf16 v[28:31], a[28:31], v[100:103], v[28:31]
    ds_read_b128 v[100:103], v8 offset:512
    s_waitcnt vmcnt(20)
    s_waitcnt lgkmcnt(1)
    v_mfma_f32_16x16x32_bf16 v[16:19], a[32:35], v[96:99], v[16:19]
    v_mfma_f32_16x16x32_bf16 v[20:23], a[36:39], v[96:99], v[20:23]
    v_mfma_f32_16x16x32_bf16 v[24:27], a[40:43], v[96:99], v[24:27]
    v_mfma_f32_16x16x32_bf16 v[28:31], a[44:47], v[96:99], v[28:31]
    ds_read_b128 v[96:99], v5 offset:768
    s_waitcnt vmcnt(16)
    s_waitcnt lgkmcnt(1)
    v_mfma_f32_16x16x32_bf16 v[16:19], a[48:51], v[100:103], v[16:19]
    v_mfma_f32_16x16x32_bf16 v[20:23], a[52:55], v[100:103], v[20:23]
    v_mfma_f32_16x16x32_bf16 v[24:27], a[56:59], v[100:103], v[24:27]
    v_mfma_f32_16x16x32_bf16 v[28:31], a[60:63], v[100:103], v[28:31]
    ds_read_b128 v[100:103], v6 offset:768
    s_waitcnt vmcnt(12)
    s_waitcnt lgkmcnt(1)
    v_mfma_f32_16x16x32_bf16 v[16:19], a[64:67], v[96:99], v[16:19]
    v_mfma_f32_16x16x32_bf16 v[20:23], a[68:71], v[96:99], v[20:23]
    v_mfma_f32_16x16x32_bf16 v[24:27], a[72:75], v[96:99], v[24:27]
    v_mfma_f32_16x16x32_bf16 v[28:31], a[76:79], v[96:99], v[28:31]
    ds_read_b128 v[96:99], v7 offset:768
    s_waitcnt vmcnt(8)
    s_waitcnt lgkmcnt(1)
    v_mfma_f32_16x16x32_bf16 v[16:19], a[80:83], v[100:103], v[16:19]
    v_mfma_f32_16x16x32_bf16 v[20:23], a[84:87], v[100:103], v[20:23]
    v_mfma_f32_16x16x32_bf16 v[24:27], a[88:91], v[100:103], v[24:27]
    v_mfma_f32_16x16x32_bf16 v[28:31], a[92:95], v[100:103], v[28:31]
    ds_read_b128 v[100:103], v8 offset:768
    s_waitcnt vmcnt(4)
    s_waitcnt lgkmcnt(1)
    v_mfma_f32_16x16x32_bf16 v[16:19], a[96:99], v[96:99], v[16:19]
    v_mfma_f32_16x16x32_bf16 v[20:23], a[100:103], v[96:99], v[20:23]
    v_mfma_f32_16x16x32_bf16 v[24:27], a[104:107], v[96:99], v[24:27]
    v_mfma_f32_16x16x32_bf16 v[28:31], a[108:111], v[96:99], v[28:31]
    s_waitcnt vmcnt(0)
    s_waitcnt lgkmcnt(0)
    v_mfma_f32_16x16x32_bf16 v[16:19], a[112:115], v[100:103], v[16:19]
    v_mfma_f32_16x16x32_bf16 v[20:23], a[116:119], v[100:103], v[20:23]
    v_mfma_f32_16x16x32_bf16 v[24:27], a[120:123], v[100:103], v[24:27]
    v_mfma_f32_16x16x32_bf16 v[28:31], a[124:127], v[100:103], v[28:31]
    s_cmp_ge_u32 s30, 28
    s_cbranch_scc1 k2l1_kernel_done
    v_mul_u32_u24 v12, 896, v3
    v_lshl_add_u32 v12, v4, 3, v12
    s_mul_i32 s40, s28, 14336
    s_lshl_b32 s41, s30, 5
    s_add_u32 s40, s40, s41
    buffer_load_dwordx2 v[32:33], v12, s[4:7], s40 offen offset:0
    buffer_load_dwordx2 v[34:35], v12, s[4:7], s40 offen offset:32
    buffer_load_dwordx2 v[36:37], v12, s[4:7], s40 offen offset:64
    buffer_load_dwordx2 v[38:39], v12, s[4:7], s40 offen offset:96
    s_nop 7
    s_waitcnt vmcnt(0)
    v_cvt_pk_bf16_f32 v208, v16, v17
    v_lshlrev_b32 v209, 16, v208
    v_and_b32 v210, 0xffff0000, v208
    v_lshlrev_b32 v211, 16, v32
    v_and_b32 v212, 0xffff0000, v32
    v_add_f32 v209, v209, v211
    v_add_f32 v210, v210, v212
    v_cvt_pk_bf16_f32 v32, v209, v210
    v_cvt_pk_bf16_f32 v208, v18, v19
    v_lshlrev_b32 v209, 16, v208
    v_and_b32 v210, 0xffff0000, v208
    v_lshlrev_b32 v211, 16, v33
    v_and_b32 v212, 0xffff0000, v33
    v_add_f32 v209, v209, v211
    v_add_f32 v210, v210, v212
    v_cvt_pk_bf16_f32 v33, v209, v210
    buffer_store_dwordx2 v[32:33], v12, s[20:23], s40 offen offset:0
    v_cvt_pk_bf16_f32 v208, v20, v21
    v_lshlrev_b32 v209, 16, v208
    v_and_b32 v210, 0xffff0000, v208
    v_lshlrev_b32 v211, 16, v34
    v_and_b32 v212, 0xffff0000, v34
    v_add_f32 v209, v209, v211
    v_add_f32 v210, v210, v212
    v_cvt_pk_bf16_f32 v34, v209, v210
    v_cvt_pk_bf16_f32 v208, v22, v23
    v_lshlrev_b32 v209, 16, v208
    v_and_b32 v210, 0xffff0000, v208
    v_lshlrev_b32 v211, 16, v35
    v_and_b32 v212, 0xffff0000, v35
    v_add_f32 v209, v209, v211
    v_add_f32 v210, v210, v212
    v_cvt_pk_bf16_f32 v35, v209, v210
    buffer_store_dwordx2 v[34:35], v12, s[20:23], s40 offen offset:32
    v_cvt_pk_bf16_f32 v208, v24, v25
    v_lshlrev_b32 v209, 16, v208
    v_and_b32 v210, 0xffff0000, v208
    v_lshlrev_b32 v211, 16, v36
    v_and_b32 v212, 0xffff0000, v36
    v_add_f32 v209, v209, v211
    v_add_f32 v210, v210, v212
    v_cvt_pk_bf16_f32 v36, v209, v210
    v_cvt_pk_bf16_f32 v208, v26, v27
    v_lshlrev_b32 v209, 16, v208
    v_and_b32 v210, 0xffff0000, v208
    v_lshlrev_b32 v211, 16, v37
    v_and_b32 v212, 0xffff0000, v37
    v_add_f32 v209, v209, v211
    v_add_f32 v210, v210, v212
    v_cvt_pk_bf16_f32 v37, v209, v210
    buffer_store_dwordx2 v[36:37], v12, s[20:23], s40 offen offset:64
    v_cvt_pk_bf16_f32 v208, v28, v29
    v_lshlrev_b32 v209, 16, v208
    v_and_b32 v210, 0xffff0000, v208
    v_lshlrev_b32 v211, 16, v38
    v_and_b32 v212, 0xffff0000, v38
    v_add_f32 v209, v209, v211
    v_add_f32 v210, v210, v212
    v_cvt_pk_bf16_f32 v38, v209, v210
    v_cvt_pk_bf16_f32 v208, v30, v31
    v_lshlrev_b32 v209, 16, v208
    v_and_b32 v210, 0xffff0000, v208
    v_lshlrev_b32 v211, 16, v39
    v_and_b32 v212, 0xffff0000, v39
    v_add_f32 v209, v209, v211
    v_add_f32 v210, v210, v212
    v_cvt_pk_bf16_f32 v39, v209, v210
    buffer_store_dwordx2 v[38:39], v12, s[20:23], s40 offen offset:96
k2l1_kernel_done:
    s_endpgm
.globl k3l1_kernel
.p2align 8
.type k3l1_kernel,@function
k3l1_kernel:
    s_cmp_ge_u32 s2, 256
    s_cbranch_scc1 k3l1_kernel_done
    s_load_dwordx2 s[24:25], s[0:1], 88
    s_load_dwordx2 s[26:27], s[0:1], 48
    v_lshrrev_b32 v9, 6, v0
    v_and_b32 v1, 63, v0
    v_lshlrev_b32 v2, 4, v1
    v_and_b32 v3, 15, v1
    v_lshrrev_b32 v4, 4, v1
    v_readfirstlane_b32 s3, v9
    v_add_u32 v9, 0, v4
    v_xor_b32 v9, v9, v3
    v_lshlrev_b32 v9, 4, v9
    v_lshl_add_u32 v5, v3, 10, v9
    v_add_u32 v9, 4, v4
    v_xor_b32 v9, v9, v3
    v_lshlrev_b32 v9, 4, v9
    v_lshl_add_u32 v6, v3, 10, v9
    v_add_u32 v9, 8, v4
    v_xor_b32 v9, v9, v3
    v_lshlrev_b32 v9, 4, v9
    v_lshl_add_u32 v7, v3, 10, v9
    v_add_u32 v9, 12, v4
    v_xor_b32 v9, v9, v3
    v_lshlrev_b32 v9, 4, v9
    v_lshl_add_u32 v8, v3, 10, v9
    s_and_b32 s28, s2, 7
    s_lshl_b32 s28, s28, 3
    s_lshr_b32 s29, s2, 5
    s_add_u32 s28, s28, s29
    s_lshr_b32 s29, s2, 3
    s_and_b32 s29, s29, 3
    s_mul_i32 s29, s29, 28
    s_mul_i32 s35, s3, 7
    s_add_u32 s29, s29, s35
    v_lshlrev_b32 v12, 3, v4
    s_lshl_b32 s36, s29, 5
    v_mul_u32_u24 v13, 3584, v3
    v_lshl_add_u32 v13, v4, 3, v13
    s_mul_i32 s37, s28, 114688
    s_add_u32 s37, s37, s36
    s_add_u32 s38, s37, 57344
    s_waitcnt lgkmcnt(0)
    s_add_u32 s4, s24, 0xd38000
    s_addc_u32 s5, s25, 0
    s_mov_b32 s6, 0x1c0000
    s_mov_b32 s7, 0x00020000
    s_add_u32 s8, s24, 0x1d0000
    s_addc_u32 s9, s25, 0
    s_mov_b32 s10, 0x188000
    s_mov_b32 s11, 0x00020000
    s_mov_b32 s12, s26
    s_mov_b32 s13, s27
    s_mov_b32 s14, 0xe00
    s_mov_b32 s15, 0x00020000
    s_add_u32 s16, s24, 0x1678000
    s_addc_u32 s17, s25, 0
    s_mov_b32 s18, 0x700000
    s_mov_b32 s19, 0x00020000
    s_mul_i32 s30, s28, 28672
    s_lshl_b32 s31, s29, 10
    v_lshrrev_b32 v9, 3, v0
    v_mul_u32_u24 v9, 896, v9
    v_and_b32 v10, 7, v0
    v_lshl_add_u32 v10, v10, 4, v9
    buffer_load_dwordx4 v[88:91], v10, s[4:7], s30 offen offset:0
    buffer_load_dwordx4 v[92:95], v10, s[4:7], s30 offen offset:128
    buffer_load_dwordx4 v[96:99], v10, s[4:7], s30 offen offset:256
    buffer_load_dwordx4 v[100:103], v10, s[4:7], s30 offen offset:384
    buffer_load_dwordx4 v[104:107], v10, s[4:7], s30 offen offset:512
    buffer_load_dwordx4 v[108:111], v10, s[4:7], s30 offen offset:640
    buffer_load_dwordx4 v[112:115], v10, s[4:7], s30 offen offset:768
    buffer_load_dwordx2 v[140:141], v12, s[12:15], s36 offen offset:0
    buffer_load_dwordx2 v[142:143], v12, s[12:15], s36 offen offset:32
    buffer_load_dwordx2 v[144:145], v12, s[12:15], s36 offen offset:64
    buffer_load_dwordx2 v[146:147], v12, s[12:15], s36 offen offset:96
    buffer_load_dwordx2 v[148:149], v12, s[12:15], s36 offen offset:128
    buffer_load_dwordx2 v[150:151], v12, s[12:15], s36 offen offset:160
    buffer_load_dwordx2 v[152:153], v12, s[12:15], s36 offen offset:192
    s_add_u32 s33, s31, 0x0
    buffer_load_dwordx4 a[0:3], v2, s[8:11], s33 offen offset:0
    buffer_load_dwordx4 a[4:7], v2, s[8:11], s33 offen offset:1024
    buffer_load_dwordx4 a[8:11], v2, s[8:11], s33 offen offset:2048
    buffer_load_dwordx4 a[12:15], v2, s[8:11], s33 offen offset:3072
    s_add_u32 s33, s31, 0x1000
    buffer_load_dwordx4 a[16:19], v2, s[8:11], s33 offen offset:0
    buffer_load_dwordx4 a[20:23], v2, s[8:11], s33 offen offset:1024
    buffer_load_dwordx4 a[24:27], v2, s[8:11], s33 offen offset:2048
    s_add_u32 s33, s31, 0x1c000
    buffer_load_dwordx4 a[28:31], v2, s[8:11], s33 offen offset:0
    buffer_load_dwordx4 a[32:35], v2, s[8:11], s33 offen offset:1024
    buffer_load_dwordx4 a[36:39], v2, s[8:11], s33 offen offset:2048
    buffer_load_dwordx4 a[40:43], v2, s[8:11], s33 offen offset:3072
    s_add_u32 s33, s31, 0x1d000
    buffer_load_dwordx4 a[44:47], v2, s[8:11], s33 offen offset:0
    buffer_load_dwordx4 a[48:51], v2, s[8:11], s33 offen offset:1024
    buffer_load_dwordx4 a[52:55], v2, s[8:11], s33 offen offset:2048
    s_add_u32 s33, s31, 0x38000
    buffer_load_dwordx4 a[56:59], v2, s[8:11], s33 offen offset:0
    buffer_load_dwordx4 a[60:63], v2, s[8:11], s33 offen offset:1024
    buffer_load_dwordx4 a[64:67], v2, s[8:11], s33 offen offset:2048
    buffer_load_dwordx4 a[68:71], v2, s[8:11], s33 offen offset:3072
    s_add_u32 s33, s31, 0x39000
    buffer_load_dwordx4 a[72:75], v2, s[8:11], s33 offen offset:0
    buffer_load_dwordx4 a[76:79], v2, s[8:11], s33 offen offset:1024
    buffer_load_dwordx4 a[80:83], v2, s[8:11], s33 offen offset:2048
    s_add_u32 s33, s31, 0x54000
    buffer_load_dwordx4 a[84:87], v2, s[8:11], s33 offen offset:0
    buffer_load_dwordx4 a[88:91], v2, s[8:11], s33 offen offset:1024
    buffer_load_dwordx4 a[92:95], v2, s[8:11], s33 offen offset:2048
    buffer_load_dwordx4 a[96:99], v2, s[8:11], s33 offen offset:3072
    s_add_u32 s33, s31, 0x55000
    buffer_load_dwordx4 a[100:103], v2, s[8:11], s33 offen offset:0
    buffer_load_dwordx4 a[104:107], v2, s[8:11], s33 offen offset:1024
    buffer_load_dwordx4 a[108:111], v2, s[8:11], s33 offen offset:2048
    s_add_u32 s33, s31, 0x70000
    buffer_load_dwordx4 a[112:115], v2, s[8:11], s33 offen offset:0
    buffer_load_dwordx4 a[116:119], v2, s[8:11], s33 offen offset:1024
    buffer_load_dwordx4 a[120:123], v2, s[8:11], s33 offen offset:2048
    buffer_load_dwordx4 a[124:127], v2, s[8:11], s33 offen offset:3072
    s_add_u32 s33, s31, 0x71000
    buffer_load_dwordx4 a[128:131], v2, s[8:11], s33 offen offset:0
    buffer_load_dwordx4 a[132:135], v2, s[8:11], s33 offen offset:1024
    buffer_load_dwordx4 a[136:139], v2, s[8:11], s33 offen offset:2048
    s_add_u32 s33, s31, 0x8c000
    buffer_load_dwordx4 a[140:143], v2, s[8:11], s33 offen offset:0
    buffer_load_dwordx4 a[144:147], v2, s[8:11], s33 offen offset:1024
    buffer_load_dwordx4 a[148:151], v2, s[8:11], s33 offen offset:2048
    buffer_load_dwordx4 a[152:155], v2, s[8:11], s33 offen offset:3072
    s_add_u32 s33, s31, 0x8d000
    buffer_load_dwordx4 a[156:159], v2, s[8:11], s33 offen offset:0
    buffer_load_dwordx4 a[160:163], v2, s[8:11], s33 offen offset:1024
    buffer_load_dwordx4 a[164:167], v2, s[8:11], s33 offen offset:2048
    s_add_u32 s33, s31, 0xa8000
    buffer_load_dwordx4 a[168:171], v2, s[8:11], s33 offen offset:0
    buffer_load_dwordx4 a[172:175], v2, s[8:11], s33 offen offset:1024
    buffer_load_dwordx4 a[176:179], v2, s[8:11], s33 offen offset:2048
    buffer_load_dwordx4 a[180:183], v2, s[8:11], s33 offen offset:3072
    s_add_u32 s33, s31, 0xa9000
    buffer_load_dwordx4 a[184:187], v2, s[8:11], s33 offen offset:0
    buffer_load_dwordx4 a[188:191], v2, s[8:11], s33 offen offset:1024
    buffer_load_dwordx4 a[192:195], v2, s[8:11], s33 offen offset:2048
    s_add_u32 s33, s31, 0xc4000
    buffer_load_dwordx4 a[196:199], v2, s[8:11], s33 offen offset:0
    buffer_load_dwordx4 a[200:203], v2, s[8:11], s33 offen offset:1024
    buffer_load_dwordx4 a[204:207], v2, s[8:11], s33 offen offset:2048
    buffer_load_dwordx4 a[208:211], v2, s[8:11], s33 offen offset:3072
    s_add_u32 s33, s31, 0xc5000
    buffer_load_dwordx4 a[212:215], v2, s[8:11], s33 offen offset:0
    buffer_load_dwordx4 a[216:219], v2, s[8:11], s33 offen offset:1024
    buffer_load_dwordx4 a[220:223], v2, s[8:11], s33 offen offset:2048
    s_waitcnt vmcnt(63)
    s_mov_b32 s34, 0x3f803f80
    v_mov_b32 v116, 0
    v_mov_b32 v117, 0
    v_mov_b32 v118, 0
    v_mov_b32 v119, 0
    v_dot2_f32_bf16 v116, v88, s34, v116
    v_dot2_f32_bf16 v118, v88, v88, v118
    v_dot2_f32_bf16 v117, v89, s34, v117
    v_dot2_f32_bf16 v119, v89, v89, v119
    v_dot2_f32_bf16 v116, v90, s34, v116
    v_dot2_f32_bf16 v118, v90, v90, v118
    v_dot2_f32_bf16 v117, v91, s34, v117
    v_dot2_f32_bf16 v119, v91, v91, v119
    v_dot2_f32_bf16 v116, v92, s34, v116
    v_dot2_f32_bf16 v118, v92, v92, v118
    v_dot2_f32_bf16 v117, v93, s34, v117
    v_dot2_f32_bf16 v119, v93, v93, v119
    v_dot2_f32_bf16 v116, v94, s34, v116
    v_dot2_f32_bf16 v118, v94, v94, v118
    v_dot2_f32_bf16 v117, v95, s34, v117
    v_dot2_f32_bf16 v119, v95, v95, v119
    v_dot2_f32_bf16 v116, v96, s34, v116
    v_dot2_f32_bf16 v118, v96, v96, v118
    v_dot2_f32_bf16 v117, v97, s34, v117
    v_dot2_f32_bf16 v119, v97, v97, v119
    v_dot2_f32_bf16 v116, v98, s34, v116
    v_dot2_f32_bf16 v118, v98, v98, v118
    v_dot2_f32_bf16 v117, v99, s34, v117
    v_dot2_f32_bf16 v119, v99, v99, v119
    v_dot2_f32_bf16 v116, v100, s34, v116
    v_dot2_f32_bf16 v118, v100, v100, v118
    v_dot2_f32_bf16 v117, v101, s34, v117
    v_dot2_f32_bf16 v119, v101, v101, v119
    v_dot2_f32_bf16 v116, v102, s34, v116
    v_dot2_f32_bf16 v118, v102, v102, v118
    v_dot2_f32_bf16 v117, v103, s34, v117
    v_dot2_f32_bf16 v119, v103, v103, v119
    v_dot2_f32_bf16 v116, v104, s34, v116
    v_dot2_f32_bf16 v118, v104, v104, v118
    v_dot2_f32_bf16 v117, v105, s34, v117
    v_dot2_f32_bf16 v119, v105, v105, v119
    v_dot2_f32_bf16 v116, v106, s34, v116
    v_dot2_f32_bf16 v118, v106, v106, v118
    v_dot2_f32_bf16 v117, v107, s34, v117
    v_dot2_f32_bf16 v119, v107, v107, v119
    v_dot2_f32_bf16 v116, v108, s34, v116
    v_dot2_f32_bf16 v118, v108, v108, v118
    v_dot2_f32_bf16 v117, v109, s34, v117
    v_dot2_f32_bf16 v119, v109, v109, v119
    v_dot2_f32_bf16 v116, v110, s34, v116
    v_dot2_f32_bf16 v118, v110, v110, v118
    v_dot2_f32_bf16 v117, v111, s34, v117
    v_dot2_f32_bf16 v119, v111, v111, v119
    v_dot2_f32_bf16 v116, v112, s34, v116
    v_dot2_f32_bf16 v118, v112, v112, v118
    v_dot2_f32_bf16 v117, v113, s34, v117
    v_dot2_f32_bf16 v119, v113, v113, v119
    v_dot2_f32_bf16 v116, v114, s34, v116
    v_dot2_f32_bf16 v118, v114, v114, v118
    v_dot2_f32_bf16 v117, v115, s34, v117
    v_dot2_f32_bf16 v119, v115, v115, v119
    s_nop 3
    v_add_f32 v116, v116, v117
    v_add_f32 v118, v118, v119
    s_nop 1
    v_add_f32_dpp v117, v116, v116 quad_perm:[1,0,3,2] row_mask:0xf bank_mask:0xf
    v_add_f32_dpp v119, v118, v118 quad_perm:[1,0,3,2] row_mask:0xf bank_mask:0xf
    v_mov_b32 v116, v117
    v_mov_b32 v118, v119
    s_nop 1
    v_add_f32_dpp v117, v116, v116 quad_perm:[2,3,0,1] row_mask:0xf bank_mask:0xf
    v_add_f32_dpp v119, v118, v118 quad_perm:[2,3,0,1] row_mask:0xf bank_mask:0xf
    v_mov_b32 v116, v117
    v_mov_b32 v118, v119
    s_nop 1
    v_add_f32_dpp v117, v116, v116 row_half_mirror row_mask:0xf bank_mask:0xf
    v_add_f32_dpp v119, v118, v118 row_half_mirror row_mask:0xf bank_mask:0xf
    v_mov_b32 v116, v117
    v_mov_b32 v118, v119
    s_mov_b32 s34, 0x3b124925
    v_mul_f32 v120, s34, v116
    v_mul_f32 v121, s34, v118
    v_fma_f32 v121, -v120, v120, v121
    v_max_f32 v121, 0, v121
    v_cvt_pk_bf16_f32 v122, v120, v121
    v_lshlrev_b32 v124, 16, v122
    v_sub_f32 v124, 0, v124
    v_mov_b32 v125, v124
    v_and_b32 v121, 0xffff0000, v122
    s_mov_b32 s34, 0x3727c5ac
    v_add_f32 v121, s34, v121
    v_cvt_pk_bf16_f32 v122, v121, v121
    v_lshlrev_b32 v121, 16, v122
    v_sqrt_f32 v121, v121
    s_nop 0
    v_cvt_pk_bf16_f32 v122, v121, v121
    v_lshlrev_b32 v121, 16, v122
    v_rcp_f32 v126, v121
    s_nop 0
    v_mov_b32 v127, v126
    v_lshlrev_b32 v128, 16, v88
    v_and_b32 v129, 0xffff0000, v88
    v_lshlrev_b32 v130, 16, v89
    v_and_b32 v131, 0xffff0000, v89
    v_lshlrev_b32 v132, 16, v90
    v_and_b32 v133, 0xffff0000, v90
    v_lshlrev_b32 v134, 16, v91
    v_and_b32 v135, 0xffff0000, v91
    v_pk_add_f32 v[128:129], v[128:129], v[124:125]
    v_pk_add_f32 v[130:131], v[130:131], v[124:125]
    v_pk_add_f32 v[132:133], v[132:133], v[124:125]
    v_pk_add_f32 v[134:135], v[134:135], v[124:125]
    v_cvt_pk_bf16_f32 v88, v128, v129
    v_cvt_pk_bf16_f32 v89, v130, v131
    v_cvt_pk_bf16_f32 v90, v132, v133
    v_cvt_pk_bf16_f32 v91, v134, v135
    v_lshlrev_b32 v128, 16, v88
    v_and_b32 v129, 0xffff0000, v88
    v_lshlrev_b32 v130, 16, v89
    v_and_b32 v131, 0xffff0000, v89
    v_lshlrev_b32 v132, 16, v90
    v_and_b32 v133, 0xffff0000, v90
    v_lshlrev_b32 v134, 16, v91
    v_and_b32 v135, 0xffff0000, v91
    v_pk_mul_f32 v[128:129], v[128:129], v[126:127]
    v_pk_mul_f32 v[130:131], v[130:131], v[126:127]
    v_pk_mul_f32 v[132:133], v[132:133], v[126:127]
    v_pk_mul_f32 v[134:135], v[134:135], v[126:127]
    v_cvt_pk_bf16_f32 v88, v128, v129
    v_cvt_pk_bf16_f32 v89, v130, v131
    v_cvt_pk_bf16_f32 v90, v132, v133
    v_cvt_pk_bf16_f32 v91, v134, v135
    v_lshlrev_b32 v128, 16, v92
    v_and_b32 v129, 0xffff0000, v92
    v_lshlrev_b32 v130, 16, v93
    v_and_b32 v131, 0xffff0000, v93
    v_lshlrev_b32 v132, 16, v94
    v_and_b32 v133, 0xffff0000, v94
    v_lshlrev_b32 v134, 16, v95
    v_and_b32 v135, 0xffff0000, v95
    v_pk_add_f32 v[128:129], v[128:129], v[124:125]
    v_pk_add_f32 v[130:131], v[130:131], v[124:125]
    v_pk_add_f32 v[132:133], v[132:133], v[124:125]
    v_pk_add_f32 v[134:135], v[134:135], v[124:125]
    v_cvt_pk_bf16_f32 v92, v128, v129
    v_cvt_pk_bf16_f32 v93, v130, v131
    v_cvt_pk_bf16_f32 v94, v132, v133
    v_cvt_pk_bf16_f32 v95, v134, v135
    v_lshlrev_b32 v128, 16, v92
    v_and_b32 v129, 0xffff0000, v92
    v_lshlrev_b32 v130, 16, v93
    v_and_b32 v131, 0xffff0000, v93
    v_lshlrev_b32 v132, 16, v94
    v_and_b32 v133, 0xffff0000, v94
    v_lshlrev_b32 v134, 16, v95
    v_and_b32 v135, 0xffff0000, v95
    v_pk_mul_f32 v[128:129], v[128:129], v[126:127]
    v_pk_mul_f32 v[130:131], v[130:131], v[126:127]
    v_pk_mul_f32 v[132:133], v[132:133], v[126:127]
    v_pk_mul_f32 v[134:135], v[134:135], v[126:127]
    v_cvt_pk_bf16_f32 v92, v128, v129
    v_cvt_pk_bf16_f32 v93, v130, v131
    v_cvt_pk_bf16_f32 v94, v132, v133
    v_cvt_pk_bf16_f32 v95, v134, v135
    v_lshlrev_b32 v128, 16, v96
    v_and_b32 v129, 0xffff0000, v96
    v_lshlrev_b32 v130, 16, v97
    v_and_b32 v131, 0xffff0000, v97
    v_lshlrev_b32 v132, 16, v98
    v_and_b32 v133, 0xffff0000, v98
    v_lshlrev_b32 v134, 16, v99
    v_and_b32 v135, 0xffff0000, v99
    v_pk_add_f32 v[128:129], v[128:129], v[124:125]
    v_pk_add_f32 v[130:131], v[130:131], v[124:125]
    v_pk_add_f32 v[132:133], v[132:133], v[124:125]
    v_pk_add_f32 v[134:135], v[134:135], v[124:125]
    v_cvt_pk_bf16_f32 v96, v128, v129
    v_cvt_pk_bf16_f32 v97, v130, v131
    v_cvt_pk_bf16_f32 v98, v132, v133
    v_cvt_pk_bf16_f32 v99, v134, v135
    v_lshlrev_b32 v128, 16, v96
    v_and_b32 v129, 0xffff0000, v96
    v_lshlrev_b32 v130, 16, v97
    v_and_b32 v131, 0xffff0000, v97
    v_lshlrev_b32 v132, 16, v98
    v_and_b32 v133, 0xffff0000, v98
    v_lshlrev_b32 v134, 16, v99
    v_and_b32 v135, 0xffff0000, v99
    v_pk_mul_f32 v[128:129], v[128:129], v[126:127]
    v_pk_mul_f32 v[130:131], v[130:131], v[126:127]
    v_pk_mul_f32 v[132:133], v[132:133], v[126:127]
    v_pk_mul_f32 v[134:135], v[134:135], v[126:127]
    v_cvt_pk_bf16_f32 v96, v128, v129
    v_cvt_pk_bf16_f32 v97, v130, v131
    v_cvt_pk_bf16_f32 v98, v132, v133
    v_cvt_pk_bf16_f32 v99, v134, v135
    v_lshlrev_b32 v128, 16, v100
    v_and_b32 v129, 0xffff0000, v100
    v_lshlrev_b32 v130, 16, v101
    v_and_b32 v131, 0xffff0000, v101
    v_lshlrev_b32 v132, 16, v102
    v_and_b32 v133, 0xffff0000, v102
    v_lshlrev_b32 v134, 16, v103
    v_and_b32 v135, 0xffff0000, v103
    v_pk_add_f32 v[128:129], v[128:129], v[124:125]
    v_pk_add_f32 v[130:131], v[130:131], v[124:125]
    v_pk_add_f32 v[132:133], v[132:133], v[124:125]
    v_pk_add_f32 v[134:135], v[134:135], v[124:125]
    v_cvt_pk_bf16_f32 v100, v128, v129
    v_cvt_pk_bf16_f32 v101, v130, v131
    v_cvt_pk_bf16_f32 v102, v132, v133
    v_cvt_pk_bf16_f32 v103, v134, v135
    v_lshlrev_b32 v128, 16, v100
    v_and_b32 v129, 0xffff0000, v100
    v_lshlrev_b32 v130, 16, v101
    v_and_b32 v131, 0xffff0000, v101
    v_lshlrev_b32 v132, 16, v102
    v_and_b32 v133, 0xffff0000, v102
    v_lshlrev_b32 v134, 16, v103
    v_and_b32 v135, 0xffff0000, v103
    v_pk_mul_f32 v[128:129], v[128:129], v[126:127]
    v_pk_mul_f32 v[130:131], v[130:131], v[126:127]
    v_pk_mul_f32 v[132:133], v[132:133], v[126:127]
    v_pk_mul_f32 v[134:135], v[134:135], v[126:127]
    v_cvt_pk_bf16_f32 v100, v128, v129
    v_cvt_pk_bf16_f32 v101, v130, v131
    v_cvt_pk_bf16_f32 v102, v132, v133
    v_cvt_pk_bf16_f32 v103, v134, v135
    v_lshlrev_b32 v128, 16, v104
    v_and_b32 v129, 0xffff0000, v104
    v_lshlrev_b32 v130, 16, v105
    v_and_b32 v131, 0xffff0000, v105
    v_lshlrev_b32 v132, 16, v106
    v_and_b32 v133, 0xffff0000, v106
    v_lshlrev_b32 v134, 16, v107
    v_and_b32 v135, 0xffff0000, v107
    v_pk_add_f32 v[128:129], v[128:129], v[124:125]
    v_pk_add_f32 v[130:131], v[130:131], v[124:125]
    v_pk_add_f32 v[132:133], v[132:133], v[124:125]
    v_pk_add_f32 v[134:135], v[134:135], v[124:125]
    v_cvt_pk_bf16_f32 v104, v128, v129
    v_cvt_pk_bf16_f32 v105, v130, v131
    v_cvt_pk_bf16_f32 v106, v132, v133
    v_cvt_pk_bf16_f32 v107, v134, v135
    v_lshlrev_b32 v128, 16, v104
    v_and_b32 v129, 0xffff0000, v104
    v_lshlrev_b32 v130, 16, v105
    v_and_b32 v131, 0xffff0000, v105
    v_lshlrev_b32 v132, 16, v106
    v_and_b32 v133, 0xffff0000, v106
    v_lshlrev_b32 v134, 16, v107
    v_and_b32 v135, 0xffff0000, v107
    v_pk_mul_f32 v[128:129], v[128:129], v[126:127]
    v_pk_mul_f32 v[130:131], v[130:131], v[126:127]
    v_pk_mul_f32 v[132:133], v[132:133], v[126:127]
    v_pk_mul_f32 v[134:135], v[134:135], v[126:127]
    v_cvt_pk_bf16_f32 v104, v128, v129
    v_cvt_pk_bf16_f32 v105, v130, v131
    v_cvt_pk_bf16_f32 v106, v132, v133
    v_cvt_pk_bf16_f32 v107, v134, v135
    v_lshlrev_b32 v128, 16, v108
    v_and_b32 v129, 0xffff0000, v108
    v_lshlrev_b32 v130, 16, v109
    v_and_b32 v131, 0xffff0000, v109
    v_lshlrev_b32 v132, 16, v110
    v_and_b32 v133, 0xffff0000, v110
    v_lshlrev_b32 v134, 16, v111
    v_and_b32 v135, 0xffff0000, v111
    v_pk_add_f32 v[128:129], v[128:129], v[124:125]
    v_pk_add_f32 v[130:131], v[130:131], v[124:125]
    v_pk_add_f32 v[132:133], v[132:133], v[124:125]
    v_pk_add_f32 v[134:135], v[134:135], v[124:125]
    v_cvt_pk_bf16_f32 v108, v128, v129
    v_cvt_pk_bf16_f32 v109, v130, v131
    v_cvt_pk_bf16_f32 v110, v132, v133
    v_cvt_pk_bf16_f32 v111, v134, v135
    v_lshlrev_b32 v128, 16, v108
    v_and_b32 v129, 0xffff0000, v108
    v_lshlrev_b32 v130, 16, v109
    v_and_b32 v131, 0xffff0000, v109
    v_lshlrev_b32 v132, 16, v110
    v_and_b32 v133, 0xffff0000, v110
    v_lshlrev_b32 v134, 16, v111
    v_and_b32 v135, 0xffff0000, v111
    v_pk_mul_f32 v[128:129], v[128:129], v[126:127]
    v_pk_mul_f32 v[130:131], v[130:131], v[126:127]
    v_pk_mul_f32 v[132:133], v[132:133], v[126:127]
    v_pk_mul_f32 v[134:135], v[134:135], v[126:127]
    v_cvt_pk_bf16_f32 v108, v128, v129
    v_cvt_pk_bf16_f32 v109, v130, v131
    v_cvt_pk_bf16_f32 v110, v132, v133
    v_cvt_pk_bf16_f32 v111, v134, v135
    v_lshlrev_b32 v128, 16, v112
    v_and_b32 v129, 0xffff0000, v112
    v_lshlrev_b32 v130, 16, v113
    v_and_b32 v131, 0xffff0000, v113
    v_lshlrev_b32 v132, 16, v114
    v_and_b32 v133, 0xffff0000, v114
    v_lshlrev_b32 v134, 16, v115
    v_and_b32 v135, 0xffff0000, v115
    v_pk_add_f32 v[128:129], v[128:129], v[124:125]
    v_pk_add_f32 v[130:131], v[130:131], v[124:125]
    v_pk_add_f32 v[132:133], v[132:133], v[124:125]
    v_pk_add_f32 v[134:135], v[134:135], v[124:125]
    v_cvt_pk_bf16_f32 v112, v128, v129
    v_cvt_pk_bf16_f32 v113, v130, v131
    v_cvt_pk_bf16_f32 v114, v132, v133
    v_cvt_pk_bf16_f32 v115, v134, v135
    v_lshlrev_b32 v128, 16, v112
    v_and_b32 v129, 0xffff0000, v112
    v_lshlrev_b32 v130, 16, v113
    v_and_b32 v131, 0xffff0000, v113
    v_lshlrev_b32 v132, 16, v114
    v_and_b32 v133, 0xffff0000, v114
    v_lshlrev_b32 v134, 16, v115
    v_and_b32 v135, 0xffff0000, v115
    v_pk_mul_f32 v[128:129], v[128:129], v[126:127]
    v_pk_mul_f32 v[130:131], v[130:131], v[126:127]
    v_pk_mul_f32 v[132:133], v[132:133], v[126:127]
    v_pk_mul_f32 v[134:135], v[134:135], v[126:127]
    v_cvt_pk_bf16_f32 v112, v128, v129
    v_cvt_pk_bf16_f32 v113, v130, v131
    v_cvt_pk_bf16_f32 v114, v132, v133
    v_cvt_pk_bf16_f32 v115, v134, v135
    v_lshrrev_b32 v116, 3, v0
    v_and_b32 v117, 7, v0
    v_and_b32 v118, 15, v116
    v_xor_b32 v119, v117, v118
    v_lshlrev_b32 v119, 4, v119
    v_add_u32 v117, 8, v117
    v_xor_b32 v118, v117, v118
    v_lshlrev_b32 v118, 4, v118
    v_lshlrev_b32 v116, 10, v116
    v_add_u32 v119, v119, v116
    v_add_u32 v118, v118, v116
    ds_write_b128 v119, v[88:91] offset:0
    ds_write_b128 v118, v[92:95] offset:0
    ds_write_b128 v119, v[96:99] offset:256
    ds_write_b128 v118, v[100:103] offset:256
    ds_write_b128 v119, v[104:107] offset:512
    ds_write_b128 v118, v[108:111] offset:512
    ds_write_b128 v119, v[112:115] offset:768
    s_waitcnt lgkmcnt(0)
    s_barrier
    ds_read_b128 v[72:75], v5 offset:0
    ds_read_b128 v[76:79], v5 offset:16384
    ds_read_b128 v[80:83], v6 offset:0
    ds_read_b128 v[84:87], v6 offset:16384
    s_waitcnt vmcnt(49)
    s_waitcnt lgkmcnt(2)
    v_mfma_f32_16x16x32_bf16 v[16:19], a[0:3], v[72:75], 0
    v_mfma_f32_16x16x32_bf16 v[20:23], a[0:3], v[76:79], 0
    v_mfma_f32_16x16x32_bf16 v[24:27], a[4:7], v[72:75], 0
    v_mfma_f32_16x16x32_bf16 v[28:31], a[4:7], v[76:79], 0
    v_mfma_f32_16x16x32_bf16 v[32:35], a[8:11], v[72:75], 0
    v_mfma_f32_16x16x32_bf16 v[36:39], a[8:11], v[76:79], 0
    v_mfma_f32_16x16x32_bf16 v[40:43], a[12:15], v[72:75], 0
    v_mfma_f32_16x16x32_bf16 v[44:47], a[12:15], v[76:79], 0
    v_mfma_f32_16x16x32_bf16 v[48:51], a[16:19], v[72:75], 0
    v_mfma_f32_16x16x32_bf16 v[52:55], a[16:19], v[76:79], 0
    v_mfma_f32_16x16x32_bf16 v[56:59], a[20:23], v[72:75], 0
    v_mfma_f32_16x16x32_bf16 v[60:63], a[20:23], v[76:79], 0
    v_mfma_f32_16x16x32_bf16 v[64:67], a[24:27], v[72:75], 0
    v_mfma_f32_16x16x32_bf16 v[68:71], a[24:27], v[76:79], 0
    s_add_u32 s33, s31, 0xe0000
    buffer_load_dwordx4 a[0:3], v2, s[8:11], s33 offen offset:0
    buffer_load_dwordx4 a[4:7], v2, s[8:11], s33 offen offset:1024
    buffer_load_dwordx4 a[8:11], v2, s[8:11], s33 offen offset:2048
    buffer_load_dwordx4 a[12:15], v2, s[8:11], s33 offen offset:3072
    s_add_u32 s33, s31, 0xe1000
    buffer_load_dwordx4 a[16:19], v2, s[8:11], s33 offen offset:0
    buffer_load_dwordx4 a[20:23], v2, s[8:11], s33 offen offset:1024
    buffer_load_dwordx4 a[24:27], v2, s[8:11], s33 offen offset:2048
    ds_read_b128 v[72:75], v7 offset:0
    ds_read_b128 v[76:79], v7 offset:16384
    s_waitcnt vmcnt(49)
    s_waitcnt lgkmcnt(2)
    v_mfma_f32_16x16x32_bf16 v[16:19], a[28:31], v[80:83], v[16:19]
    v_mfma_f32_16x16x32_bf16 v[20:23], a[28:31], v[84:87], v[20:23]
    v_mfma_f32_16x16x32_bf16 v[24:27], a[32:35], v[80:83], v[24:27]
    v_mfma_f32_16x16x32_bf16 v[28:31], a[32:35], v[84:87], v[28:31]
    v_mfma_f32_16x16x32_bf16 v[32:35], a[36:39], v[80:83], v[32:35]
    v_mfma_f32_16x16x32_bf16 v[36:39], a[36:39], v[84:87], v[36:39]
    v_mfma_f32_16x16x32_bf16 v[40:43], a[40:43], v[80:83], v[40:43]
    v_mfma_f32_16x16x32_bf16 v[44:47], a[40:43], v[84:87], v[44:47]
    v_mfma_f32_16x16x32_bf16 v[48:51], a[44:47], v[80:83], v[48:51]
    v_mfma_f32_16x16x32_bf16 v[52:55], a[44:47], v[84:87], v[52:55]
    v_mfma_f32_16x16x32_bf16 v[56:59], a[48:51], v[80:83], v[56:59]
    v_mfma_f32_16x16x32_bf16 v[60:63], a[48:51], v[84:87], v[60:63]
    v_mfma_f32_16x16x32_bf16 v[64:67], a[52:55], v[80:83], v[64:67]
    v_mfma_f32_16x16x32_bf16 v[68:71], a[52:55], v[84:87], v[68:71]
    s_add_u32 s33, s31, 0xfc000
    buffer_load_dwordx4 a[28:31], v2, s[8:11], s33 offen offset:0
    buffer_load_dwordx4 a[32:35], v2, s[8:11], s33 offen offset:1024
    buffer_load_dwordx4 a[36:39], v2, s[8:11], s33 offen offset:2048
    buffer_load_dwordx4 a[40:43], v2, s[8:11], s33 offen offset:3072
    s_add_u32 s33, s31, 0xfd000
    buffer_load_dwordx4 a[44:47], v2, s[8:11], s33 offen offset:0
    buffer_load_dwordx4 a[48:51], v2, s[8:11], s33 offen offset:1024
    buffer_load_dwordx4 a[52:55], v2, s[8:11], s33 offen offset:2048
    ds_read_b128 v[80:83], v8 offset:0
    ds_read_b128 v[84:87], v8 offset:16384
    s_waitcnt vmcnt(49)
    s_waitcnt lgkmcnt(2)
    v_mfma_f32_16x16x32_bf16 v[16:19], a[56:59], v[72:75], v[16:19]
    v_mfma_f32_16x16x32_bf16 v[20:23], a[56:59], v[76:79], v[20:23]
    v_mfma_f32_16x16x32_bf16 v[24:27], a[60:63], v[72:75], v[24:27]
    v_mfma_f32_16x16x32_bf16 v[28:31], a[60:63], v[76:79], v[28:31]
    v_mfma_f32_16x16x32_bf16 v[32:35], a[64:67], v[72:75], v[32:35]
    v_mfma_f32_16x16x32_bf16 v[36:39], a[64:67], v[76:79], v[36:39]
    v_mfma_f32_16x16x32_bf16 v[40:43], a[68:71], v[72:75], v[40:43]
    v_mfma_f32_16x16x32_bf16 v[44:47], a[68:71], v[76:79], v[44:47]
    v_mfma_f32_16x16x32_bf16 v[48:51], a[72:75], v[72:75], v[48:51]
    v_mfma_f32_16x16x32_bf16 v[52:55], a[72:75], v[76:79], v[52:55]
    v_mfma_f32_16x16x32_bf16 v[56:59], a[76:79], v[72:75], v[56:59]
    v_mfma_f32_16x16x32_bf16 v[60:63], a[76:79], v[76:79], v[60:63]
    v_mfma_f32_16x16x32_bf16 v[64:67], a[80:83], v[72:75], v[64:67]
    v_mfma_f32_16x16x32_bf16 v[68:71], a[80:83], v[76:79], v[68:71]
    s_add_u32 s33, s31, 0x118000
    buffer_load_dwordx4 a[56:59], v2, s[8:11], s33 offen offset:0
    buffer_load_dwordx4 a[60:63], v2, s[8:11], s33 offen offset:1024
    buffer_load_dwordx4 a[64:67], v2, s[8:11], s33 offen offset:2048
    buffer_load_dwordx4 a[68:71], v2, s[8:11], s33 offen offset:3072
    s_add_u32 s33, s31, 0x119000
    buffer_load_dwordx4 a[72:75], v2, s[8:11], s33 offen offset:0
    buffer_load_dwordx4 a[76:79], v2, s[8:11], s33 offen offset:1024
    buffer_load_dwordx4 a[80:83], v2, s[8:11], s33 offen offset:2048
    ds_read_b128 v[72:75], v5 offset:256
    ds_read_b128 v[76:79], v5 offset:16640
    s_waitcnt vmcnt(49)
    s_waitcnt lgkmcnt(2)
    v_mfma_f32_16x16x32_bf16 v[16:19], a[84:87], v[80:83], v[16:19]
    v_mfma_f32_16x16x32_bf16 v[20:23], a[84:87], v[84:87], v[20:23]
    v_mfma_f32_16x16x32_bf16 v[24:27], a[88:91], v[80:83], v[24:27]
    v_mfma_f32_16x16x32_bf16 v[28:31], a[88:91], v[84:87], v[28:31]
    v_mfma_f32_16x16x32_bf16 v[32:35], a[92:95], v[80:83], v[32:35]
    v_mfma_f32_16x16x32_bf16 v[36:39], a[92:95], v[84:87], v[36:39]
    v_mfma_f32_16x16x32_bf16 v[40:43], a[96:99], v[80:83], v[40:43]
    v_mfma_f32_16x16x32_bf16 v[44:47], a[96:99], v[84:87], v[44:47]
    v_mfma_f32_16x16x32_bf16 v[48:51], a[100:103], v[80:83], v[48:51]
    v_mfma_f32_16x16x32_bf16 v[52:55], a[100:103], v[84:87], v[52:55]
    v_mfma_f32_16x16x32_bf16 v[56:59], a[104:107], v[80:83], v[56:59]
    v_mfma_f32_16x16x32_bf16 v[60:63], a[104:107], v[84:87], v[60:63]
    v_mfma_f32_16x16x32_bf16 v[64:67], a[108:111], v[80:83], v[64:67]
    v_mfma_f32_16x16x32_bf16 v[68:71], a[108:111], v[84:87], v[68:71]
    s_add_u32 s33, s31, 0x134000
    buffer_load_dwordx4 a[84:87], v2, s[8:11], s33 offen offset:0
    buffer_load_dwordx4 a[88:91], v2, s[8:11], s33 offen offset:1024
    buffer_load_dwordx4 a[92:95], v2, s[8:11], s33 offen offset:2048
    buffer_load_dwordx4 a[96:99], v2, s[8:11], s33 offen offset:3072
    s_add_u32 s33, s31, 0x135000
    buffer_load_dwordx4 a[100:103], v2, s[8:11], s33 offen offset:0
    buffer_load_dwordx4 a[104:107], v2, s[8:11], s33 offen offset:1024
    buffer_load_dwordx4 a[108:111], v2, s[8:11], s33 offen offset:2048
    ds_read_b128 v[80:83], v6 offset:256
    ds_read_b128 v[84:87], v6 offset:16640
    s_waitcnt vmcnt(49)
    s_waitcnt lgkmcnt(2)
    v_mfma_f32_16x16x32_bf16 v[16:19], a[112:115], v[72:75], v[16:19]
    v_mfma_f32_16x16x32_bf16 v[20:23], a[112:115], v[76:79], v[20:23]
    v_mfma_f32_16x16x32_bf16 v[24:27], a[116:119], v[72:75], v[24:27]
    v_mfma_f32_16x16x32_bf16 v[28:31], a[116:119], v[76:79], v[28:31]
    v_mfma_f32_16x16x32_bf16 v[32:35], a[120:123], v[72:75], v[32:35]
    v_mfma_f32_16x16x32_bf16 v[36:39], a[120:123], v[76:79], v[36:39]
    v_mfma_f32_16x16x32_bf16 v[40:43], a[124:127], v[72:75], v[40:43]
    v_mfma_f32_16x16x32_bf16 v[44:47], a[124:127], v[76:79], v[44:47]
    v_mfma_f32_16x16x32_bf16 v[48:51], a[128:131], v[72:75], v[48:51]
    v_mfma_f32_16x16x32_bf16 v[52:55], a[128:131], v[76:79], v[52:55]
    v_mfma_f32_16x16x32_bf16 v[56:59], a[132:135], v[72:75], v[56:59]
    v_mfma_f32_16x16x32_bf16 v[60:63], a[132:135], v[76:79], v[60:63]
    v_mfma_f32_16x16x32_bf16 v[64:67], a[136:139], v[72:75], v[64:67]
    v_mfma_f32_16x16x32_bf16 v[68:71], a[136:139], v[76:79], v[68:71]
    s_add_u32 s33, s31, 0x150000
    buffer_load_dwordx4 a[112:115], v2, s[8:11], s33 offen offset:0
    buffer_load_dwordx4 a[116:119], v2, s[8:11], s33 offen offset:1024
    buffer_load_dwordx4 a[120:123], v2, s[8:11], s33 offen offset:2048
    buffer_load_dwordx4 a[124:127], v2, s[8:11], s33 offen offset:3072
    s_add_u32 s33, s31, 0x151000
    buffer_load_dwordx4 a[128:131], v2, s[8:11], s33 offen offset:0
    buffer_load_dwordx4 a[132:135], v2, s[8:11], s33 offen offset:1024
    buffer_load_dwordx4 a[136:139], v2, s[8:11], s33 offen offset:2048
    ds_read_b128 v[72:75], v7 offset:256
    ds_read_b128 v[76:79], v7 offset:16640
    s_waitcnt vmcnt(49)
    s_waitcnt lgkmcnt(2)
    v_mfma_f32_16x16x32_bf16 v[16:19], a[140:143], v[80:83], v[16:19]
    v_mfma_f32_16x16x32_bf16 v[20:23], a[140:143], v[84:87], v[20:23]
    v_mfma_f32_16x16x32_bf16 v[24:27], a[144:147], v[80:83], v[24:27]
    v_mfma_f32_16x16x32_bf16 v[28:31], a[144:147], v[84:87], v[28:31]
    v_mfma_f32_16x16x32_bf16 v[32:35], a[148:151], v[80:83], v[32:35]
    v_mfma_f32_16x16x32_bf16 v[36:39], a[148:151], v[84:87], v[36:39]
    v_mfma_f32_16x16x32_bf16 v[40:43], a[152:155], v[80:83], v[40:43]
    v_mfma_f32_16x16x32_bf16 v[44:47], a[152:155], v[84:87], v[44:47]
    v_mfma_f32_16x16x32_bf16 v[48:51], a[156:159], v[80:83], v[48:51]
    v_mfma_f32_16x16x32_bf16 v[52:55], a[156:159], v[84:87], v[52:55]
    v_mfma_f32_16x16x32_bf16 v[56:59], a[160:163], v[80:83], v[56:59]
    v_mfma_f32_16x16x32_bf16 v[60:63], a[160:163], v[84:87], v[60:63]
    v_mfma_f32_16x16x32_bf16 v[64:67], a[164:167], v[80:83], v[64:67]
    v_mfma_f32_16x16x32_bf16 v[68:71], a[164:167], v[84:87], v[68:71]
    s_add_u32 s33, s31, 0x16c000
    buffer_load_dwordx4 a[140:143], v2, s[8:11], s33 offen offset:0
    buffer_load_dwordx4 a[144:147], v2, s[8:11], s33 offen offset:1024
    buffer_load_dwordx4 a[148:151], v2, s[8:11], s33 offen offset:2048
    buffer_load_dwordx4 a[152:155], v2, s[8:11], s33 offen offset:3072
    s_add_u32 s33, s31, 0x16d000
    buffer_load_dwordx4 a[156:159], v2, s[8:11], s33 offen offset:0
    buffer_load_dwordx4 a[160:163], v2, s[8:11], s33 offen offset:1024
    buffer_load_dwordx4 a[164:167], v2, s[8:11], s33 offen offset:2048
    ds_read_b128 v[80:83], v8 offset:256
    ds_read_b128 v[84:87], v8 offset:16640
    s_waitcnt vmcnt(49)
    s_waitcnt lgkmcnt(2)
    v_mfma_f32_16x16x32_bf16 v[16:19], a[168:171], v[72:75], v[16:19]
    v_mfma_f32_16x16x32_bf16 v[20:23], a[168:171], v[76:79], v[20:23]
    v_mfma_f32_16x16x32_bf16 v[24:27], a[172:175], v[72:75], v[24:27]
    v_mfma_f32_16x16x32_bf16 v[28:31], a[172:175], v[76:79], v[28:31]
    v_mfma_f32_16x16x32_bf16 v[32:35], a[176:179], v[72:75], v[32:35]
    v_mfma_f32_16x16x32_bf16 v[36:39], a[176:179], v[76:79], v[36:39]
    v_mfma_f32_16x16x32_bf16 v[40:43], a[180:183], v[72:75], v[40:43]
    v_mfma_f32_16x16x32_bf16 v[44:47], a[180:183], v[76:79], v[44:47]
    v_mfma_f32_16x16x32_bf16 v[48:51], a[184:187], v[72:75], v[48:51]
    v_mfma_f32_16x16x32_bf16 v[52:55], a[184:187], v[76:79], v[52:55]
    v_mfma_f32_16x16x32_bf16 v[56:59], a[188:191], v[72:75], v[56:59]
    v_mfma_f32_16x16x32_bf16 v[60:63], a[188:191], v[76:79], v[60:63]
    v_mfma_f32_16x16x32_bf16 v[64:67], a[192:195], v[72:75], v[64:67]
    v_mfma_f32_16x16x32_bf16 v[68:71], a[192:195], v[76:79], v[68:71]
    ds_read_b128 v[72:75], v5 offset:512
    ds_read_b128 v[76:79], v5 offset:16896
    s_waitcnt vmcnt(42)
    s_waitcnt lgkmcnt(2)
    v_mfma_f32_16x16x32_bf16 v[16:19], a[196:199], v[80:83], v[16:19]
    v_mfma_f32_16x16x32_bf16 v[20:23], a[196:199], v[84:87], v[20:23]
    v_mfma_f32_16x16x32_bf16 v[24:27], a[200:203], v[80:83], v[24:27]
    v_mfma_f32_16x16x32_bf16 v[28:31], a[200:203], v[84:87], v[28:31]
    v_mfma_f32_16x16x32_bf16 v[32:35], a[204:207], v[80:83], v[32:35]
    v_mfma_f32_16x16x32_bf16 v[36:39], a[204:207], v[84:87], v[36:39]
    v_mfma_f32_16x16x32_bf16 v[40:43], a[208:211], v[80:83], v[40:43]
    v_mfma_f32_16x16x32_bf16 v[44:47], a[208:211], v[84:87], v[44:47]
    v_mfma_f32_16x16x32_bf16 v[48:51], a[212:215], v[80:83], v[48:51]
    v_mfma_f32_16x16x32_bf16 v[52:55], a[212:215], v[84:87], v[52:55]
    v_mfma_f32_16x16x32_bf16 v[56:59], a[216:219], v[80:83], v[56:59]
    v_mfma_f32_16x16x32_bf16 v[60:63], a[216:219], v[84:87], v[60:63]
    v_mfma_f32_16x16x32_bf16 v[64:67], a[220:223], v[80:83], v[64:67]
    v_mfma_f32_16x16x32_bf16 v[68:71], a[220:223], v[84:87], v[68:71]
    ds_read_b128 v[80:83], v6 offset:512
    ds_read_b128 v[84:87], v6 offset:16896
    s_waitcnt vmcnt(35)
    s_waitcnt lgkmcnt(2)
    v_mfma_f32_16x16x32_bf16 v[16:19], a[0:3], v[72:75], v[16:19]
    v_mfma_f32_16x16x32_bf16 v[20:23], a[0:3], v[76:79], v[20:23]
    v_mfma_f32_16x16x32_bf16 v[24:27], a[4:7], v[72:75], v[24:27]
    v_mfma_f32_16x16x32_bf16 v[28:31], a[4:7], v[76:79], v[28:31]
    v_mfma_f32_16x16x32_bf16 v[32:35], a[8:11], v[72:75], v[32:35]
    v_mfma_f32_16x16x32_bf16 v[36:39], a[8:11], v[76:79], v[36:39]
    v_mfma_f32_16x16x32_bf16 v[40:43], a[12:15], v[72:75], v[40:43]
    v_mfma_f32_16x16x32_bf16 v[44:47], a[12:15], v[76:79], v[44:47]
    v_mfma_f32_16x16x32_bf16 v[48:51], a[16:19], v[72:75], v[48:51]
    v_mfma_f32_16x16x32_bf16 v[52:55], a[16:19], v[76:79], v[52:55]
    v_mfma_f32_16x16x32_bf16 v[56:59], a[20:23], v[72:75], v[56:59]
    v_mfma_f32_16x16x32_bf16 v[60:63], a[20:23], v[76:79], v[60:63]
    v_mfma_f32_16x16x32_bf16 v[64:67], a[24:27], v[72:75], v[64:67]
    v_mfma_f32_16x16x32_bf16 v[68:71], a[24:27], v[76:79], v[68:71]
    ds_read_b128 v[72:75], v7 offset:512
    ds_read_b128 v[76:79], v7 offset:16896
    s_waitcnt vmcnt(28)
    s_waitcnt lgkmcnt(2)
    v_mfma_f32_16x16x32_bf16 v[16:19], a[28:31], v[80:83], v[16:19]
    v_mfma_f32_16x16x32_bf16 v[20:23], a[28:31], v[84:87], v[20:23]
    v_mfma_f32_16x16x32_bf16 v[24:27], a[32:35], v[80:83], v[24:27]
    v_mfma_f32_16x16x32_bf16 v[28:31], a[32:35], v[84:87], v[28:31]
    v_mfma_f32_16x16x32_bf16 v[32:35], a[36:39], v[80:83], v[32:35]
    v_mfma_f32_16x16x32_bf16 v[36:39], a[36:39], v[84:87], v[36:39]
    v_mfma_f32_16x16x32_bf16 v[40:43], a[40:43], v[80:83], v[40:43]
    v_mfma_f32_16x16x32_bf16 v[44:47], a[40:43], v[84:87], v[44:47]
    v_mfma_f32_16x16x32_bf16 v[48:51], a[44:47], v[80:83], v[48:51]
    v_mfma_f32_16x16x32_bf16 v[52:55], a[44:47], v[84:87], v[52:55]
    v_mfma_f32_16x16x32_bf16 v[56:59], a[48:51], v[80:83], v[56:59]
    v_mfma_f32_16x16x32_bf16 v[60:63], a[48:51], v[84:87], v[60:63]
    v_mfma_f32_16x16x32_bf16 v[64:67], a[52:55], v[80:83], v[64:67]
    v_mfma_f32_16x16x32_bf16 v[68:71], a[52:55], v[84:87], v[68:71]
    ds_read_b128 v[80:83], v8 offset:512
    ds_read_b128 v[84:87], v8 offset:16896
    s_waitcnt vmcnt(21)
    s_waitcnt lgkmcnt(2)
    v_mfma_f32_16x16x32_bf16 v[16:19], a[56:59], v[72:75], v[16:19]
    v_mfma_f32_16x16x32_bf16 v[20:23], a[56:59], v[76:79], v[20:23]
    v_mfma_f32_16x16x32_bf16 v[24:27], a[60:63], v[72:75], v[24:27]
    v_mfma_f32_16x16x32_bf16 v[28:31], a[60:63], v[76:79], v[28:31]
    v_mfma_f32_16x16x32_bf16 v[32:35], a[64:67], v[72:75], v[32:35]
    v_mfma_f32_16x16x32_bf16 v[36:39], a[64:67], v[76:79], v[36:39]
    v_mfma_f32_16x16x32_bf16 v[40:43], a[68:71], v[72:75], v[40:43]
    v_mfma_f32_16x16x32_bf16 v[44:47], a[68:71], v[76:79], v[44:47]
    v_mfma_f32_16x16x32_bf16 v[48:51], a[72:75], v[72:75], v[48:51]
    v_mfma_f32_16x16x32_bf16 v[52:55], a[72:75], v[76:79], v[52:55]
    v_mfma_f32_16x16x32_bf16 v[56:59], a[76:79], v[72:75], v[56:59]
    v_mfma_f32_16x16x32_bf16 v[60:63], a[76:79], v[76:79], v[60:63]
    v_mfma_f32_16x16x32_bf16 v[64:67], a[80:83], v[72:75], v[64:67]
    v_mfma_f32_16x16x32_bf16 v[68:71], a[80:83], v[76:79], v[68:71]
    ds_read_b128 v[72:75], v5 offset:768
    ds_read_b128 v[76:79], v5 offset:17152
    s_waitcnt vmcnt(14)
    s_waitcnt lgkmcnt(2)
    v_mfma_f32_16x16x32_bf16 v[16:19], a[84:87], v[80:83], v[16:19]
    v_mfma_f32_16x16x32_bf16 v[20:23], a[84:87], v[84:87], v[20:23]
    v_mfma_f32_16x16x32_bf16 v[24:27], a[88:91], v[80:83], v[24:27]
    v_mfma_f32_16x16x32_bf16 v[28:31], a[88:91], v[84:87], v[28:31]
    v_mfma_f32_16x16x32_bf16 v[32:35], a[92:95], v[80:83], v[32:35]
    v_mfma_f32_16x16x32_bf16 v[36:39], a[92:95], v[84:87], v[36:39]
    v_mfma_f32_16x16x32_bf16 v[40:43], a[96:99], v[80:83], v[40:43]
    v_mfma_f32_16x16x32_bf16 v[44:47], a[96:99], v[84:87], v[44:47]
    v_mfma_f32_16x16x32_bf16 v[48:51], a[100:103], v[80:83], v[48:51]
    v_mfma_f32_16x16x32_bf16 v[52:55], a[100:103], v[84:87], v[52:55]
    v_mfma_f32_16x16x32_bf16 v[56:59], a[104:107], v[80:83], v[56:59]
    v_mfma_f32_16x16x32_bf16 v[60:63], a[104:107], v[84:87], v[60:63]
    v_mfma_f32_16x16x32_bf16 v[64:67], a[108:111], v[80:83], v[64:67]
    v_mfma_f32_16x16x32_bf16 v[68:71], a[108:111], v[84:87], v[68:71]
    ds_read_b128 v[80:83], v6 offset:768
    ds_read_b128 v[84:87], v6 offset:17152
    s_waitcnt vmcnt(7)
    s_waitcnt lgkmcnt(2)
    v_mfma_f32_16x16x32_bf16 v[16:19], a[112:115], v[72:75], v[16:19]
    v_mfma_f32_16x16x32_bf16 v[20:23], a[112:115], v[76:79], v[20:23]
    v_mfma_f32_16x16x32_bf16 v[24:27], a[116:119], v[72:75], v[24:27]
    v_mfma_f32_16x16x32_bf16 v[28:31], a[116:119], v[76:79], v[28:31]
    v_mfma_f32_16x16x32_bf16 v[32:35], a[120:123], v[72:75], v[32:35]
    v_mfma_f32_16x16x32_bf16 v[36:39], a[120:123], v[76:79], v[36:39]
    v_mfma_f32_16x16x32_bf16 v[40:43], a[124:127], v[72:75], v[40:43]
    v_mfma_f32_16x16x32_bf16 v[44:47], a[124:127], v[76:79], v[44:47]
    v_mfma_f32_16x16x32_bf16 v[48:51], a[128:131], v[72:75], v[48:51]
    v_mfma_f32_16x16x32_bf16 v[52:55], a[128:131], v[76:79], v[52:55]
    v_mfma_f32_16x16x32_bf16 v[56:59], a[132:135], v[72:75], v[56:59]
    v_mfma_f32_16x16x32_bf16 v[60:63], a[132:135], v[76:79], v[60:63]
    v_mfma_f32_16x16x32_bf16 v[64:67], a[136:139], v[72:75], v[64:67]
    v_mfma_f32_16x16x32_bf16 v[68:71], a[136:139], v[76:79], v[68:71]
    s_waitcnt vmcnt(0)
    s_waitcnt lgkmcnt(0)
    v_mfma_f32_16x16x32_bf16 v[16:19], a[140:143], v[80:83], v[16:19]
    v_mfma_f32_16x16x32_bf16 v[20:23], a[140:143], v[84:87], v[20:23]
    v_mfma_f32_16x16x32_bf16 v[24:27], a[144:147], v[80:83], v[24:27]
    v_mfma_f32_16x16x32_bf16 v[28:31], a[144:147], v[84:87], v[28:31]
    v_mfma_f32_16x16x32_bf16 v[32:35], a[148:151], v[80:83], v[32:35]
    v_mfma_f32_16x16x32_bf16 v[36:39], a[148:151], v[84:87], v[36:39]
    v_mfma_f32_16x16x32_bf16 v[40:43], a[152:155], v[80:83], v[40:43]
    v_mfma_f32_16x16x32_bf16 v[44:47], a[152:155], v[84:87], v[44:47]
    v_mfma_f32_16x16x32_bf16 v[48:51], a[156:159], v[80:83], v[48:51]
    v_mfma_f32_16x16x32_bf16 v[52:55], a[156:159], v[84:87], v[52:55]
    v_mfma_f32_16x16x32_bf16 v[56:59], a[160:163], v[80:83], v[56:59]
    v_mfma_f32_16x16x32_bf16 v[60:63], a[160:163], v[84:87], v[60:63]
    v_mfma_f32_16x16x32_bf16 v[64:67], a[164:167], v[80:83], v[64:67]
    v_mfma_f32_16x16x32_bf16 v[68:71], a[164:167], v[84:87], v[68:71]
    s_nop 7
    s_nop 1
    v_cvt_pk_bf16_f32 v88, v16, v17
    v_lshlrev_b32 v91, 16, v140
    v_and_b32 v92, 0xffff0000, v140
    v_cvt_pk_bf16_f32 v93, v18, v19
    v_lshlrev_b32 v96, 16, v141
    v_and_b32 v97, 0xffff0000, v141
    v_cvt_pk_bf16_f32 v98, v20, v21
    v_lshlrev_b32 v101, 16, v140
    v_and_b32 v102, 0xffff0000, v140
    v_cvt_pk_bf16_f32 v103, v22, v23
    v_lshlrev_b32 v106, 16, v141
    v_and_b32 v107, 0xffff0000, v141
    v_lshlrev_b32 v89, 16, v88
    v_and_b32 v90, 0xffff0000, v88
    v_lshlrev_b32 v94, 16, v93
    v_and_b32 v95, 0xffff0000, v93
    v_lshlrev_b32 v99, 16, v98
    v_and_b32 v100, 0xffff0000, v98
    v_lshlrev_b32 v104, 16, v103
    v_and_b32 v105, 0xffff0000, v103
    v_add_f32 v89, v89, v91
    v_add_f32 v90, v90, v92
    v_add_f32 v94, v94, v96
    v_add_f32 v95, v95, v97
    v_add_f32 v99, v99, v101
    v_add_f32 v100, v100, v102
    v_add_f32 v104, v104, v106
    v_add_f32 v105, v105, v107
    v_cvt_pk_bf16_f32 v88, v89, v90
    v_cvt_pk_bf16_f32 v93, v94, v95
    v_cvt_pk_bf16_f32 v98, v99, v100
    v_cvt_pk_bf16_f32 v103, v104, v105
    v_lshlrev_b32 v89, 16, v88
    v_and_b32 v90, 0xffff0000, v88
    v_lshlrev_b32 v94, 16, v93
    v_and_b32 v95, 0xffff0000, v93
    v_lshlrev_b32 v99, 16, v98
    v_and_b32 v100, 0xffff0000, v98
    v_lshlrev_b32 v104, 16, v103
    v_and_b32 v105, 0xffff0000, v103
    v_max_f32 v89, 0, v89
    v_max_f32 v90, 0, v90
    v_max_f32 v94, 0, v94
    v_max_f32 v95, 0, v95
    v_max_f32 v99, 0, v99
    v_max_f32 v100, 0, v100
    v_max_f32 v104, 0, v104
    v_max_f32 v105, 0, v105
    v_mul_f32 v89, v89, v89
    v_mul_f32 v90, v90, v90
    v_mul_f32 v94, v94, v94
    v_mul_f32 v95, v95, v95
    v_mul_f32 v99, v99, v99
    v_mul_f32 v100, v100, v100
    v_mul_f32 v104, v104, v104
    v_mul_f32 v105, v105, v105
    v_cvt_pk_bf16_f32 v16, v89, v90
    v_cvt_pk_bf16_f32 v17, v94, v95
    v_cvt_pk_bf16_f32 v20, v99, v100
    v_cvt_pk_bf16_f32 v21, v104, v105
    buffer_store_dwordx2 v[16:17], v13, s[16:19], s37 offen offset:0
    buffer_store_dwordx2 v[20:21], v13, s[16:19], s38 offen offset:0
    v_cvt_pk_bf16_f32 v88, v24, v25
    v_lshlrev_b32 v91, 16, v142
    v_and_b32 v92, 0xffff0000, v142
    v_cvt_pk_bf16_f32 v93, v26, v27
    v_lshlrev_b32 v96, 16, v143
    v_and_b32 v97, 0xffff0000, v143
    v_cvt_pk_bf16_f32 v98, v28, v29
    v_lshlrev_b32 v101, 16, v142
    v_and_b32 v102, 0xffff0000, v142
    v_cvt_pk_bf16_f32 v103, v30, v31
    v_lshlrev_b32 v106, 16, v143
    v_and_b32 v107, 0xffff0000, v143
    v_lshlrev_b32 v89, 16, v88
    v_and_b32 v90, 0xffff0000, v88
    v_lshlrev_b32 v94, 16, v93
    v_and_b32 v95, 0xffff0000, v93
    v_lshlrev_b32 v99, 16, v98
    v_and_b32 v100, 0xffff0000, v98
    v_lshlrev_b32 v104, 16, v103
    v_and_b32 v105, 0xffff0000, v103
    v_add_f32 v89, v89, v91
    v_add_f32 v90, v90, v92
    v_add_f32 v94, v94, v96
    v_add_f32 v95, v95, v97
    v_add_f32 v99, v99, v101
    v_add_f32 v100, v100, v102
    v_add_f32 v104, v104, v106
    v_add_f32 v105, v105, v107
    v_cvt_pk_bf16_f32 v88, v89, v90
    v_cvt_pk_bf16_f32 v93, v94, v95
    v_cvt_pk_bf16_f32 v98, v99, v100
    v_cvt_pk_bf16_f32 v103, v104, v105
    v_lshlrev_b32 v89, 16, v88
    v_and_b32 v90, 0xffff0000, v88
    v_lshlrev_b32 v94, 16, v93
    v_and_b32 v95, 0xffff0000, v93
    v_lshlrev_b32 v99, 16, v98
    v_and_b32 v100, 0xffff0000, v98
    v_lshlrev_b32 v104, 16, v103
    v_and_b32 v105, 0xffff0000, v103
    v_max_f32 v89, 0, v89
    v_max_f32 v90, 0, v90
    v_max_f32 v94, 0, v94
    v_max_f32 v95, 0, v95
    v_max_f32 v99, 0, v99
    v_max_f32 v100, 0, v100
    v_max_f32 v104, 0, v104
    v_max_f32 v105, 0, v105
    v_mul_f32 v89, v89, v89
    v_mul_f32 v90, v90, v90
    v_mul_f32 v94, v94, v94
    v_mul_f32 v95, v95, v95
    v_mul_f32 v99, v99, v99
    v_mul_f32 v100, v100, v100
    v_mul_f32 v104, v104, v104
    v_mul_f32 v105, v105, v105
    v_cvt_pk_bf16_f32 v24, v89, v90
    v_cvt_pk_bf16_f32 v25, v94, v95
    v_cvt_pk_bf16_f32 v28, v99, v100
    v_cvt_pk_bf16_f32 v29, v104, v105
    buffer_store_dwordx2 v[24:25], v13, s[16:19], s37 offen offset:32
    buffer_store_dwordx2 v[28:29], v13, s[16:19], s38 offen offset:32
    v_cvt_pk_bf16_f32 v88, v32, v33
    v_lshlrev_b32 v91, 16, v144
    v_and_b32 v92, 0xffff0000, v144
    v_cvt_pk_bf16_f32 v93, v34, v35
    v_lshlrev_b32 v96, 16, v145
    v_and_b32 v97, 0xffff0000, v145
    v_cvt_pk_bf16_f32 v98, v36, v37
    v_lshlrev_b32 v101, 16, v144
    v_and_b32 v102, 0xffff0000, v144
    v_cvt_pk_bf16_f32 v103, v38, v39
    v_lshlrev_b32 v106, 16, v145
    v_and_b32 v107, 0xffff0000, v145
    v_lshlrev_b32 v89, 16, v88
    v_and_b32 v90, 0xffff0000, v88
    v_lshlrev_b32 v94, 16, v93
    v_and_b32 v95, 0xffff0000, v93
    v_lshlrev_b32 v99, 16, v98
    v_and_b32 v100, 0xffff0000, v98
    v_lshlrev_b32 v104, 16, v103
    v_and_b32 v105, 0xffff0000, v103
    v_add_f32 v89, v89, v91
    v_add_f32 v90, v90, v92
    v_add_f32 v94, v94, v96
    v_add_f32 v95, v95, v97
    v_add_f32 v99, v99, v101
    v_add_f32 v100, v100, v102
    v_add_f32 v104, v104, v106
    v_add_f32 v105, v105, v107
    v_cvt_pk_bf16_f32 v88, v89, v90
    v_cvt_pk_bf16_f32 v93, v94, v95
    v_cvt_pk_bf16_f32 v98, v99, v100
    v_cvt_pk_bf16_f32 v103, v104, v105
    v_lshlrev_b32 v89, 16, v88
    v_and_b32 v90, 0xffff0000, v88
    v_lshlrev_b32 v94, 16, v93
    v_and_b32 v95, 0xffff0000, v93
    v_lshlrev_b32 v99, 16, v98
    v_and_b32 v100, 0xffff0000, v98
    v_lshlrev_b32 v104, 16, v103
    v_and_b32 v105, 0xffff0000, v103
    v_max_f32 v89, 0, v89
    v_max_f32 v90, 0, v90
    v_max_f32 v94, 0, v94
    v_max_f32 v95, 0, v95
    v_max_f32 v99, 0, v99
    v_max_f32 v100, 0, v100
    v_max_f32 v104, 0, v104
    v_max_f32 v105, 0, v105
    v_mul_f32 v89, v89, v89
    v_mul_f32 v90, v90, v90
    v_mul_f32 v94, v94, v94
    v_mul_f32 v95, v95, v95
    v_mul_f32 v99, v99, v99
    v_mul_f32 v100, v100, v100
    v_mul_f32 v104, v104, v104
    v_mul_f32 v105, v105, v105
    v_cvt_pk_bf16_f32 v32, v89, v90
    v_cvt_pk_bf16_f32 v33, v94, v95
    v_cvt_pk_bf16_f32 v36, v99, v100
    v_cvt_pk_bf16_f32 v37, v104, v105
    buffer_store_dwordx2 v[32:33], v13, s[16:19], s37 offen offset:64
    buffer_store_dwordx2 v[36:37], v13, s[16:19], s38 offen offset:64
    v_cvt_pk_bf16_f32 v88, v40, v41
    v_lshlrev_b32 v91, 16, v146
    v_and_b32 v92, 0xffff0000, v146
    v_cvt_pk_bf16_f32 v93, v42, v43
    v_lshlrev_b32 v96, 16, v147
    v_and_b32 v97, 0xffff0000, v147
    v_cvt_pk_bf16_f32 v98, v44, v45
    v_lshlrev_b32 v101, 16, v146
    v_and_b32 v102, 0xffff0000, v146
    v_cvt_pk_bf16_f32 v103, v46, v47
    v_lshlrev_b32 v106, 16, v147
    v_and_b32 v107, 0xffff0000, v147
    v_lshlrev_b32 v89, 16, v88
    v_and_b32 v90, 0xffff0000, v88
    v_lshlrev_b32 v94, 16, v93
    v_and_b32 v95, 0xffff0000, v93
    v_lshlrev_b32 v99, 16, v98
    v_and_b32 v100, 0xffff0000, v98
    v_lshlrev_b32 v104, 16, v103
    v_and_b32 v105, 0xffff0000, v103
    v_add_f32 v89, v89, v91
    v_add_f32 v90, v90, v92
    v_add_f32 v94, v94, v96
    v_add_f32 v95, v95, v97
    v_add_f32 v99, v99, v101
    v_add_f32 v100, v100, v102
    v_add_f32 v104, v104, v106
    v_add_f32 v105, v105, v107
    v_cvt_pk_bf16_f32 v88, v89, v90
    v_cvt_pk_bf16_f32 v93, v94, v95
    v_cvt_pk_bf16_f32 v98, v99, v100
    v_cvt_pk_bf16_f32 v103, v104, v105
    v_lshlrev_b32 v89, 16, v88
    v_and_b32 v90, 0xffff0000, v88
    v_lshlrev_b32 v94, 16, v93
    v_and_b32 v95, 0xffff0000, v93
    v_lshlrev_b32 v99, 16, v98
    v_and_b32 v100, 0xffff0000, v98
    v_lshlrev_b32 v104, 16, v103
    v_and_b32 v105, 0xffff0000, v103
    v_max_f32 v89, 0, v89
    v_max_f32 v90, 0, v90
    v_max_f32 v94, 0, v94
    v_max_f32 v95, 0, v95
    v_max_f32 v99, 0, v99
    v_max_f32 v100, 0, v100
    v_max_f32 v104, 0, v104
    v_max_f32 v105, 0, v105
    v_mul_f32 v89, v89, v89
    v_mul_f32 v90, v90, v90
    v_mul_f32 v94, v94, v94
    v_mul_f32 v95, v95, v95
    v_mul_f32 v99, v99, v99
    v_mul_f32 v100, v100, v100
    v_mul_f32 v104, v104, v104
    v_mul_f32 v105, v105, v105
    v_cvt_pk_bf16_f32 v40, v89, v90
    v_cvt_pk_bf16_f32 v41, v94, v95
    v_cvt_pk_bf16_f32 v44, v99, v100
    v_cvt_pk_bf16_f32 v45, v104, v105
    buffer_store_dwordx2 v[40:41], v13, s[16:19], s37 offen offset:96
    buffer_store_dwordx2 v[44:45], v13, s[16:19], s38 offen offset:96
    v_cvt_pk_bf16_f32 v88, v48, v49
    v_lshlrev_b32 v91, 16, v148
    v_and_b32 v92, 0xffff0000, v148
    v_cvt_pk_bf16_f32 v93, v50, v51
    v_lshlrev_b32 v96, 16, v149
    v_and_b32 v97, 0xffff0000, v149
    v_cvt_pk_bf16_f32 v98, v52, v53
    v_lshlrev_b32 v101, 16, v148
    v_and_b32 v102, 0xffff0000, v148
    v_cvt_pk_bf16_f32 v103, v54, v55
    v_lshlrev_b32 v106, 16, v149
    v_and_b32 v107, 0xffff0000, v149
    v_lshlrev_b32 v89, 16, v88
    v_and_b32 v90, 0xffff0000, v88
    v_lshlrev_b32 v94, 16, v93
    v_and_b32 v95, 0xffff0000, v93
    v_lshlrev_b32 v99, 16, v98
    v_and_b32 v100, 0xffff0000, v98
    v_lshlrev_b32 v104, 16, v103
    v_and_b32 v105, 0xffff0000, v103
    v_add_f32 v89, v89, v91
    v_add_f32 v90, v90, v92
    v_add_f32 v94, v94, v96
    v_add_f32 v95, v95, v97
    v_add_f32 v99, v99, v101
    v_add_f32 v100, v100, v102
    v_add_f32 v104, v104, v106
    v_add_f32 v105, v105, v107
    v_cvt_pk_bf16_f32 v88, v89, v90
    v_cvt_pk_bf16_f32 v93, v94, v95
    v_cvt_pk_bf16_f32 v98, v99, v100
    v_cvt_pk_bf16_f32 v103, v104, v105
    v_lshlrev_b32 v89, 16, v88
    v_and_b32 v90, 0xffff0000, v88
    v_lshlrev_b32 v94, 16, v93
    v_and_b32 v95, 0xffff0000, v93
    v_lshlrev_b32 v99, 16, v98
    v_and_b32 v100, 0xffff0000, v98
    v_lshlrev_b32 v104, 16, v103
    v_and_b32 v105, 0xffff0000, v103
    v_max_f32 v89, 0, v89
    v_max_f32 v90, 0, v90
    v_max_f32 v94, 0, v94
    v_max_f32 v95, 0, v95
    v_max_f32 v99, 0, v99
    v_max_f32 v100, 0, v100
    v_max_f32 v104, 0, v104
    v_max_f32 v105, 0, v105
    v_mul_f32 v89, v89, v89
    v_mul_f32 v90, v90, v90
    v_mul_f32 v94, v94, v94
    v_mul_f32 v95, v95, v95
    v_mul_f32 v99, v99, v99
    v_mul_f32 v100, v100, v100
    v_mul_f32 v104, v104, v104
    v_mul_f32 v105, v105, v105
    v_cvt_pk_bf16_f32 v48, v89, v90
    v_cvt_pk_bf16_f32 v49, v94, v95
    v_cvt_pk_bf16_f32 v52, v99, v100
    v_cvt_pk_bf16_f32 v53, v104, v105
    buffer_store_dwordx2 v[48:49], v13, s[16:19], s37 offen offset:128
    buffer_store_dwordx2 v[52:53], v13, s[16:19], s38 offen offset:128
    v_cvt_pk_bf16_f32 v88, v56, v57
    v_lshlrev_b32 v91, 16, v150
    v_and_b32 v92, 0xffff0000, v150
    v_cvt_pk_bf16_f32 v93, v58, v59
    v_lshlrev_b32 v96, 16, v151
    v_and_b32 v97, 0xffff0000, v151
    v_cvt_pk_bf16_f32 v98, v60, v61
    v_lshlrev_b32 v101, 16, v150
    v_and_b32 v102, 0xffff0000, v150
    v_cvt_pk_bf16_f32 v103, v62, v63
    v_lshlrev_b32 v106, 16, v151
    v_and_b32 v107, 0xffff0000, v151
    v_lshlrev_b32 v89, 16, v88
    v_and_b32 v90, 0xffff0000, v88
    v_lshlrev_b32 v94, 16, v93
    v_and_b32 v95, 0xffff0000, v93
    v_lshlrev_b32 v99, 16, v98
    v_and_b32 v100, 0xffff0000, v98
    v_lshlrev_b32 v104, 16, v103
    v_and_b32 v105, 0xffff0000, v103
    v_add_f32 v89, v89, v91
    v_add_f32 v90, v90, v92
    v_add_f32 v94, v94, v96
    v_add_f32 v95, v95, v97
    v_add_f32 v99, v99, v101
    v_add_f32 v100, v100, v102
    v_add_f32 v104, v104, v106
    v_add_f32 v105, v105, v107
    v_cvt_pk_bf16_f32 v88, v89, v90
    v_cvt_pk_bf16_f32 v93, v94, v95
    v_cvt_pk_bf16_f32 v98, v99, v100
    v_cvt_pk_bf16_f32 v103, v104, v105
    v_lshlrev_b32 v89, 16, v88
    v_and_b32 v90, 0xffff0000, v88
    v_lshlrev_b32 v94, 16, v93
    v_and_b32 v95, 0xffff0000, v93
    v_lshlrev_b32 v99, 16, v98
    v_and_b32 v100, 0xffff0000, v98
    v_lshlrev_b32 v104, 16, v103
    v_and_b32 v105, 0xffff0000, v103
    v_max_f32 v89, 0, v89
    v_max_f32 v90, 0, v90
    v_max_f32 v94, 0, v94
    v_max_f32 v95, 0, v95
    v_max_f32 v99, 0, v99
    v_max_f32 v100, 0, v100
    v_max_f32 v104, 0, v104
    v_max_f32 v105, 0, v105
    v_mul_f32 v89, v89, v89
    v_mul_f32 v90, v90, v90
    v_mul_f32 v94, v94, v94
    v_mul_f32 v95, v95, v95
    v_mul_f32 v99, v99, v99
    v_mul_f32 v100, v100, v100
    v_mul_f32 v104, v104, v104
    v_mul_f32 v105, v105, v105
    v_cvt_pk_bf16_f32 v56, v89, v90
    v_cvt_pk_bf16_f32 v57, v94, v95
    v_cvt_pk_bf16_f32 v60, v99, v100
    v_cvt_pk_bf16_f32 v61, v104, v105
    buffer_store_dwordx2 v[56:57], v13, s[16:19], s37 offen offset:160
    buffer_store_dwordx2 v[60:61], v13, s[16:19], s38 offen offset:160
    v_cvt_pk_bf16_f32 v88, v64, v65
    v_lshlrev_b32 v91, 16, v152
    v_and_b32 v92, 0xffff0000, v152
    v_cvt_pk_bf16_f32 v93, v66, v67
    v_lshlrev_b32 v96, 16, v153
    v_and_b32 v97, 0xffff0000, v153
    v_cvt_pk_bf16_f32 v98, v68, v69
    v_lshlrev_b32 v101, 16, v152
    v_and_b32 v102, 0xffff0000, v152
    v_cvt_pk_bf16_f32 v103, v70, v71
    v_lshlrev_b32 v106, 16, v153
    v_and_b32 v107, 0xffff0000, v153
    v_lshlrev_b32 v89, 16, v88
    v_and_b32 v90, 0xffff0000, v88
    v_lshlrev_b32 v94, 16, v93
    v_and_b32 v95, 0xffff0000, v93
    v_lshlrev_b32 v99, 16, v98
    v_and_b32 v100, 0xffff0000, v98
    v_lshlrev_b32 v104, 16, v103
    v_and_b32 v105, 0xffff0000, v103
    v_add_f32 v89, v89, v91
    v_add_f32 v90, v90, v92
    v_add_f32 v94, v94, v96
    v_add_f32 v95, v95, v97
    v_add_f32 v99, v99, v101
    v_add_f32 v100, v100, v102
    v_add_f32 v104, v104, v106
    v_add_f32 v105, v105, v107
    v_cvt_pk_bf16_f32 v88, v89, v90
    v_cvt_pk_bf16_f32 v93, v94, v95
    v_cvt_pk_bf16_f32 v98, v99, v100
    v_cvt_pk_bf16_f32 v103, v104, v105
    v_lshlrev_b32 v89, 16, v88
    v_and_b32 v90, 0xffff0000, v88
    v_lshlrev_b32 v94, 16, v93
    v_and_b32 v95, 0xffff0000, v93
    v_lshlrev_b32 v99, 16, v98
    v_and_b32 v100, 0xffff0000, v98
    v_lshlrev_b32 v104, 16, v103
    v_and_b32 v105, 0xffff0000, v103
    v_max_f32 v89, 0, v89
    v_max_f32 v90, 0, v90
    v_max_f32 v94, 0, v94
    v_max_f32 v95, 0, v95
    v_max_f32 v99, 0, v99
    v_max_f32 v100, 0, v100
    v_max_f32 v104, 0, v104
    v_max_f32 v105, 0, v105
    v_mul_f32 v89, v89, v89
    v_mul_f32 v90, v90, v90
    v_mul_f32 v94, v94, v94
    v_mul_f32 v95, v95, v95
    v_mul_f32 v99, v99, v99
    v_mul_f32 v100, v100, v100
    v_mul_f32 v104, v104, v104
    v_mul_f32 v105, v105, v105
    v_cvt_pk_bf16_f32 v64, v89, v90
    v_cvt_pk_bf16_f32 v65, v94, v95
    v_cvt_pk_bf16_f32 v68, v99, v100
    v_cvt_pk_bf16_f32 v69, v104, v105
    buffer_store_dwordx2 v[64:65], v13, s[16:19], s37 offen offset:192
    buffer_store_dwordx2 v[68:69], v13, s[16:19], s38 offen offset:192
k3l1_kernel_done:
    s_endpgm
.globl k4l1_kernel
.p2align 8
.type k4l1_kernel,@function
k4l1_kernel:
    s_cmp_ge_u32 s2, 224
    s_cbranch_scc1 k4l1_kernel_done
    s_load_dwordx2 s[24:25], s[0:1], 88
    s_load_dwordx2 s[26:27], s[0:1], 64
    s_load_dwordx2 s[44:45], s[0:1], 72
    v_lshrrev_b32 v9, 6, v0
    v_and_b32 v1, 63, v0
    v_lshlrev_b32 v2, 4, v1
    v_and_b32 v3, 15, v1
    v_lshrrev_b32 v4, 4, v1
    v_readfirstlane_b32 s3, v9
    v_add_u32 v9, 0, v4
    v_xor_b32 v9, v9, v3
    v_lshlrev_b32 v9, 4, v9
    v_lshl_add_u32 v5, v3, 10, v9
    v_add_u32 v9, 4, v4
    v_xor_b32 v9, v9, v3
    v_lshlrev_b32 v9, 4, v9
    v_lshl_add_u32 v6, v3, 10, v9
    v_add_u32 v9, 8, v4
    v_xor_b32 v9, v9, v3
    v_lshlrev_b32 v9, 4, v9
    v_lshl_add_u32 v7, v3, 10, v9
    v_add_u32 v9, 12, v4
    v_xor_b32 v9, v9, v3
    v_lshlrev_b32 v9, 4, v9
    v_lshl_add_u32 v8, v3, 10, v9
    v_add_u32 v10, 0x10000, v5
    v_add_u32 v11, 0x10000, v6
    v_add_u32 v12, 0x10000, v7
    v_add_u32 v13, 0x10000, v8
    s_lshr_b32 s29, s2, 3
    s_mul_hi_u32 s28, s29, 0x24924925
    s_mul_i32 s30, s28, 7
    s_sub_u32 s29, s29, s30
    s_and_b32 s30, s2, 7
    s_lshl_b32 s30, s30, 2
    s_add_u32 s28, s28, s30
    s_lshl_b32 s29, s29, 2
    s_add_u32 s29, s29, s3
    s_waitcnt lgkmcnt(0)
    s_add_u32 s4, s24, 0x1678000
    s_addc_u32 s5, s25, 0
    s_mov_b32 s6, 0x700000
    s_mov_b32 s7, 0x00020000
    s_add_u32 s8, s24, 0x358000
    s_addc_u32 s9, s25, 0
    s_mov_b32 s10, 0x188000
    s_mov_b32 s11, 0x00020000
    s_mov_b32 s12, s26
    s_mov_b32 s13, s27
    s_mov_b32 s14, 0x380
    s_mov_b32 s15, 0x00020000
    s_add_u32 s16, s24, 0xd38000
    s_addc_u32 s17, s25, 0
    s_mov_b32 s18, 0x1c0000
    s_mov_b32 s19, 0x00020000
    s_add_u32 s20, s24, 0xef8000
    s_addc_u32 s21, s25, 0
    s_mov_b32 s22, 0x1c0000
    s_mov_b32 s23, 0x00020000
    s_mul_i32 s30, s28, 229376
    s_lshl_b32 s31, s29, 10
    v_lshrrev_b32 v14, 3, v0
    v_mul_u32_u24 v14, 3584, v14
    v_and_b32 v15, 7, v0
    v_lshl_add_u32 v14, v15, 4, v14
    v_lshrrev_b32 v16, 3, v0
    v_and_b32 v17, 15, v16
    v_xor_b32 v18, v15, v17
    v_lshlrev_b32 v18, 4, v18
    v_add_u32 v15, 8, v15
    v_xor_b32 v19, v15, v17
    v_lshlrev_b32 v19, 4, v19
    v_lshlrev_b32 v16, 10, v16
    v_add_u32 v18, v18, v16
    v_add_u32 v19, v19, v16
    v_add_u32 v158, 0x10000, v18
    v_add_u32 v159, 0x10000, v19
    s_add_u32 s34, s30, 0
    buffer_load_dwordx4 v[100:103], v14, s[4:7], s34 offen offset:0
    buffer_load_dwordx4 v[104:107], v14, s[4:7], s34 offen offset:128
    buffer_load_dwordx4 v[108:111], v14, s[4:7], s34 offen offset:256
    buffer_load_dwordx4 v[112:115], v14, s[4:7], s34 offen offset:384
    buffer_load_dwordx4 v[116:119], v14, s[4:7], s34 offen offset:512
    buffer_load_dwordx4 v[120:123], v14, s[4:7], s34 offen offset:640
    buffer_load_dwordx4 v[124:127], v14, s[4:7], s34 offen offset:768
    s_add_u32 s34, s30, 114688
    buffer_load_dwordx4 v[128:131], v14, s[4:7], s34 offen offset:0
    buffer_load_dwordx4 v[132:135], v14, s[4:7], s34 offen offset:128
    buffer_load_dwordx4 v[136:139], v14, s[4:7], s34 offen offset:256
    buffer_load_dwordx4 v[140:143], v14, s[4:7], s34 offen offset:384
    buffer_load_dwordx4 v[144:147], v14, s[4:7], s34 offen offset:512
    buffer_load_dwordx4 v[148:151], v14, s[4:7], s34 offen offset:640
    buffer_load_dwordx4 v[152:155], v14, s[4:7], s34 offen offset:768
    s_add_u32 s33, s31, 0x0
    buffer_load_dwordx4 a[0:3], v2, s[8:11], s33 offen offset:0
    s_add_u32 s33, s31, 0x7000
    buffer_load_dwordx4 a[4:7], v2, s[8:11], s33 offen offset:0
    s_add_u32 s33, s31, 0xe000
    buffer_load_dwordx4 a[8:11], v2, s[8:11], s33 offen offset:0
    s_add_u32 s33, s31, 0x15000
    buffer_load_dwordx4 a[12:15], v2, s[8:11], s33 offen offset:0
    s_add_u32 s33, s31, 0x1c000
    buffer_load_dwordx4 a[16:19], v2, s[8:11], s33 offen offset:0
    s_add_u32 s33, s31, 0x23000
    buffer_load_dwordx4 a[20:23], v2, s[8:11], s33 offen offset:0
    s_add_u32 s33, s31, 0x2a000
    buffer_load_dwordx4 a[24:27], v2, s[8:11], s33 offen offset:0
    s_add_u32 s33, s31, 0x31000
    buffer_load_dwordx4 a[28:31], v2, s[8:11], s33 offen offset:0
    s_add_u32 s33, s31, 0x38000
    buffer_load_dwordx4 a[32:35], v2, s[8:11], s33 offen offset:0
    s_add_u32 s33, s31, 0x3f000
    buffer_load_dwordx4 a[36:39], v2, s[8:11], s33 offen offset:0
    s_add_u32 s33, s31, 0x46000
    buffer_load_dwordx4 a[40:43], v2, s[8:11], s33 offen offset:0
    s_add_u32 s33, s31, 0x4d000
    buffer_load_dwordx4 a[44:47], v2, s[8:11], s33 offen offset:0
    s_add_u32 s33, s31, 0x54000
    buffer_load_dwordx4 a[48:51], v2, s[8:11], s33 offen offset:0
    s_add_u32 s33, s31, 0x5b000
    buffer_load_dwordx4 a[52:55], v2, s[8:11], s33 offen offset:0
    s_add_u32 s33, s31, 0x62000
    buffer_load_dwordx4 a[56:59], v2, s[8:11], s33 offen offset:0
    s_add_u32 s33, s31, 0x69000
    buffer_load_dwordx4 a[60:63], v2, s[8:11], s33 offen offset:0
    s_add_u32 s33, s31, 0x70000
    buffer_load_dwordx4 a[64:67], v2, s[8:11], s33 offen offset:0
    s_add_u32 s33, s31, 0x77000
    buffer_load_dwordx4 a[68:71], v2, s[8:11], s33 offen offset:0
    s_add_u32 s33, s31, 0x7e000
    buffer_load_dwordx4 a[72:75], v2, s[8:11], s33 offen offset:0
    s_add_u32 s33, s31, 0x85000
    buffer_load_dwordx4 a[76:79], v2, s[8:11], s33 offen offset:0
    s_add_u32 s33, s31, 0x8c000
    buffer_load_dwordx4 a[80:83], v2, s[8:11], s33 offen offset:0
    s_add_u32 s33, s31, 0x93000
    buffer_load_dwordx4 a[84:87], v2, s[8:11], s33 offen offset:0
    s_add_u32 s33, s31, 0x9a000
    buffer_load_dwordx4 a[88:91], v2, s[8:11], s33 offen offset:0
    s_add_u32 s33, s31, 0xa1000
    buffer_load_dwordx4 a[92:95], v2, s[8:11], s33 offen offset:0
    s_waitcnt vmcnt(24)
    ds_write_b128 v18, v[100:103] offset:0
    ds_write_b128 v19, v[104:107] offset:0
    ds_write_b128 v18, v[108:111] offset:256
    ds_write_b128 v19, v[112:115] offset:256
    ds_write_b128 v18, v[116:119] offset:512
    ds_write_b128 v19, v[120:123] offset:512
    ds_write_b128 v18, v[124:127] offset:768
    ds_write_b128 v18, v[128:131] offset:32768
    ds_write_b128 v19, v[132:135] offset:32768
    ds_write_b128 v18, v[136:139] offset:33024
    ds_write_b128 v19, v[140:143] offset:33024
    ds_write_b128 v18, v[144:147] offset:33280
    ds_write_b128 v19, v[148:151] offset:33280
    ds_write_b128 v18, v[152:155] offset:33536
    s_add_u32 s34, s30, 896
    buffer_load_dwordx4 v[100:103], v14, s[4:7], s34 offen offset:0
    buffer_load_dwordx4 v[104:107], v14, s[4:7], s34 offen offset:128
    buffer_load_dwordx4 v[108:111], v14, s[4:7], s34 offen offset:256
    buffer_load_dwordx4 v[112:115], v14, s[4:7], s34 offen offset:384
    buffer_load_dwordx4 v[116:119], v14, s[4:7], s34 offen offset:512
    buffer_load_dwordx4 v[120:123], v14, s[4:7], s34 offen offset:640
    buffer_load_dwordx4 v[124:127], v14, s[4:7], s34 offen offset:768
    s_add_u32 s34, s30, 115584
    buffer_load_dwordx4 v[128:131], v14, s[4:7], s34 offen offset:0
    buffer_load_dwordx4 v[132:135], v14, s[4:7], s34 offen offset:128
    buffer_load_dwordx4 v[136:139], v14, s[4:7], s34 offen offset:256
    buffer_load_dwordx4 v[140:143], v14, s[4:7], s34 offen offset:384
    buffer_load_dwordx4 v[144:147], v14, s[4:7], s34 offen offset:512
    buffer_load_dwordx4 v[148:151], v14, s[4:7], s34 offen offset:640
    buffer_load_dwordx4 v[152:155], v14, s[4:7], s34 offen offset:768
    s_waitcnt lgkmcnt(0)
    s_barrier
    ds_read_b128 v[68:71], v5 offset:0
    ds_read_b128 v[72:75], v5 offset:16384
    ds_read_b128 v[76:79], v5 offset:32768
    ds_read_b128 v[80:83], v5 offset:49152
    ds_read_b128 v[84:87], v6 offset:0
    ds_read_b128 v[88:91], v6 offset:16384
    ds_read_b128 v[92:95], v6 offset:32768
    ds_read_b128 v[96:99], v6 offset:49152
    s_waitcnt vmcnt(37)
    s_waitcnt lgkmcnt(4)
    v_mfma_f32_16x16x32_bf16 v[20:23], a[0:3], v[68:71], 0
    v_mfma_f32_16x16x32_bf16 v[24:27], a[0:3], v[72:75], 0
    v_mfma_f32_16x16x32_bf16 v[28:31], a[0:3], v[76:79], 0
    v_mfma_f32_16x16x32_bf16 v[32:35], a[0:3], v[80:83], 0
    s_add_u32 s33, s31, 0xa8000
    buffer_load_dwordx4 a[0:3], v2, s[8:11], s33 offen offset:0
    ds_read_b128 v[68:71], v7 offset:0
    ds_read_b128 v[72:75], v7 offset:16384
    ds_read_b128 v[76:79], v7 offset:32768
    ds_read_b128 v[80:83], v7 offset:49152
    s_waitcnt vmcnt(37)
    s_waitcnt lgkmcnt(4)
    v_mfma_f32_16x16x32_bf16 v[20:23], a[4:7], v[84:87], v[20:23]
    v_mfma_f32_16x16x32_bf16 v[24:27], a[4:7], v[88:91], v[24:27]
    v_mfma_f32_16x16x32_bf16 v[28:31], a[4:7], v[92:95], v[28:31]
    v_mfma_f32_16x16x32_bf16 v[32:35], a[4:7], v[96:99], v[32:35]
    s_add_u32 s33, s31, 0xaf000
    buffer_load_dwordx4 a[4:7], v2, s[8:11], s33 offen offset:0
    ds_read_b128 v[84:87], v8 offset:0
    ds_read_b128 v[88:91], v8 offset:16384
    ds_read_b128 v[92:95], v8 offset:32768
    ds_read_b128 v[96:99], v8 offset:49152
    s_waitcnt vmcnt(37)
    s_waitcnt lgkmcnt(4)
    v_mfma_f32_16x16x32_bf16 v[20:23], a[8:11], v[68:71], v[20:23]
    v_mfma_f32_16x16x32_bf16 v[24:27], a[8:11], v[72:75], v[24:27]
    v_mfma_f32_16x16x32_bf16 v[28:31], a[8:11], v[76:79], v[28:31]
    v_mfma_f32_16x16x32_bf16 v[32:35], a[8:11], v[80:83], v[32:35]
    s_add_u32 s33, s31, 0xb6000
    buffer_load_dwordx4 a[8:11], v2, s[8:11], s33 offen offset:0
    ds_read_b128 v[68:71], v5 offset:256
    ds_read_b128 v[72:75], v5 offset:16640
    ds_read_b128 v[76:79], v5 offset:33024
    ds_read_b128 v[80:83], v5 offset:49408
    s_waitcnt vmcnt(37)
    s_waitcnt lgkmcnt(4)
    v_mfma_f32_16x16x32_bf16 v[20:23], a[12:15], v[84:87], v[20:23]
    v_mfma_f32_16x16x32_bf16 v[24:27], a[12:15], v[88:91], v[24:27]
    v_mfma_f32_16x16x32_bf16 v[28:31], a[12:15], v[92:95], v[28:31]
    v_mfma_f32_16x16x32_bf16 v[32:35], a[12:15], v[96:99], v[32:35]
    s_add_u32 s33, s31, 0xbd000
    buffer_load_dwordx4 a[12:15], v2, s[8:11], s33 offen offset:0
    ds_read_b128 v[84:87], v6 offset:256
    ds_read_b128 v[88:91], v6 offset:16640
    ds_read_b128 v[92:95], v6 offset:33024
    ds_read_b128 v[96:99], v6 offset:49408
    s_waitcnt vmcnt(37)
    s_waitcnt lgkmcnt(4)
    v_mfma_f32_16x16x32_bf16 v[20:23], a[16:19], v[68:71], v[20:23]
    v_mfma_f32_16x16x32_bf16 v[24:27], a[16:19], v[72:75], v[24:27]
    v_mfma_f32_16x16x32_bf16 v[28:31], a[16:19], v[76:79], v[28:31]
    v_mfma_f32_16x16x32_bf16 v[32:35], a[16:19], v[80:83], v[32:35]
    s_add_u32 s33, s31, 0xc4000
    buffer_load_dwordx4 a[16:19], v2, s[8:11], s33 offen offset:0
    ds_read_b128 v[68:71], v7 offset:256
    ds_read_b128 v[72:75], v7 offset:16640
    ds_read_b128 v[76:79], v7 offset:33024
    ds_read_b128 v[80:83], v7 offset:49408
    s_waitcnt vmcnt(37)
    s_waitcnt lgkmcnt(4)
    v_mfma_f32_16x16x32_bf16 v[20:23], a[20:23], v[84:87], v[20:23]
    v_mfma_f32_16x16x32_bf16 v[24:27], a[20:23], v[88:91], v[24:27]
    v_mfma_f32_16x16x32_bf16 v[28:31], a[20:23], v[92:95], v[28:31]
    v_mfma_f32_16x16x32_bf16 v[32:35], a[20:23], v[96:99], v[32:35]
    s_add_u32 s33, s31, 0xcb000
    buffer_load_dwordx4 a[20:23], v2, s[8:11], s33 offen offset:0
    ds_read_b128 v[84:87], v8 offset:256
    ds_read_b128 v[88:91], v8 offset:16640
    ds_read_b128 v[92:95], v8 offset:33024
    ds_read_b128 v[96:99], v8 offset:49408
    s_waitcnt vmcnt(37)
    s_waitcnt lgkmcnt(4)
    v_mfma_f32_16x16x32_bf16 v[20:23], a[24:27], v[68:71], v[20:23]
    v_mfma_f32_16x16x32_bf16 v[24:27], a[24:27], v[72:75], v[24:27]
    v_mfma_f32_16x16x32_bf16 v[28:31], a[24:27], v[76:79], v[28:31]
    v_mfma_f32_16x16x32_bf16 v[32:35], a[24:27], v[80:83], v[32:35]
    s_add_u32 s33, s31, 0xd2000
    buffer_load_dwordx4 a[24:27], v2, s[8:11], s33 offen offset:0
    ds_read_b128 v[68:71], v5 offset:512
    ds_read_b128 v[72:75], v5 offset:16896
    ds_read_b128 v[76:79], v5 offset:33280
    ds_read_b128 v[80:83], v5 offset:49664
    s_waitcnt vmcnt(37)
    s_waitcnt lgkmcnt(4)
    v_mfma_f32_16x16x32_bf16 v[20:23], a[28:31], v[84:87], v[20:23]
    v_mfma_f32_16x16x32_bf16 v[24:27], a[28:31], v[88:91], v[24:27]
    v_mfma_f32_16x16x32_bf16 v[28:31], a[28:31], v[92:95], v[28:31]
    v_mfma_f32_16x16x32_bf16 v[32:35], a[28:31], v[96:99], v[32:35]
    s_add_u32 s33, s31, 0xd9000
    buffer_load_dwordx4 a[28:31], v2, s[8:11], s33 offen offset:0
    ds_read_b128 v[84:87], v6 offset:512
    ds_read_b128 v[88:91], v6 offset:16896
    ds_read_b128 v[92:95], v6 offset:33280
    ds_read_b128 v[96:99], v6 offset:49664
    s_waitcnt vmcnt(37)
    s_waitcnt lgkmcnt(4)
    v_mfma_f32_16x16x32_bf16 v[20:23], a[32:35], v[68:71], v[20:23]
    v_mfma_f32_16x16x32_bf16 v[24:27], a[32:35], v[72:75], v[24:27]
    v_mfma_f32_16x16x32_bf16 v[28:31], a[32:35], v[76:79], v[28:31]
    v_mfma_f32_16x16x32_bf16 v[32:35], a[32:35], v[80:83], v[32:35]
    s_add_u32 s33, s31, 0xe0000
    buffer_load_dwordx4 a[32:35], v2, s[8:11], s33 offen offset:0
    ds_read_b128 v[68:71], v7 offset:512
    ds_read_b128 v[72:75], v7 offset:16896
    ds_read_b128 v[76:79], v7 offset:33280
    ds_read_b128 v[80:83], v7 offset:49664
    s_waitcnt vmcnt(37)
    s_waitcnt lgkmcnt(4)
    v_mfma_f32_16x16x32_bf16 v[20:23], a[36:39], v[84:87], v[20:23]
    v_mfma_f32_16x16x32_bf16 v[24:27], a[36:39], v[88:91], v[24:27]
    v_mfma_f32_16x16x32_bf16 v[28:31], a[36:39], v[92:95], v[28:31]
    v_mfma_f32_16x16x32_bf16 v[32:35], a[36:39], v[96:99], v[32:35]
    s_add_u32 s33, s31, 0xe7000
    buffer_load_dwordx4 a[36:39], v2, s[8:11], s33 offen offset:0
    ds_read_b128 v[84:87], v8 offset:512
    ds_read_b128 v[88:91], v8 offset:16896
    ds_read_b128 v[92:95], v8 offset:33280
    ds_read_b128 v[96:99], v8 offset:49664
    s_waitcnt vmcnt(37)
    s_waitcnt lgkmcnt(4)
    v_mfma_f32_16x16x32_bf16 v[20:23], a[40:43], v[68:71], v[20:23]
    v_mfma_f32_16x16x32_bf16 v[24:27], a[40:43], v[72:75], v[24:27]
    v_mfma_f32_16x16x32_bf16 v[28:31], a[40:43], v[76:79], v[28:31]
    v_mfma_f32_16x16x32_bf16 v[32:35], a[40:43], v[80:83], v[32:35]
    s_add_u32 s33, s31, 0xee000
    buffer_load_dwordx4 a[40:43], v2, s[8:11], s33 offen offset:0
    ds_read_b128 v[68:71], v5 offset:768
    ds_read_b128 v[72:75], v5 offset:17152
    ds_read_b128 v[76:79], v5 offset:33536
    ds_read_b128 v[80:83], v5 offset:49920
    s_waitcnt vmcnt(37)
    s_waitcnt lgkmcnt(4)
    v_mfma_f32_16x16x32_bf16 v[20:23], a[44:47], v[84:87], v[20:23]
    v_mfma_f32_16x16x32_bf16 v[24:27], a[44:47], v[88:91], v[24:27]
    v_mfma_f32_16x16x32_bf16 v[28:31], a[44:47], v[92:95], v[28:31]
    v_mfma_f32_16x16x32_bf16 v[32:35], a[44:47], v[96:99], v[32:35]
    s_add_u32 s33, s31, 0xf5000
    buffer_load_dwordx4 a[44:47], v2, s[8:11], s33 offen offset:0
    ds_read_b128 v[84:87], v6 offset:768
    ds_read_b128 v[88:91], v6 offset:17152
    ds_read_b128 v[92:95], v6 offset:33536
    ds_read_b128 v[96:99], v6 offset:49920
    s_waitcnt vmcnt(37)
    s_waitcnt lgkmcnt(4)
    v_mfma_f32_16x16x32_bf16 v[20:23], a[48:51], v[68:71], v[20:23]
    v_mfma_f32_16x16x32_bf16 v[24:27], a[48:51], v[72:75], v[24:27]
    v_mfma_f32_16x16x32_bf16 v[28:31], a[48:51], v[76:79], v[28:31]
    v_mfma_f32_16x16x32_bf16 v[32:35], a[48:51], v[80:83], v[32:35]
    s_add_u32 s33, s31, 0xfc000
    buffer_load_dwordx4 a[48:51], v2, s[8:11], s33 offen offset:0
    s_waitcnt vmcnt(37)
    s_waitcnt lgkmcnt(0)
    v_mfma_f32_16x16x32_bf16 v[20:23], a[52:55], v[84:87], v[20:23]
    v_mfma_f32_16x16x32_bf16 v[24:27], a[52:55], v[88:91], v[24:27]
    v_mfma_f32_16x16x32_bf16 v[28:31], a[52:55], v[92:95], v[28:31]
    v_mfma_f32_16x16x32_bf16 v[32:35], a[52:55], v[96:99], v[32:35]
    s_add_u32 s33, s31, 0x103000
    buffer_load_dwordx4 a[52:55], v2, s[8:11], s33 offen offset:0
    s_waitcnt vmcnt(14)
    ds_write_b128 v158, v[100:103] offset:0
    ds_write_b128 v159, v[104:107] offset:0
    ds_write_b128 v158, v[108:111] offset:256
    ds_write_b128 v159, v[112:115] offset:256
    ds_write_b128 v158, v[116:119] offset:512
    ds_write_b128 v159, v[120:123] offset:512
    ds_write_b128 v158, v[124:127] offset:768
    ds_write_b128 v158, v[128:131] offset:32768
    ds_write_b128 v159, v[132:135] offset:32768
    ds_write_b128 v158, v[136:139] offset:33024
    ds_write_b128 v159, v[140:143] offset:33024
    ds_write_b128 v158, v[144:147] offset:33280
    ds_write_b128 v159, v[148:151] offset:33280
    ds_write_b128 v158, v[152:155] offset:33536
    s_add_u32 s34, s30, 1792
    buffer_load_dwordx4 v[100:103], v14, s[4:7], s34 offen offset:0
    buffer_load_dwordx4 v[104:107], v14, s[4:7], s34 offen offset:128
    buffer_load_dwordx4 v[108:111], v14, s[4:7], s34 offen offset:256
    buffer_load_dwordx4 v[112:115], v14, s[4:7], s34 offen offset:384
    buffer_load_dwordx4 v[116:119], v14, s[4:7], s34 offen offset:512
    buffer_load_dwordx4 v[120:123], v14, s[4:7], s34 offen offset:640
    buffer_load_dwordx4 v[124:127], v14, s[4:7], s34 offen offset:768
    s_add_u32 s34, s30, 116480
    buffer_load_dwordx4 v[128:131], v14, s[4:7], s34 offen offset:0
    buffer_load_dwordx4 v[132:135], v14, s[4:7], s34 offen offset:128
    buffer_load_dwordx4 v[136:139], v14, s[4:7], s34 offen offset:256
    buffer_load_dwordx4 v[140:143], v14, s[4:7], s34 offen offset:384
    buffer_load_dwordx4 v[144:147], v14, s[4:7], s34 offen offset:512
    buffer_load_dwordx4 v[148:151], v14, s[4:7], s34 offen offset:640
    buffer_load_dwordx4 v[152:155], v14, s[4:7], s34 offen offset:768
    s_waitcnt lgkmcnt(0)
    s_barrier
    ds_read_b128 v[68:71], v10 offset:0
    ds_read_b128 v[72:75], v10 offset:16384
    ds_read_b128 v[76:79], v10 offset:32768
    ds_read_b128 v[80:83], v10 offset:49152
    ds_read_b128 v[84:87], v11 offset:0
    ds_read_b128 v[88:91], v11 offset:16384
    ds_read_b128 v[92:95], v11 offset:32768
    ds_read_b128 v[96:99], v11 offset:49152
    s_waitcnt lgkmcnt(4)
    v_mfma_f32_16x16x32_bf16 v[20:23], a[56:59], v[68:71], v[20:23]
    v_mfma_f32_16x16x32_bf16 v[24:27], a[56:59], v[72:75], v[24:27]
    v_mfma_f32_16x16x32_bf16 v[28:31], a[56:59], v[76:79], v[28:31]
    v_mfma_f32_16x16x32_bf16 v[32:35], a[56:59], v[80:83], v[32:35]
    s_add_u32 s33, s31, 0x10a000
    buffer_load_dwordx4 a[56:59], v2, s[8:11], s33 offen offset:0
    ds_read_b128 v[68:71], v12 offset:0
    ds_read_b128 v[72:75], v12 offset:16384
    ds_read_b128 v[76:79], v12 offset:32768
    ds_read_b128 v[80:83], v12 offset:49152
    s_waitcnt lgkmcnt(4)
    v_mfma_f32_16x16x32_bf16 v[20:23], a[60:63], v[84:87], v[20:23]
    v_mfma_f32_16x16x32_bf16 v[24:27], a[60:63], v[88:91], v[24:27]
    v_mfma_f32_16x16x32_bf16 v[28:31], a[60:63], v[92:95], v[28:31]
    v_mfma_f32_16x16x32_bf16 v[32:35], a[60:63], v[96:99], v[32:35]
    s_add_u32 s33, s31, 0x111000
    buffer_load_dwordx4 a[60:63], v2, s[8:11], s33 offen offset:0
    ds_read_b128 v[84:87], v13 offset:0
    ds_read_b128 v[88:91], v13 offset:16384
    ds_read_b128 v[92:95], v13 offset:32768
    ds_read_b128 v[96:99], v13 offset:49152
    s_waitcnt lgkmcnt(4)
    v_mfma_f32_16x16x32_bf16 v[20:23], a[64:67], v[68:71], v[20:23]
    v_mfma_f32_16x16x32_bf16 v[24:27], a[64:67], v[72:75], v[24:27]
    v_mfma_f32_16x16x32_bf16 v[28:31], a[64:67], v[76:79], v[28:31]
    v_mfma_f32_16x16x32_bf16 v[32:35], a[64:67], v[80:83], v[32:35]
    s_add_u32 s33, s31, 0x118000
    buffer_load_dwordx4 a[64:67], v2, s[8:11], s33 offen offset:0
    ds_read_b128 v[68:71], v10 offset:256
    ds_read_b128 v[72:75], v10 offset:16640
    ds_read_b128 v[76:79], v10 offset:33024
    ds_read_b128 v[80:83], v10 offset:49408
    s_waitcnt lgkmcnt(4)
    v_mfma_f32_16x16x32_bf16 v[20:23], a[68:71], v[84:87], v[20:23]
    v_mfma_f32_16x16x32_bf16 v[24:27], a[68:71], v[88:91], v[24:27]
    v_mfma_f32_16x16x32_bf16 v[28:31], a[68:71], v[92:95], v[28:31]
    v_mfma_f32_16x16x32_bf16 v[32:35], a[68:71], v[96:99], v[32:35]
    s_add_u32 s33, s31, 0x11f000
    buffer_load_dwordx4 a[68:71], v2, s[8:11], s33 offen offset:0
    ds_read_b128 v[84:87], v11 offset:256
    ds_read_b128 v[88:91], v11 offset:16640
    ds_read_b128 v[92:95], v11 offset:33024
    ds_read_b128 v[96:99], v11 offset:49408
    s_waitcnt lgkmcnt(4)
    v_mfma_f32_16x16x32_bf16 v[20:23], a[72:75], v[68:71], v[20:23]
    v_mfma_f32_16x16x32_bf16 v[24:27], a[72:75], v[72:75], v[24:27]
    v_mfma_f32_16x16x32_bf16 v[28:31], a[72:75], v[76:79], v[28:31]
    v_mfma_f32_16x16x32_bf16 v[32:35], a[72:75], v[80:83], v[32:35]
    s_add_u32 s33, s31, 0x126000
    buffer_load_dwordx4 a[72:75], v2, s[8:11], s33 offen offset:0
    ds_read_b128 v[68:71], v12 offset:256
    ds_read_b128 v[72:75], v12 offset:16640
    ds_read_b128 v[76:79], v12 offset:33024
    ds_read_b128 v[80:83], v12 offset:49408
    s_waitcnt lgkmcnt(4)
    v_mfma_f32_16x16x32_bf16 v[20:23], a[76:79], v[84:87], v[20:23]
    v_mfma_f32_16x16x32_bf16 v[24:27], a[76:79], v[88:91], v[24:27]
    v_mfma_f32_16x16x32_bf16 v[28:31], a[76:79], v[92:95], v[28:31]
    v_mfma_f32_16x16x32_bf16 v[32:35], a[76:79], v[96:99], v[32:35]
    s_add_u32 s33, s31, 0x12d000
    buffer_load_dwordx4 a[76:79], v2, s[8:11], s33 offen offset:0
    ds_read_b128 v[84:87], v13 offset:256
    ds_read_b128 v[88:91], v13 offset:16640
    ds_read_b128 v[92:95], v13 offset:33024
    ds_read_b128 v[96:99], v13 offset:49408
    s_waitcnt lgkmcnt(4)
    v_mfma_f32_16x16x32_bf16 v[20:23], a[80:83], v[68:71], v[20:23]
    v_mfma_f32_16x16x32_bf16 v[24:27], a[80:83], v[72:75], v[24:27]
    v_mfma_f32_16x16x32_bf16 v[28:31], a[80:83], v[76:79], v[28:31]
    v_mfma_f32_16x16x32_bf16 v[32:35], a[80:83], v[80:83], v[32:35]
    s_add_u32 s33, s31, 0x134000
    buffer_load_dwordx4 a[80:83], v2, s[8:11], s33 offen offset:0
    ds_read_b128 v[68:71], v10 offset:512
    ds_read_b128 v[72:75], v10 offset:16896
    ds_read_b128 v[76:79], v10 offset:33280
    ds_read_b128 v[80:83], v10 offset:49664
    s_waitcnt lgkmcnt(4)
    v_mfma_f32_16x16x32_bf16 v[20:23], a[84:87], v[84:87], v[20:23]
    v_mfma_f32_16x16x32_bf16 v[24:27], a[84:87], v[88:91], v[24:27]
    v_mfma_f32_16x16x32_bf16 v[28:31], a[84:87], v[92:95], v[28:31]
    v_mfma_f32_16x16x32_bf16 v[32:35], a[84:87], v[96:99], v[32:35]
    s_add_u32 s33, s31, 0x13b000
    buffer_load_dwordx4 a[84:87], v2, s[8:11], s33 offen offset:0
    ds_read_b128 v[84:87], v11 offset:512
    ds_read_b128 v[88:91], v11 offset:16896
    ds_read_b128 v[92:95], v11 offset:33280
    ds_read_b128 v[96:99], v11 offset:49664
    s_waitcnt lgkmcnt(4)
    v_mfma_f32_16x16x32_bf16 v[20:23], a[88:91], v[68:71], v[20:23]
    v_mfma_f32_16x16x32_bf16 v[24:27], a[88:91], v[72:75], v[24:27]
    v_mfma_f32_16x16x32_bf16 v[28:31], a[88:91], v[76:79], v[28:31]
    v_mfma_f32_16x16x32_bf16 v[32:35], a[88:91], v[80:83], v[32:35]
    s_add_u32 s33, s31, 0x142000
    buffer_load_dwordx4 a[88:91], v2, s[8:11], s33 offen offset:0
    ds_read_b128 v[68:71], v12 offset:512
    ds_read_b128 v[72:75], v12 offset:16896
    ds_read_b128 v[76:79], v12 offset:33280
    ds_read_b128 v[80:83], v12 offset:49664
    s_waitcnt lgkmcnt(4)
    v_mfma_f32_16x16x32_bf16 v[20:23], a[92:95], v[84:87], v[20:23]
    v_mfma_f32_16x16x32_bf16 v[24:27], a[92:95], v[88:91], v[24:27]
    v_mfma_f32_16x16x32_bf16 v[28:31], a[92:95], v[92:95], v[28:31]
    v_mfma_f32_16x16x32_bf16 v[32:35], a[92:95], v[96:99], v[32:35]
    s_add_u32 s33, s31, 0x149000
    buffer_load_dwordx4 a[92:95], v2, s[8:11], s33 offen offset:0
    ds_read_b128 v[84:87], v13 offset:512
    ds_read_b128 v[88:91], v13 offset:16896
    ds_read_b128 v[92:95], v13 offset:33280
    ds_read_b128 v[96:99], v13 offset:49664
    s_waitcnt vmcnt(37)
    s_waitcnt lgkmcnt(4)
    v_mfma_f32_16x16x32_bf16 v[20:23], a[0:3], v[68:71], v[20:23]
    v_mfma_f32_16x16x32_bf16 v[24:27], a[0:3], v[72:75], v[24:27]
    v_mfma_f32_16x16x32_bf16 v[28:31], a[0:3], v[76:79], v[28:31]
    v_mfma_f32_16x16x32_bf16 v[32:35], a[0:3], v[80:83], v[32:35]
    s_add_u32 s33, s31, 0x150000
    buffer_load_dwordx4 a[0:3], v2, s[8:11], s33 offen offset:0
    ds_read_b128 v[68:71], v10 offset:768
    ds_read_b128 v[72:75], v10 offset:17152
    ds_read_b128 v[76:79], v10 offset:33536
    ds_read_b128 v[80:83], v10 offset:49920
    s_waitcnt vmcnt(37)
    s_waitcnt lgkmcnt(4)
    v_mfma_f32_16x16x32_bf16 v[20:23], a[4:7], v[84:87], v[20:23]
    v_mfma_f32_16x16x32_bf16 v[24:27], a[4:7], v[88:91], v[24:27]
    v_mfma_f32_16x16x32_bf16 v[28:31], a[4:7], v[92:95], v[28:31]
    v_mfma_f32_16x16x32_bf16 v[32:35], a[4:7], v[96:99], v[32:35]
    s_add_u32 s33, s31, 0x157000
    buffer_load_dwordx4 a[4:7], v2, s[8:11], s33 offen offset:0
    ds_read_b128 v[84:87], v11 offset:768
    ds_read_b128 v[88:91], v11 offset:17152
    ds_read_b128 v[92:95], v11 offset:33536
    ds_read_b128 v[96:99], v11 offset:49920
    s_waitcnt vmcnt(37)
    s_waitcnt lgkmcnt(4)
    v_mfma_f32_16x16x32_bf16 v[20:23], a[8:11], v[68:71], v[20:23]
    v_mfma_f32_16x16x32_bf16 v[24:27], a[8:11], v[72:75], v[24:27]
    v_mfma_f32_16x16x32_bf16 v[28:31], a[8:11], v[76:79], v[28:31]
    v_mfma_f32_16x16x32_bf16 v[32:35], a[8:11], v[80:83], v[32:35]
    s_add_u32 s33, s31, 0x15e000
    buffer_load_dwordx4 a[8:11], v2, s[8:11], s33 offen offset:0
    s_waitcnt vmcnt(37)
    s_waitcnt lgkmcnt(0)
    v_mfma_f32_16x16x32_bf16 v[20:23], a[12:15], v[84:87], v[20:23]
    v_mfma_f32_16x16x32_bf16 v[24:27], a[12:15], v[88:91], v[24:27]
    v_mfma_f32_16x16x32_bf16 v[28:31], a[12:15], v[92:95], v[28:31]
    v_mfma_f32_16x16x32_bf16 v[32:35], a[12:15], v[96:99], v[32:35]
    s_add_u32 s33, s31, 0x165000
    buffer_load_dwordx4 a[12:15], v2, s[8:11], s33 offen offset:0
    s_waitcnt vmcnt(14)
    ds_write_b128 v18, v[100:103] offset:0
    ds_write_b128 v19, v[104:107] offset:0
    ds_write_b128 v18, v[108:111] offset:256
    ds_write_b128 v19, v[112:115] offset:256
    ds_write_b128 v18, v[116:119] offset:512
    ds_write_b128 v19, v[120:123] offset:512
    ds_write_b128 v18, v[124:127] offset:768
    ds_write_b128 v18, v[128:131] offset:32768
    ds_write_b128 v19, v[132:135] offset:32768
    ds_write_b128 v18, v[136:139] offset:33024
    ds_write_b128 v19, v[140:143] offset:33024
    ds_write_b128 v18, v[144:147] offset:33280
    ds_write_b128 v19, v[148:151] offset:33280
    ds_write_b128 v18, v[152:155] offset:33536
    s_add_u32 s34, s30, 2688
    buffer_load_dwordx4 v[100:103], v14, s[4:7], s34 offen offset:0
    buffer_load_dwordx4 v[104:107], v14, s[4:7], s34 offen offset:128
    buffer_load_dwordx4 v[108:111], v14, s[4:7], s34 offen offset:256
    buffer_load_dwordx4 v[112:115], v14, s[4:7], s34 offen offset:384
    buffer_load_dwordx4 v[116:119], v14, s[4:7], s34 offen offset:512
    buffer_load_dwordx4 v[120:123], v14, s[4:7], s34 offen offset:640
    buffer_load_dwordx4 v[124:127], v14, s[4:7], s34 offen offset:768
    s_add_u32 s34, s30, 117376
    buffer_load_dwordx4 v[128:131], v14, s[4:7], s34 offen offset:0
    buffer_load_dwordx4 v[132:135], v14, s[4:7], s34 offen offset:128
    buffer_load_dwordx4 v[136:139], v14, s[4:7], s34 offen offset:256
    buffer_load_dwordx4 v[140:143], v14, s[4:7], s34 offen offset:384
    buffer_load_dwordx4 v[144:147], v14, s[4:7], s34 offen offset:512
    buffer_load_dwordx4 v[148:151], v14, s[4:7], s34 offen offset:640
    buffer_load_dwordx4 v[152:155], v14, s[4:7], s34 offen offset:768
    s_waitcnt lgkmcnt(0)
    s_barrier
    ds_read_b128 v[68:71], v5 offset:0
    ds_read_b128 v[72:75], v5 offset:16384
    ds_read_b128 v[76:79], v5 offset:32768
    ds_read_b128 v[80:83], v5 offset:49152
    ds_read_b128 v[84:87], v6 offset:0
    ds_read_b128 v[88:91], v6 offset:16384
    ds_read_b128 v[92:95], v6 offset:32768
    ds_read_b128 v[96:99], v6 offset:49152
    s_waitcnt lgkmcnt(4)
    v_mfma_f32_16x16x32_bf16 v[20:23], a[16:19], v[68:71], v[20:23]
    v_mfma_f32_16x16x32_bf16 v[24:27], a[16:19], v[72:75], v[24:27]
    v_mfma_f32_16x16x32_bf16 v[28:31], a[16:19], v[76:79], v[28:31]
    v_mfma_f32_16x16x32_bf16 v[32:35], a[16:19], v[80:83], v[32:35]
    s_add_u32 s33, s31, 0x16c000
    buffer_load_dwordx4 a[16:19], v2, s[8:11], s33 offen offset:0
    ds_read_b128 v[68:71], v7 offset:0
    ds_read_b128 v[72:75], v7 offset:16384
    ds_read_b128 v[76:79], v7 offset:32768
    ds_read_b128 v[80:83], v7 offset:49152
    s_waitcnt lgkmcnt(4)
    v_mfma_f32_16x16x32_bf16 v[20:23], a[20:23], v[84:87], v[20:23]
    v_mfma_f32_16x16x32_bf16 v[24:27], a[20:23], v[88:91], v[24:27]
    v_mfma_f32_16x16x32_bf16 v[28:31], a[20:23], v[92:95], v[28:31]
    v_mfma_f32_16x16x32_bf16 v[32:35], a[20:23], v[96:99], v[32:35]
    s_add_u32 s33, s31, 0x173000
    buffer_load_dwordx4 a[20:23], v2, s[8:11], s33 offen offset:0
    ds_read_b128 v[84:87], v8 offset:0
    ds_read_b128 v[88:91], v8 offset:16384
    ds_read_b128 v[92:95], v8 offset:32768
    ds_read_b128 v[96:99], v8 offset:49152
    s_waitcnt lgkmcnt(4)
    v_mfma_f32_16x16x32_bf16 v[20:23], a[24:27], v[68:71], v[20:23]
    v_mfma_f32_16x16x32_bf16 v[24:27], a[24:27], v[72:75], v[24:27]
    v_mfma_f32_16x16x32_bf16 v[28:31], a[24:27], v[76:79], v[28:31]
    v_mfma_f32_16x16x32_bf16 v[32:35], a[24:27], v[80:83], v[32:35]
    s_add_u32 s33, s31, 0x17a000
    buffer_load_dwordx4 a[24:27], v2, s[8:11], s33 offen offset:0
    ds_read_b128 v[68:71], v5 offset:256
    ds_read_b128 v[72:75], v5 offset:16640
    ds_read_b128 v[76:79], v5 offset:33024
    ds_read_b128 v[80:83], v5 offset:49408
    s_waitcnt lgkmcnt(4)
    v_mfma_f32_16x16x32_bf16 v[20:23], a[28:31], v[84:87], v[20:23]
    v_mfma_f32_16x16x32_bf16 v[24:27], a[28:31], v[88:91], v[24:27]
    v_mfma_f32_16x16x32_bf16 v[28:31], a[28:31], v[92:95], v[28:31]
    v_mfma_f32_16x16x32_bf16 v[32:35], a[28:31], v[96:99], v[32:35]
    s_add_u32 s33, s31, 0x181000
    buffer_load_dwordx4 a[28:31], v2, s[8:11], s33 offen offset:0
    ds_read_b128 v[84:87], v6 offset:256
    ds_read_b128 v[88:91], v6 offset:16640
    ds_read_b128 v[92:95], v6 offset:33024
    ds_read_b128 v[96:99], v6 offset:49408
    s_waitcnt lgkmcnt(4)
    v_mfma_f32_16x16x32_bf16 v[20:23], a[32:35], v[68:71], v[20:23]
    v_mfma_f32_16x16x32_bf16 v[24:27], a[32:35], v[72:75], v[24:27]
    v_mfma_f32_16x16x32_bf16 v[28:31], a[32:35], v[76:79], v[28:31]
    v_mfma_f32_16x16x32_bf16 v[32:35], a[32:35], v[80:83], v[32:35]
    ds_read_b128 v[68:71], v7 offset:256
    ds_read_b128 v[72:75], v7 offset:16640
    ds_read_b128 v[76:79], v7 offset:33024
    ds_read_b128 v[80:83], v7 offset:49408
    s_waitcnt lgkmcnt(4)
    v_mfma_f32_16x16x32_bf16 v[20:23], a[36:39], v[84:87], v[20:23]
    v_mfma_f32_16x16x32_bf16 v[24:27], a[36:39], v[88:91], v[24:27]
    v_mfma_f32_16x16x32_bf16 v[28:31], a[36:39], v[92:95], v[28:31]
    v_mfma_f32_16x16x32_bf16 v[32:35], a[36:39], v[96:99], v[32:35]
    ds_read_b128 v[84:87], v8 offset:256
    ds_read_b128 v[88:91], v8 offset:16640
    ds_read_b128 v[92:95], v8 offset:33024
    ds_read_b128 v[96:99], v8 offset:49408
    s_waitcnt lgkmcnt(4)
    v_mfma_f32_16x16x32_bf16 v[20:23], a[40:43], v[68:71], v[20:23]
    v_mfma_f32_16x16x32_bf16 v[24:27], a[40:43], v[72:75], v[24:27]
    v_mfma_f32_16x16x32_bf16 v[28:31], a[40:43], v[76:79], v[28:31]
    v_mfma_f32_16x16x32_bf16 v[32:35], a[40:43], v[80:83], v[32:35]
    ds_read_b128 v[68:71], v5 offset:512
    ds_read_b128 v[72:75], v5 offset:16896
    ds_read_b128 v[76:79], v5 offset:33280
    ds_read_b128 v[80:83], v5 offset:49664
    s_waitcnt lgkmcnt(4)
    v_mfma_f32_16x16x32_bf16 v[20:23], a[44:47], v[84:87], v[20:23]
    v_mfma_f32_16x16x32_bf16 v[24:27], a[44:47], v[88:91], v[24:27]
    v_mfma_f32_16x16x32_bf16 v[28:31], a[44:47], v[92:95], v[28:31]
    v_mfma_f32_16x16x32_bf16 v[32:35], a[44:47], v[96:99], v[32:35]
    ds_read_b128 v[84:87], v6 offset:512
    ds_read_b128 v[88:91], v6 offset:16896
    ds_read_b128 v[92:95], v6 offset:33280
    ds_read_b128 v[96:99], v6 offset:49664
    s_waitcnt lgkmcnt(4)
    v_mfma_f32_16x16x32_bf16 v[20:23], a[48:51], v[68:71], v[20:23]
    v_mfma_f32_16x16x32_bf16 v[24:27], a[48:51], v[72:75], v[24:27]
    v_mfma_f32_16x16x32_bf16 v[28:31], a[48:51], v[76:79], v[28:31]
    v_mfma_f32_16x16x32_bf16 v[32:35], a[48:51], v[80:83], v[32:35]
    ds_read_b128 v[68:71], v7 offset:512
    ds_read_b128 v[72:75], v7 offset:16896
    ds_read_b128 v[76:79], v7 offset:33280
    ds_read_b128 v[80:83], v7 offset:49664
    s_waitcnt lgkmcnt(4)
    v_mfma_f32_16x16x32_bf16 v[20:23], a[52:55], v[84:87], v[20:23]
    v_mfma_f32_16x16x32_bf16 v[24:27], a[52:55], v[88:91], v[24:27]
    v_mfma_f32_16x16x32_bf16 v[28:31], a[52:55], v[92:95], v[28:31]
    v_mfma_f32_16x16x32_bf16 v[32:35], a[52:55], v[96:99], v[32:35]
    ds_read_b128 v[84:87], v8 offset:512
    ds_read_b128 v[88:91], v8 offset:16896
    ds_read_b128 v[92:95], v8 offset:33280
    ds_read_b128 v[96:99], v8 offset:49664
    s_waitcnt vmcnt(31)
    s_waitcnt lgkmcnt(4)
    v_mfma_f32_16x16x32_bf16 v[20:23], a[56:59], v[68:71], v[20:23]
    v_mfma_f32_16x16x32_bf16 v[24:27], a[56:59], v[72:75], v[24:27]
    v_mfma_f32_16x16x32_bf16 v[28:31], a[56:59], v[76:79], v[28:31]
    v_mfma_f32_16x16x32_bf16 v[32:35], a[56:59], v[80:83], v[32:35]
    ds_read_b128 v[68:71], v5 offset:768
    ds_read_b128 v[72:75], v5 offset:17152
    ds_read_b128 v[76:79], v5 offset:33536
    ds_read_b128 v[80:83], v5 offset:49920
    s_waitcnt vmcnt(30)
    s_waitcnt lgkmcnt(4)
    v_mfma_f32_16x16x32_bf16 v[20:23], a[60:63], v[84:87], v[20:23]
    v_mfma_f32_16x16x32_bf16 v[24:27], a[60:63], v[88:91], v[24:27]
    v_mfma_f32_16x16x32_bf16 v[28:31], a[60:63], v[92:95], v[28:31]
    v_mfma_f32_16x16x32_bf16 v[32:35], a[60:63], v[96:99], v[32:35]
    ds_read_b128 v[84:87], v6 offset:768
    ds_read_b128 v[88:91], v6 offset:17152
    ds_read_b128 v[92:95], v6 offset:33536
    ds_read_b128 v[96:99], v6 offset:49920
    s_waitcnt vmcnt(29)
    s_waitcnt lgkmcnt(4)
    v_mfma_f32_16x16x32_bf16 v[20:23], a[64:67], v[68:71], v[20:23]
    v_mfma_f32_16x16x32_bf16 v[24:27], a[64:67], v[72:75], v[24:27]
    v_mfma_f32_16x16x32_bf16 v[28:31], a[64:67], v[76:79], v[28:31]
    v_mfma_f32_16x16x32_bf16 v[32:35], a[64:67], v[80:83], v[32:35]
    s_waitcnt vmcnt(28)
    s_waitcnt lgkmcnt(0)
    v_mfma_f32_16x16x32_bf16 v[20:23], a[68:71], v[84:87], v[20:23]
    v_mfma_f32_16x16x32_bf16 v[24:27], a[68:71], v[88:91], v[24:27]
    v_mfma_f32_16x16x32_bf16 v[28:31], a[68:71], v[92:95], v[28:31]
    v_mfma_f32_16x16x32_bf16 v[32:35], a[68:71], v[96:99], v[32:35]
    s_waitcnt vmcnt(4)
    ds_write_b128 v158, v[100:103] offset:0
    ds_write_b128 v159, v[104:107] offset:0
    ds_write_b128 v158, v[108:111] offset:256
    ds_write_b128 v159, v[112:115] offset:256
    ds_write_b128 v158, v[116:119] offset:512
    ds_write_b128 v159, v[120:123] offset:512
    ds_write_b128 v158, v[124:127] offset:768
    ds_write_b128 v158, v[128:131] offset:32768
    ds_write_b128 v159, v[132:135] offset:32768
    ds_write_b128 v158, v[136:139] offset:33024
    ds_write_b128 v159, v[140:143] offset:33024
    ds_write_b128 v158, v[144:147] offset:33280
    ds_write_b128 v159, v[148:151] offset:33280
    ds_write_b128 v158, v[152:155] offset:33536
    s_waitcnt lgkmcnt(0)
    s_barrier
    ds_read_b128 v[68:71], v10 offset:0
    ds_read_b128 v[72:75], v10 offset:16384
    ds_read_b128 v[76:79], v10 offset:32768
    ds_read_b128 v[80:83], v10 offset:49152
    ds_read_b128 v[84:87], v11 offset:0
    ds_read_b128 v[88:91], v11 offset:16384
    ds_read_b128 v[92:95], v11 offset:32768
    ds_read_b128 v[96:99], v11 offset:49152
    s_waitcnt lgkmcnt(4)
    v_mfma_f32_16x16x32_bf16 v[20:23], a[72:75], v[68:71], v[20:23]
    v_mfma_f32_16x16x32_bf16 v[24:27], a[72:75], v[72:75], v[24:27]
    v_mfma_f32_16x16x32_bf16 v[28:31], a[72:75], v[76:79], v[28:31]
    v_mfma_f32_16x16x32_bf16 v[32:35], a[72:75], v[80:83], v[32:35]
    ds_read_b128 v[68:71], v12 offset:0
    ds_read_b128 v[72:75], v12 offset:16384
    ds_read_b128 v[76:79], v12 offset:32768
    ds_read_b128 v[80:83], v12 offset:49152
    s_waitcnt lgkmcnt(4)
    v_mfma_f32_16x16x32_bf16 v[20:23], a[76:79], v[84:87], v[20:23]
    v_mfma_f32_16x16x32_bf16 v[24:27], a[76:79], v[88:91], v[24:27]
    v_mfma_f32_16x16x32_bf16 v[28:31], a[76:79], v[92:95], v[28:31]
    v_mfma_f32_16x16x32_bf16 v[32:35], a[76:79], v[96:99], v[32:35]
    ds_read_b128 v[84:87], v13 offset:0
    ds_read_b128 v[88:91], v13 offset:16384
    ds_read_b128 v[92:95], v13 offset:32768
    ds_read_b128 v[96:99], v13 offset:49152
    s_waitcnt lgkmcnt(4)
    v_mfma_f32_16x16x32_bf16 v[20:23], a[80:83], v[68:71], v[20:23]
    v_mfma_f32_16x16x32_bf16 v[24:27], a[80:83], v[72:75], v[24:27]
    v_mfma_f32_16x16x32_bf16 v[28:31], a[80:83], v[76:79], v[28:31]
    v_mfma_f32_16x16x32_bf16 v[32:35], a[80:83], v[80:83], v[32:35]
    ds_read_b128 v[68:71], v10 offset:256
    ds_read_b128 v[72:75], v10 offset:16640
    ds_read_b128 v[76:79], v10 offset:33024
    ds_read_b128 v[80:83], v10 offset:49408
    s_waitcnt lgkmcnt(4)
    v_mfma_f32_16x16x32_bf16 v[20:23], a[84:87], v[84:87], v[20:23]
    v_mfma_f32_16x16x32_bf16 v[24:27], a[84:87], v[88:91], v[24:27]
    v_mfma_f32_16x16x32_bf16 v[28:31], a[84:87], v[92:95], v[28:31]
    v_mfma_f32_16x16x32_bf16 v[32:35], a[84:87], v[96:99], v[32:35]
    ds_read_b128 v[84:87], v11 offset:256
    ds_read_b128 v[88:91], v11 offset:16640
    ds_read_b128 v[92:95], v11 offset:33024
    ds_read_b128 v[96:99], v11 offset:49408
    s_waitcnt lgkmcnt(4)
    v_mfma_f32_16x16x32_bf16 v[20:23], a[88:91], v[68:71], v[20:23]
    v_mfma_f32_16x16x32_bf16 v[24:27], a[88:91], v[72:75], v[24:27]
    v_mfma_f32_16x16x32_bf16 v[28:31], a[88:91], v[76:79], v[28:31]
    v_mfma_f32_16x16x32_bf16 v[32:35], a[88:91], v[80:83], v[32:35]
    ds_read_b128 v[68:71], v12 offset:256
    ds_read_b128 v[72:75], v12 offset:16640
    ds_read_b128 v[76:79], v12 offset:33024
    ds_read_b128 v[80:83], v12 offset:49408
    s_waitcnt lgkmcnt(4)
    v_mfma_f32_16x16x32_bf16 v[20:23], a[92:95], v[84:87], v[20:23]
    v_mfma_f32_16x16x32_bf16 v[24:27], a[92:95], v[88:91], v[24:27]
    v_mfma_f32_16x16x32_bf16 v[28:31], a[92:95], v[92:95], v[28:31]
    v_mfma_f32_16x16x32_bf16 v[32:35], a[92:95], v[96:99], v[32:35]
    ds_read_b128 v[84:87], v13 offset:256
    ds_read_b128 v[88:91], v13 offset:16640
    ds_read_b128 v[92:95], v13 offset:33024
    ds_read_b128 v[96:99], v13 offset:49408
    s_waitcnt lgkmcnt(4)
    v_mfma_f32_16x16x32_bf16 v[20:23], a[0:3], v[68:71], v[20:23]
    v_mfma_f32_16x16x32_bf16 v[24:27], a[0:3], v[72:75], v[24:27]
    v_mfma_f32_16x16x32_bf16 v[28:31], a[0:3], v[76:79], v[28:31]
    v_mfma_f32_16x16x32_bf16 v[32:35], a[0:3], v[80:83], v[32:35]
    ds_read_b128 v[68:71], v10 offset:512
    ds_read_b128 v[72:75], v10 offset:16896
    ds_read_b128 v[76:79], v10 offset:33280
    ds_read_b128 v[80:83], v10 offset:49664
    s_waitcnt lgkmcnt(4)
    v_mfma_f32_16x16x32_bf16 v[20:23], a[4:7], v[84:87], v[20:23]
    v_mfma_f32_16x16x32_bf16 v[24:27], a[4:7], v[88:91], v[24:27]
    v_mfma_f32_16x16x32_bf16 v[28:31], a[4:7], v[92:95], v[28:31]
    v_mfma_f32_16x16x32_bf16 v[32:35], a[4:7], v[96:99], v[32:35]
    ds_read_b128 v[84:87], v11 offset:512
    ds_read_b128 v[88:91], v11 offset:16896
    ds_read_b128 v[92:95], v11 offset:33280
    ds_read_b128 v[96:99], v11 offset:49664
    s_waitcnt lgkmcnt(4)
    v_mfma_f32_16x16x32_bf16 v[20:23], a[8:11], v[68:71], v[20:23]
    v_mfma_f32_16x16x32_bf16 v[24:27], a[8:11], v[72:75], v[24:27]
    v_mfma_f32_16x16x32_bf16 v[28:31], a[8:11], v[76:79], v[28:31]
    v_mfma_f32_16x16x32_bf16 v[32:35], a[8:11], v[80:83], v[32:35]
    ds_read_b128 v[68:71], v12 offset:512
    ds_read_b128 v[72:75], v12 offset:16896
    ds_read_b128 v[76:79], v12 offset:33280
    ds_read_b128 v[80:83], v12 offset:49664
    s_waitcnt lgkmcnt(4)
    v_mfma_f32_16x16x32_bf16 v[20:23], a[12:15], v[84:87], v[20:23]
    v_mfma_f32_16x16x32_bf16 v[24:27], a[12:15], v[88:91], v[24:27]
    v_mfma_f32_16x16x32_bf16 v[28:31], a[12:15], v[92:95], v[28:31]
    v_mfma_f32_16x16x32_bf16 v[32:35], a[12:15], v[96:99], v[32:35]
    ds_read_b128 v[84:87], v13 offset:512
    ds_read_b128 v[88:91], v13 offset:16896
    ds_read_b128 v[92:95], v13 offset:33280
    ds_read_b128 v[96:99], v13 offset:49664
    s_waitcnt vmcnt(3)
    s_waitcnt lgkmcnt(4)
    v_mfma_f32_16x16x32_bf16 v[20:23], a[16:19], v[68:71], v[20:23]
    v_mfma_f32_16x16x32_bf16 v[24:27], a[16:19], v[72:75], v[24:27]
    v_mfma_f32_16x16x32_bf16 v[28:31], a[16:19], v[76:79], v[28:31]
    v_mfma_f32_16x16x32_bf16 v[32:35], a[16:19], v[80:83], v[32:35]
    ds_read_b128 v[68:71], v10 offset:768
    ds_read_b128 v[72:75], v10 offset:17152
    ds_read_b128 v[76:79], v10 offset:33536
    ds_read_b128 v[80:83], v10 offset:49920
    s_waitcnt vmcnt(2)
    s_waitcnt lgkmcnt(4)
    v_mfma_f32_16x16x32_bf16 v[20:23], a[20:23], v[84:87], v[20:23]
    v_mfma_f32_16x16x32_bf16 v[24:27], a[20:23], v[88:91], v[24:27]
    v_mfma_f32_16x16x32_bf16 v[28:31], a[20:23], v[92:95], v[28:31]
    v_mfma_f32_16x16x32_bf16 v[32:35], a[20:23], v[96:99], v[32:35]
    ds_read_b128 v[84:87], v11 offset:768
    ds_read_b128 v[88:91], v11 offset:17152
    ds_read_b128 v[92:95], v11 offset:33536
    ds_read_b128 v[96:99], v11 offset:49920
    s_waitcnt vmcnt(1)
    s_waitcnt lgkmcnt(4)
    v_mfma_f32_16x16x32_bf16 v[20:23], a[24:27], v[68:71], v[20:23]
    v_mfma_f32_16x16x32_bf16 v[24:27], a[24:27], v[72:75], v[24:27]
    v_mfma_f32_16x16x32_bf16 v[28:31], a[24:27], v[76:79], v[28:31]
    v_mfma_f32_16x16x32_bf16 v[32:35], a[24:27], v[80:83], v[32:35]
    s_waitcnt vmcnt(0)
    s_waitcnt lgkmcnt(0)
    v_mfma_f32_16x16x32_bf16 v[20:23], a[28:31], v[84:87], v[20:23]
    v_mfma_f32_16x16x32_bf16 v[24:27], a[28:31], v[88:91], v[24:27]
    v_mfma_f32_16x16x32_bf16 v[28:31], a[28:31], v[92:95], v[28:31]
    v_mfma_f32_16x16x32_bf16 v[32:35], a[28:31], v[96:99], v[32:35]
    v_lshlrev_b32 v12, 3, v4
    s_lshl_b32 s36, s29, 5
    buffer_load_dwordx2 v[36:37], v12, s[12:15], s36 offen
    v_mul_u32_u24 v13, 896, v3
    v_lshl_add_u32 v13, v4, 3, v13
    s_mul_i32 s37, s28, 57344
    s_add_u32 s37, s37, s36
    s_add_u32 s38, s37, 0
    buffer_load_dwordx2 v[38:39], v13, s[16:19], s38 offen
    s_add_u32 s39, s37, 14336
    buffer_load_dwordx2 v[40:41], v13, s[16:19], s39 offen
    s_add_u32 s40, s37, 28672
    buffer_load_dwordx2 v[42:43], v13, s[16:19], s40 offen
    s_add_u32 s41, s37, 43008
    buffer_load_dwordx2 v[44:45], v13, s[16:19], s41 offen
    s_nop 7
    s_waitcnt vmcnt(0)
    v_cvt_pk_bf16_f32 v160, v20, v21
    v_lshlrev_b32 v161, 16, v160
    v_and_b32 v162, 0xffff0000, v160
    v_lshlrev_b32 v163, 16, v36
    v_and_b32 v164, 0xffff0000, v36
    v_add_f32 v161, v161, v163
    v_add_f32 v162, v162, v164
    v_cvt_pk_bf16_f32 v160, v161, v162
    v_lshlrev_b32 v161, 16, v160
    v_and_b32 v162, 0xffff0000, v160
    v_lshlrev_b32 v163, 16, v38
    v_and_b32 v164, 0xffff0000, v38
    v_add_f32 v161, v161, v163
    v_add_f32 v162, v162, v164
    v_cvt_pk_bf16_f32 v38, v161, v162
    v_cvt_pk_bf16_f32 v160, v22, v23
    v_lshlrev_b32 v161, 16, v160
    v_and_b32 v162, 0xffff0000, v160
    v_lshlrev_b32 v163, 16, v37
    v_and_b32 v164, 0xffff0000, v37
    v_add_f32 v161, v161, v163
    v_add_f32 v162, v162, v164
    v_cvt_pk_bf16_f32 v160, v161, v162
    v_lshlrev_b32 v161, 16, v160
    v_and_b32 v162, 0xffff0000, v160
    v_lshlrev_b32 v163, 16, v39
    v_and_b32 v164, 0xffff0000, v39
    v_add_f32 v161, v161, v163
    v_add_f32 v162, v162, v164
    v_cvt_pk_bf16_f32 v39, v161, v162
    buffer_store_dwordx2 v[38:39], v13, s[20:23], s38 offen
    v_cvt_pk_bf16_f32 v160, v24, v25
    v_lshlrev_b32 v161, 16, v160
    v_and_b32 v162, 0xffff0000, v160
    v_lshlrev_b32 v163, 16, v36
    v_and_b32 v164, 0xffff0000, v36
    v_add_f32 v161, v161, v163
    v_add_f32 v162, v162, v164
    v_cvt_pk_bf16_f32 v160, v161, v162
    v_lshlrev_b32 v161, 16, v160
    v_and_b32 v162, 0xffff0000, v160
    v_lshlrev_b32 v163, 16, v40
    v_and_b32 v164, 0xffff0000, v40
    v_add_f32 v161, v161, v163
    v_add_f32 v162, v162, v164
    v_cvt_pk_bf16_f32 v40, v161, v162
    v_cvt_pk_bf16_f32 v160, v26, v27
    v_lshlrev_b32 v161, 16, v160
    v_and_b32 v162, 0xffff0000, v160
    v_lshlrev_b32 v163, 16, v37
    v_and_b32 v164, 0xffff0000, v37
    v_add_f32 v161, v161, v163
    v_add_f32 v162, v162, v164
    v_cvt_pk_bf16_f32 v160, v161, v162
    v_lshlrev_b32 v161, 16, v160
    v_and_b32 v162, 0xffff0000, v160
    v_lshlrev_b32 v163, 16, v41
    v_and_b32 v164, 0xffff0000, v41
    v_add_f32 v161, v161, v163
    v_add_f32 v162, v162, v164
    v_cvt_pk_bf16_f32 v41, v161, v162
    buffer_store_dwordx2 v[40:41], v13, s[20:23], s39 offen
    v_cvt_pk_bf16_f32 v160, v28, v29
    v_lshlrev_b32 v161, 16, v160
    v_and_b32 v162, 0xffff0000, v160
    v_lshlrev_b32 v163, 16, v36
    v_and_b32 v164, 0xffff0000, v36
    v_add_f32 v161, v161, v163
    v_add_f32 v162, v162, v164
    v_cvt_pk_bf16_f32 v160, v161, v162
    v_lshlrev_b32 v161, 16, v160
    v_and_b32 v162, 0xffff0000, v160
    v_lshlrev_b32 v163, 16, v42
    v_and_b32 v164, 0xffff0000, v42
    v_add_f32 v161, v161, v163
    v_add_f32 v162, v162, v164
    v_cvt_pk_bf16_f32 v42, v161, v162
    v_cvt_pk_bf16_f32 v160, v30, v31
    v_lshlrev_b32 v161, 16, v160
    v_and_b32 v162, 0xffff0000, v160
    v_lshlrev_b32 v163, 16, v37
    v_and_b32 v164, 0xffff0000, v37
    v_add_f32 v161, v161, v163
    v_add_f32 v162, v162, v164
    v_cvt_pk_bf16_f32 v160, v161, v162
    v_lshlrev_b32 v161, 16, v160
    v_and_b32 v162, 0xffff0000, v160
    v_lshlrev_b32 v163, 16, v43
    v_and_b32 v164, 0xffff0000, v43
    v_add_f32 v161, v161, v163
    v_add_f32 v162, v162, v164
    v_cvt_pk_bf16_f32 v43, v161, v162
    buffer_store_dwordx2 v[42:43], v13, s[20:23], s40 offen
    v_cvt_pk_bf16_f32 v160, v32, v33
    v_lshlrev_b32 v161, 16, v160
    v_and_b32 v162, 0xffff0000, v160
    v_lshlrev_b32 v163, 16, v36
    v_and_b32 v164, 0xffff0000, v36
    v_add_f32 v161, v161, v163
    v_add_f32 v162, v162, v164
    v_cvt_pk_bf16_f32 v160, v161, v162
    v_lshlrev_b32 v161, 16, v160
    v_and_b32 v162, 0xffff0000, v160
    v_lshlrev_b32 v163, 16, v44
    v_and_b32 v164, 0xffff0000, v44
    v_add_f32 v161, v161, v163
    v_add_f32 v162, v162, v164
    v_cvt_pk_bf16_f32 v44, v161, v162
    v_cvt_pk_bf16_f32 v160, v34, v35
    v_lshlrev_b32 v161, 16, v160
    v_and_b32 v162, 0xffff0000, v160
    v_lshlrev_b32 v163, 16, v37
    v_and_b32 v164, 0xffff0000, v37
    v_add_f32 v161, v161, v163
    v_add_f32 v162, v162, v164
    v_cvt_pk_bf16_f32 v160, v161, v162
    v_lshlrev_b32 v161, 16, v160
    v_and_b32 v162, 0xffff0000, v160
    v_lshlrev_b32 v163, 16, v45
    v_and_b32 v164, 0xffff0000, v45
    v_add_f32 v161, v161, v163
    v_add_f32 v162, v162, v164
    v_cvt_pk_bf16_f32 v45, v161, v162
    buffer_store_dwordx2 v[44:45], v13, s[20:23], s41 offen
k4l1_kernel_done:
    s_endpgm
.globl k1l2_kernel
.p2align 8
.type k1l2_kernel,@function
k1l2_kernel:
    s_cmp_ge_u32 s2, 256
    s_cbranch_scc1 k1l2_kernel_done
    s_load_dwordx2 s[24:25], s[0:1], 88
    s_load_dwordx2 s[26:27], s[0:1], 0
    v_lshrrev_b32 v9, 6, v0
    v_and_b32 v1, 63, v0
    v_lshlrev_b32 v2, 4, v1
    v_and_b32 v3, 15, v1
    v_lshrrev_b32 v4, 4, v1
    v_readfirstlane_b32 s3, v9
    v_add_u32 v9, 0, v4
    v_xor_b32 v9, v9, v3
    v_lshlrev_b32 v9, 4, v9
    v_lshl_add_u32 v5, v3, 10, v9
    v_add_u32 v9, 4, v4
    v_xor_b32 v9, v9, v3
    v_lshlrev_b32 v9, 4, v9
    v_lshl_add_u32 v6, v3, 10, v9
    v_add_u32 v9, 8, v4
    v_xor_b32 v9, v9, v3
    v_lshlrev_b32 v9, 4, v9
    v_lshl_add_u32 v7, v3, 10, v9
    v_add_u32 v9, 12, v4
    v_xor_b32 v9, v9, v3
    v_lshlrev_b32 v9, 4, v9
    v_lshl_add_u32 v8, v3, 10, v9
    s_and_b32 s28, s2, 7
    s_lshl_b32 s28, s28, 3
    s_lshr_b32 s29, s2, 5
    s_add_u32 s28, s28, s29
    s_lshr_b32 s29, s2, 3
    s_and_b32 s29, s29, 3
    s_lshl_b32 s29, s29, 2
    s_add_u32 s29, s29, s3
    s_waitcnt lgkmcnt(0)
    s_add_u32 s4, s24, 0xef8000
    s_addc_u32 s5, s25, 0
    s_mov_b32 s6, 0x1c0000
    s_mov_b32 s7, 0x00020000
    s_mov_b32 s8, s24
    s_mov_b32 s9, s25
    s_mov_b32 s10, 0x150000
    s_mov_b32 s11, 0x00020000
    s_add_u32 s12, s24, 0x4e0000
    s_addc_u32 s13, s25, 0
    s_mov_b32 s14, 0x8000
    s_mov_b32 s15, 0x00020000
    s_add_u32 s16, s24, 0x1278000
    s_addc_u32 s17, s25, 0
    s_mov_b32 s18, 0x400000
    s_mov_b32 s19, 0x00020000
    s_add_u32 s20, s24, 0x528000
    s_addc_u32 s21, s25, 0
    s_mov_b32 s22, 0x800000
    s_mov_b32 s23, 0x00020000
    s_mul_i32 s30, s28, 28672
    s_mul_i32 s31, s29, 86016
    v_lshrrev_b32 v9, 3, v0
    v_mul_u32_u24 v9, 896, v9
    v_and_b32 v10, 7, v0
    v_lshl_add_u32 v10, v10, 4, v9
    buffer_load_dwordx4 v[160:163], v10, s[4:7], s30 offen offset:0
    buffer_load_dwordx4 v[164:167], v10, s[4:7], s30 offen offset:128
    buffer_load_dwordx4 v[168:171], v10, s[4:7], s30 offen offset:256
    buffer_load_dwordx4 v[172:175], v10, s[4:7], s30 offen offset:384
    buffer_load_dwordx4 v[176:179], v10, s[4:7], s30 offen offset:512
    buffer_load_dwordx4 v[180:183], v10, s[4:7], s30 offen offset:640
    buffer_load_dwordx4 v[184:187], v10, s[4:7], s30 offen offset:768
    s_lshl_b32 s32, s29, 11
    buffer_load_dwordx4 v[152:155], v2, s[12:15], s32 offen
    buffer_load_dwordx4 v[156:159], v2, s[12:15], s32 offen offset:1024
    s_add_u32 s33, s31, 0x0
    buffer_load_dwordx4 a[0:3], v2, s[8:11], s33 offen offset:0
    buffer_load_dwordx4 a[4:7], v2, s[8:11], s33 offen offset:1024
    buffer_load_dwordx4 a[8:11], v2, s[8:11], s33 offen offset:2048
    buffer_load_dwordx4 a[12:15], v2, s[8:11], s33 offen offset:3072
    s_add_u32 s33, s31, 0x1000
    buffer_load_dwordx4 a[16:19], v2, s[8:11], s33 offen offset:0
    buffer_load_dwordx4 a[20:23], v2, s[8:11], s33 offen offset:1024
    s_add_u32 s33, s31, 0x1800
    buffer_load_dwordx4 a[24:27], v2, s[8:11], s33 offen offset:0
    buffer_load_dwordx4 a[28:31], v2, s[8:11], s33 offen offset:1024
    buffer_load_dwordx4 a[32:35], v2, s[8:11], s33 offen offset:2048
    buffer_load_dwordx4 a[36:39], v2, s[8:11], s33 offen offset:3072
    s_add_u32 s33, s31, 0x2800
    buffer_load_dwordx4 a[40:43], v2, s[8:11], s33 offen offset:0
    buffer_load_dwordx4 a[44:47], v2, s[8:11], s33 offen offset:1024
    s_add_u32 s33, s31, 0x3000
    buffer_load_dwordx4 a[48:51], v2, s[8:11], s33 offen offset:0
    buffer_load_dwordx4 a[52:55], v2, s[8:11], s33 offen offset:1024
    buffer_load_dwordx4 a[56:59], v2, s[8:11], s33 offen offset:2048
    buffer_load_dwordx4 a[60:63], v2, s[8:11], s33 offen offset:3072
    s_add_u32 s33, s31, 0x4000
    buffer_load_dwordx4 a[64:67], v2, s[8:11], s33 offen offset:0
    buffer_load_dwordx4 a[68:71], v2, s[8:11], s33 offen offset:1024
    s_add_u32 s33, s31, 0x4800
    buffer_load_dwordx4 a[72:75], v2, s[8:11], s33 offen offset:0
    buffer_load_dwordx4 a[76:79], v2, s[8:11], s33 offen offset:1024
    buffer_load_dwordx4 a[80:83], v2, s[8:11], s33 offen offset:2048
    buffer_load_dwordx4 a[84:87], v2, s[8:11], s33 offen offset:3072
    s_add_u32 s33, s31, 0x5800
    buffer_load_dwordx4 a[88:91], v2, s[8:11], s33 offen offset:0
    buffer_load_dwordx4 a[92:95], v2, s[8:11], s33 offen offset:1024
    s_add_u32 s33, s31, 0x6000
    buffer_load_dwordx4 a[96:99], v2, s[8:11], s33 offen offset:0
    buffer_load_dwordx4 a[100:103], v2, s[8:11], s33 offen offset:1024
    buffer_load_dwordx4 a[104:107], v2, s[8:11], s33 offen offset:2048
    buffer_load_dwordx4 a[108:111], v2, s[8:11], s33 offen offset:3072
    s_add_u32 s33, s31, 0x7000
    buffer_load_dwordx4 a[112:115], v2, s[8:11], s33 offen offset:0
    buffer_load_dwordx4 a[116:119], v2, s[8:11], s33 offen offset:1024
    s_add_u32 s33, s31, 0x7800
    buffer_load_dwordx4 a[120:123], v2, s[8:11], s33 offen offset:0
    buffer_load_dwordx4 a[124:127], v2, s[8:11], s33 offen offset:1024
    buffer_load_dwordx4 a[128:131], v2, s[8:11], s33 offen offset:2048
    buffer_load_dwordx4 a[132:135], v2, s[8:11], s33 offen offset:3072
    s_add_u32 s33, s31, 0x8800
    buffer_load_dwordx4 a[136:139], v2, s[8:11], s33 offen offset:0
    buffer_load_dwordx4 a[140:143], v2, s[8:11], s33 offen offset:1024
    s_add_u32 s33, s31, 0x9000
    buffer_load_dwordx4 a[144:147], v2, s[8:11], s33 offen offset:0
    buffer_load_dwordx4 a[148:151], v2, s[8:11], s33 offen offset:1024
    buffer_load_dwordx4 a[152:155], v2, s[8:11], s33 offen offset:2048
    buffer_load_dwordx4 a[156:159], v2, s[8:11], s33 offen offset:3072
    s_add_u32 s33, s31, 0xa000
    buffer_load_dwordx4 a[160:163], v2, s[8:11], s33 offen offset:0
    buffer_load_dwordx4 a[164:167], v2, s[8:11], s33 offen offset:1024
    s_add_u32 s33, s31, 0xa800
    buffer_load_dwordx4 a[168:171], v2, s[8:11], s33 offen offset:0
    buffer_load_dwordx4 a[172:175], v2, s[8:11], s33 offen offset:1024
    buffer_load_dwordx4 a[176:179], v2, s[8:11], s33 offen offset:2048
    buffer_load_dwordx4 a[180:183], v2, s[8:11], s33 offen offset:3072
    s_add_u32 s33, s31, 0xb800
    buffer_load_dwordx4 a[184:187], v2, s[8:11], s33 offen offset:0
    buffer_load_dwordx4 a[188:191], v2, s[8:11], s33 offen offset:1024
    s_add_u32 s33, s31, 0xc000
    buffer_load_dwordx4 a[192:195], v2, s[8:11], s33 offen offset:0
    buffer_load_dwordx4 a[196:199], v2, s[8:11], s33 offen offset:1024
    buffer_load_dwordx4 a[200:203], v2, s[8:11], s33 offen offset:2048
    buffer_load_dwordx4 a[204:207], v2, s[8:11], s33 offen offset:3072
    s_add_u32 s33, s31, 0xd000
    buffer_load_dwordx4 a[208:211], v2, s[8:11], s33 offen offset:0
    buffer_load_dwordx4 a[212:215], v2, s[8:11], s33 offen offset:1024
    s_waitcnt vmcnt(56)
    s_mov_b32 s34, 0x3f803f80
    v_mov_b32 v188, 0
    v_mov_b32 v189, 0
    v_mov_b32 v190, 0
    v_mov_b32 v191, 0
    v_dot2_f32_bf16 v188, v160, s34, v188
    v_dot2_f32_bf16 v190, v160, v160, v190
    v_dot2_f32_bf16 v189, v161, s34, v189
    v_dot2_f32_bf16 v191, v161, v161, v191
    v_dot2_f32_bf16 v188, v162, s34, v188
    v_dot2_f32_bf16 v190, v162, v162, v190
    v_dot2_f32_bf16 v189, v163, s34, v189
    v_dot2_f32_bf16 v191, v163, v163, v191
    v_dot2_f32_bf16 v188, v164, s34, v188
    v_dot2_f32_bf16 v190, v164, v164, v190
    v_dot2_f32_bf16 v189, v165, s34, v189
    v_dot2_f32_bf16 v191, v165, v165, v191
    v_dot2_f32_bf16 v188, v166, s34, v188
    v_dot2_f32_bf16 v190, v166, v166, v190
    v_dot2_f32_bf16 v189, v167, s34, v189
    v_dot2_f32_bf16 v191, v167, v167, v191
    v_dot2_f32_bf16 v188, v168, s34, v188
    v_dot2_f32_bf16 v190, v168, v168, v190
    v_dot2_f32_bf16 v189, v169, s34, v189
    v_dot2_f32_bf16 v191, v169, v169, v191
    v_dot2_f32_bf16 v188, v170, s34, v188
    v_dot2_f32_bf16 v190, v170, v170, v190
    v_dot2_f32_bf16 v189, v171, s34, v189
    v_dot2_f32_bf16 v191, v171, v171, v191
    v_dot2_f32_bf16 v188, v172, s34, v188
    v_dot2_f32_bf16 v190, v172, v172, v190
    v_dot2_f32_bf16 v189, v173, s34, v189
    v_dot2_f32_bf16 v191, v173, v173, v191
    v_dot2_f32_bf16 v188, v174, s34, v188
    v_dot2_f32_bf16 v190, v174, v174, v190
    v_dot2_f32_bf16 v189, v175, s34, v189
    v_dot2_f32_bf16 v191, v175, v175, v191
    v_dot2_f32_bf16 v188, v176, s34, v188
    v_dot2_f32_bf16 v190, v176, v176, v190
    v_dot2_f32_bf16 v189, v177, s34, v189
    v_dot2_f32_bf16 v191, v177, v177, v191
    v_dot2_f32_bf16 v188, v178, s34, v188
    v_dot2_f32_bf16 v190, v178, v178, v190
    v_dot2_f32_bf16 v189, v179, s34, v189
    v_dot2_f32_bf16 v191, v179, v179, v191
    v_dot2_f32_bf16 v188, v180, s34, v188
    v_dot2_f32_bf16 v190, v180, v180, v190
    v_dot2_f32_bf16 v189, v181, s34, v189
    v_dot2_f32_bf16 v191, v181, v181, v191
    v_dot2_f32_bf16 v188, v182, s34, v188
    v_dot2_f32_bf16 v190, v182, v182, v190
    v_dot2_f32_bf16 v189, v183, s34, v189
    v_dot2_f32_bf16 v191, v183, v183, v191
    v_dot2_f32_bf16 v188, v184, s34, v188
    v_dot2_f32_bf16 v190, v184, v184, v190
    v_dot2_f32_bf16 v189, v185, s34, v189
    v_dot2_f32_bf16 v191, v185, v185, v191
    v_dot2_f32_bf16 v188, v186, s34, v188
    v_dot2_f32_bf16 v190, v186, v186, v190
    v_dot2_f32_bf16 v189, v187, s34, v189
    v_dot2_f32_bf16 v191, v187, v187, v191
    s_nop 3
    v_add_f32 v188, v188, v189
    v_add_f32 v190, v190, v191
    s_nop 1
    v_add_f32_dpp v189, v188, v188 quad_perm:[1,0,3,2] row_mask:0xf bank_mask:0xf
    v_add_f32_dpp v191, v190, v190 quad_perm:[1,0,3,2] row_mask:0xf bank_mask:0xf
    v_mov_b32 v188, v189
    v_mov_b32 v190, v191
    s_nop 1
    v_add_f32_dpp v189, v188, v188 quad_perm:[2,3,0,1] row_mask:0xf bank_mask:0xf
    v_add_f32_dpp v191, v190, v190 quad_perm:[2,3,0,1] row_mask:0xf bank_mask:0xf
    v_mov_b32 v188, v189
    v_mov_b32 v190, v191
    s_nop 1
    v_add_f32_dpp v189, v188, v188 row_half_mirror row_mask:0xf bank_mask:0xf
    v_add_f32_dpp v191, v190, v190 row_half_mirror row_mask:0xf bank_mask:0xf
    v_mov_b32 v188, v189
    v_mov_b32 v190, v191
    s_mov_b32 s34, 0x3b124925
    v_mul_f32 v192, s34, v188
    v_mul_f32 v193, s34, v190
    v_fma_f32 v193, -v192, v192, v193
    v_max_f32 v193, 0, v193
    v_cvt_pk_bf16_f32 v194, v192, v193
    v_lshlrev_b32 v196, 16, v194
    v_sub_f32 v196, 0, v196
    v_mov_b32 v197, v196
    v_and_b32 v193, 0xffff0000, v194
    s_mov_b32 s34, 0x3727c5ac
    v_add_f32 v193, s34, v193
    v_cvt_pk_bf16_f32 v194, v193, v193
    v_lshlrev_b32 v193, 16, v194
    v_sqrt_f32 v193, v193
    s_nop 0
    v_cvt_pk_bf16_f32 v194, v193, v193
    v_lshlrev_b32 v193, 16, v194
    v_rcp_f32 v198, v193
    s_nop 0
    v_mov_b32 v199, v198
    v_lshlrev_b32 v200, 16, v160
    v_and_b32 v201, 0xffff0000, v160
    v_lshlrev_b32 v202, 16, v161
    v_and_b32 v203, 0xffff0000, v161
    v_lshlrev_b32 v204, 16, v162
    v_and_b32 v205, 0xffff0000, v162
    v_lshlrev_b32 v206, 16, v163
    v_and_b32 v207, 0xffff0000, v163
    v_pk_add_f32 v[200:201], v[200:201], v[196:197]
    v_pk_add_f32 v[202:203], v[202:203], v[196:197]
    v_pk_add_f32 v[204:205], v[204:205], v[196:197]
    v_pk_add_f32 v[206:207], v[206:207], v[196:197]
    v_cvt_pk_bf16_f32 v160, v200, v201
    v_cvt_pk_bf16_f32 v161, v202, v203
    v_cvt_pk_bf16_f32 v162, v204, v205
    v_cvt_pk_bf16_f32 v163, v206, v207
    v_lshlrev_b32 v200, 16, v160
    v_and_b32 v201, 0xffff0000, v160
    v_lshlrev_b32 v202, 16, v161
    v_and_b32 v203, 0xffff0000, v161
    v_lshlrev_b32 v204, 16, v162
    v_and_b32 v205, 0xffff0000, v162
    v_lshlrev_b32 v206, 16, v163
    v_and_b32 v207, 0xffff0000, v163
    v_pk_mul_f32 v[200:201], v[200:201], v[198:199]
    v_pk_mul_f32 v[202:203], v[202:203], v[198:199]
    v_pk_mul_f32 v[204:205], v[204:205], v[198:199]
    v_pk_mul_f32 v[206:207], v[206:207], v[198:199]
    v_cvt_pk_bf16_f32 v160, v200, v201
    v_cvt_pk_bf16_f32 v161, v202, v203
    v_cvt_pk_bf16_f32 v162, v204, v205
    v_cvt_pk_bf16_f32 v163, v206, v207
    v_lshlrev_b32 v200, 16, v164
    v_and_b32 v201, 0xffff0000, v164
    v_lshlrev_b32 v202, 16, v165
    v_and_b32 v203, 0xffff0000, v165
    v_lshlrev_b32 v204, 16, v166
    v_and_b32 v205, 0xffff0000, v166
    v_lshlrev_b32 v206, 16, v167
    v_and_b32 v207, 0xffff0000, v167
    v_pk_add_f32 v[200:201], v[200:201], v[196:197]
    v_pk_add_f32 v[202:203], v[202:203], v[196:197]
    v_pk_add_f32 v[204:205], v[204:205], v[196:197]
    v_pk_add_f32 v[206:207], v[206:207], v[196:197]
    v_cvt_pk_bf16_f32 v164, v200, v201
    v_cvt_pk_bf16_f32 v165, v202, v203
    v_cvt_pk_bf16_f32 v166, v204, v205
    v_cvt_pk_bf16_f32 v167, v206, v207
    v_lshlrev_b32 v200, 16, v164
    v_and_b32 v201, 0xffff0000, v164
    v_lshlrev_b32 v202, 16, v165
    v_and_b32 v203, 0xffff0000, v165
    v_lshlrev_b32 v204, 16, v166
    v_and_b32 v205, 0xffff0000, v166
    v_lshlrev_b32 v206, 16, v167
    v_and_b32 v207, 0xffff0000, v167
    v_pk_mul_f32 v[200:201], v[200:201], v[198:199]
    v_pk_mul_f32 v[202:203], v[202:203], v[198:199]
    v_pk_mul_f32 v[204:205], v[204:205], v[198:199]
    v_pk_mul_f32 v[206:207], v[206:207], v[198:199]
    v_cvt_pk_bf16_f32 v164, v200, v201
    v_cvt_pk_bf16_f32 v165, v202, v203
    v_cvt_pk_bf16_f32 v166, v204, v205
    v_cvt_pk_bf16_f32 v167, v206, v207
    v_lshlrev_b32 v200, 16, v168
    v_and_b32 v201, 0xffff0000, v168
    v_lshlrev_b32 v202, 16, v169
    v_and_b32 v203, 0xffff0000, v169
    v_lshlrev_b32 v204, 16, v170
    v_and_b32 v205, 0xffff0000, v170
    v_lshlrev_b32 v206, 16, v171
    v_and_b32 v207, 0xffff0000, v171
    v_pk_add_f32 v[200:201], v[200:201], v[196:197]
    v_pk_add_f32 v[202:203], v[202:203], v[196:197]
    v_pk_add_f32 v[204:205], v[204:205], v[196:197]
    v_pk_add_f32 v[206:207], v[206:207], v[196:197]
    v_cvt_pk_bf16_f32 v168, v200, v201
    v_cvt_pk_bf16_f32 v169, v202, v203
    v_cvt_pk_bf16_f32 v170, v204, v205
    v_cvt_pk_bf16_f32 v171, v206, v207
    v_lshlrev_b32 v200, 16, v168
    v_and_b32 v201, 0xffff0000, v168
    v_lshlrev_b32 v202, 16, v169
    v_and_b32 v203, 0xffff0000, v169
    v_lshlrev_b32 v204, 16, v170
    v_and_b32 v205, 0xffff0000, v170
    v_lshlrev_b32 v206, 16, v171
    v_and_b32 v207, 0xffff0000, v171
    v_pk_mul_f32 v[200:201], v[200:201], v[198:199]
    v_pk_mul_f32 v[202:203], v[202:203], v[198:199]
    v_pk_mul_f32 v[204:205], v[204:205], v[198:199]
    v_pk_mul_f32 v[206:207], v[206:207], v[198:199]
    v_cvt_pk_bf16_f32 v168, v200, v201
    v_cvt_pk_bf16_f32 v169, v202, v203
    v_cvt_pk_bf16_f32 v170, v204, v205
    v_cvt_pk_bf16_f32 v171, v206, v207
    v_lshlrev_b32 v200, 16, v172
    v_and_b32 v201, 0xffff0000, v172
    v_lshlrev_b32 v202, 16, v173
    v_and_b32 v203, 0xffff0000, v173
    v_lshlrev_b32 v204, 16, v174
    v_and_b32 v205, 0xffff0000, v174
    v_lshlrev_b32 v206, 16, v175
    v_and_b32 v207, 0xffff0000, v175
    v_pk_add_f32 v[200:201], v[200:201], v[196:197]
    v_pk_add_f32 v[202:203], v[202:203], v[196:197]
    v_pk_add_f32 v[204:205], v[204:205], v[196:197]
    v_pk_add_f32 v[206:207], v[206:207], v[196:197]
    v_cvt_pk_bf16_f32 v172, v200, v201
    v_cvt_pk_bf16_f32 v173, v202, v203
    v_cvt_pk_bf16_f32 v174, v204, v205
    v_cvt_pk_bf16_f32 v175, v206, v207
    v_lshlrev_b32 v200, 16, v172
    v_and_b32 v201, 0xffff0000, v172
    v_lshlrev_b32 v202, 16, v173
    v_and_b32 v203, 0xffff0000, v173
    v_lshlrev_b32 v204, 16, v174
    v_and_b32 v205, 0xffff0000, v174
    v_lshlrev_b32 v206, 16, v175
    v_and_b32 v207, 0xffff0000, v175
    v_pk_mul_f32 v[200:201], v[200:201], v[198:199]
    v_pk_mul_f32 v[202:203], v[202:203], v[198:199]
    v_pk_mul_f32 v[204:205], v[204:205], v[198:199]
    v_pk_mul_f32 v[206:207], v[206:207], v[198:199]
    v_cvt_pk_bf16_f32 v172, v200, v201
    v_cvt_pk_bf16_f32 v173, v202, v203
    v_cvt_pk_bf16_f32 v174, v204, v205
    v_cvt_pk_bf16_f32 v175, v206, v207
    v_lshlrev_b32 v200, 16, v176
    v_and_b32 v201, 0xffff0000, v176
    v_lshlrev_b32 v202, 16, v177
    v_and_b32 v203, 0xffff0000, v177
    v_lshlrev_b32 v204, 16, v178
    v_and_b32 v205, 0xffff0000, v178
    v_lshlrev_b32 v206, 16, v179
    v_and_b32 v207, 0xffff0000, v179
    v_pk_add_f32 v[200:201], v[200:201], v[196:197]
    v_pk_add_f32 v[202:203], v[202:203], v[196:197]
    v_pk_add_f32 v[204:205], v[204:205], v[196:197]
    v_pk_add_f32 v[206:207], v[206:207], v[196:197]
    v_cvt_pk_bf16_f32 v176, v200, v201
    v_cvt_pk_bf16_f32 v177, v202, v203
    v_cvt_pk_bf16_f32 v178, v204, v205
    v_cvt_pk_bf16_f32 v179, v206, v207
    v_lshlrev_b32 v200, 16, v176
    v_and_b32 v201, 0xffff0000, v176
    v_lshlrev_b32 v202, 16, v177
    v_and_b32 v203, 0xffff0000, v177
    v_lshlrev_b32 v204, 16, v178
    v_and_b32 v205, 0xffff0000, v178
    v_lshlrev_b32 v206, 16, v179
    v_and_b32 v207, 0xffff0000, v179
    v_pk_mul_f32 v[200:201], v[200:201], v[198:199]
    v_pk_mul_f32 v[202:203], v[202:203], v[198:199]
    v_pk_mul_f32 v[204:205], v[204:205], v[198:199]
    v_pk_mul_f32 v[206:207], v[206:207], v[198:199]
    v_cvt_pk_bf16_f32 v176, v200, v201
    v_cvt_pk_bf16_f32 v177, v202, v203
    v_cvt_pk_bf16_f32 v178, v204, v205
    v_cvt_pk_bf16_f32 v179, v206, v207
    v_lshlrev_b32 v200, 16, v180
    v_and_b32 v201, 0xffff0000, v180
    v_lshlrev_b32 v202, 16, v181
    v_and_b32 v203, 0xffff0000, v181
    v_lshlrev_b32 v204, 16, v182
    v_and_b32 v205, 0xffff0000, v182
    v_lshlrev_b32 v206, 16, v183
    v_and_b32 v207, 0xffff0000, v183
    v_pk_add_f32 v[200:201], v[200:201], v[196:197]
    v_pk_add_f32 v[202:203], v[202:203], v[196:197]
    v_pk_add_f32 v[204:205], v[204:205], v[196:197]
    v_pk_add_f32 v[206:207], v[206:207], v[196:197]
    v_cvt_pk_bf16_f32 v180, v200, v201
    v_cvt_pk_bf16_f32 v181, v202, v203
    v_cvt_pk_bf16_f32 v182, v204, v205
    v_cvt_pk_bf16_f32 v183, v206, v207
    v_lshlrev_b32 v200, 16, v180
    v_and_b32 v201, 0xffff0000, v180
    v_lshlrev_b32 v202, 16, v181
    v_and_b32 v203, 0xffff0000, v181
    v_lshlrev_b32 v204, 16, v182
    v_and_b32 v205, 0xffff0000, v182
    v_lshlrev_b32 v206, 16, v183
    v_and_b32 v207, 0xffff0000, v183
    v_pk_mul_f32 v[200:201], v[200:201], v[198:199]
    v_pk_mul_f32 v[202:203], v[202:203], v[198:199]
    v_pk_mul_f32 v[204:205], v[204:205], v[198:199]
    v_pk_mul_f32 v[206:207], v[206:207], v[198:199]
    v_cvt_pk_bf16_f32 v180, v200, v201
    v_cvt_pk_bf16_f32 v181, v202, v203
    v_cvt_pk_bf16_f32 v182, v204, v205
    v_cvt_pk_bf16_f32 v183, v206, v207
    v_lshlrev_b32 v200, 16, v184
    v_and_b32 v201, 0xffff0000, v184
    v_lshlrev_b32 v202, 16, v185
    v_and_b32 v203, 0xffff0000, v185
    v_lshlrev_b32 v204, 16, v186
    v_and_b32 v205, 0xffff0000, v186
    v_lshlrev_b32 v206, 16, v187
    v_and_b32 v207, 0xffff0000, v187
    v_pk_add_f32 v[200:201], v[200:201], v[196:197]
    v_pk_add_f32 v[202:203], v[202:203], v[196:197]
    v_pk_add_f32 v[204:205], v[204:205], v[196:197]
    v_pk_add_f32 v[206:207], v[206:207], v[196:197]
    v_cvt_pk_bf16_f32 v184, v200, v201
    v_cvt_pk_bf16_f32 v185, v202, v203
    v_cvt_pk_bf16_f32 v186, v204, v205
    v_cvt_pk_bf16_f32 v187, v206, v207
    v_lshlrev_b32 v200, 16, v184
    v_and_b32 v201, 0xffff0000, v184
    v_lshlrev_b32 v202, 16, v185
    v_and_b32 v203, 0xffff0000, v185
    v_lshlrev_b32 v204, 16, v186
    v_and_b32 v205, 0xffff0000, v186
    v_lshlrev_b32 v206, 16, v187
    v_and_b32 v207, 0xffff0000, v187
    v_pk_mul_f32 v[200:201], v[200:201], v[198:199]
    v_pk_mul_f32 v[202:203], v[202:203], v[198:199]
    v_pk_mul_f32 v[204:205], v[204:205], v[198:199]
    v_pk_mul_f32 v[206:207], v[206:207], v[198:199]
    v_cvt_pk_bf16_f32 v184, v200, v201
    v_cvt_pk_bf16_f32 v185, v202, v203
    v_cvt_pk_bf16_f32 v186, v204, v205
    v_cvt_pk_bf16_f32 v187, v206, v207
    v_lshrrev_b32 v188, 3, v0
    v_and_b32 v189, 7, v0
    v_and_b32 v190, 15, v188
    v_xor_b32 v191, v189, v190
    v_lshlrev_b32 v191, 4, v191
    v_add_u32 v189, 8, v189
    v_xor_b32 v190, v189, v190
    v_lshlrev_b32 v190, 4, v190
    v_lshlrev_b32 v188, 10, v188
    v_add_u32 v191, v191, v188
    v_add_u32 v190, v190, v188
    ds_write_b128 v191, v[160:163] offset:0
    ds_write_b128 v190, v[164:167] offset:0
    ds_write_b128 v191, v[168:171] offset:256
    ds_write_b128 v190, v[172:175] offset:256
    ds_write_b128 v191, v[176:179] offset:512
    ds_write_b128 v190, v[180:183] offset:512
    ds_write_b128 v191, v[184:187] offset:768
    s_waitcnt lgkmcnt(0)
    s_barrier
    ds_read_b128 v[136:139], v5 offset:0
    ds_read_b128 v[140:143], v5 offset:16384
    ds_read_b128 v[144:147], v6 offset:0
    ds_read_b128 v[148:151], v6 offset:16384
    s_waitcnt vmcnt(48)
    s_waitcnt lgkmcnt(2)
    v_mfma_f32_16x16x32_bf16 v[16:19], a[0:3], v[136:139], 0
    v_mfma_f32_16x16x32_bf16 v[20:23], a[0:3], v[140:143], 0
    v_mfma_f32_16x16x32_bf16 v[24:27], a[4:7], v[136:139], 0
    v_mfma_f32_16x16x32_bf16 v[28:31], a[4:7], v[140:143], 0
    v_mfma_f32_16x16x32_bf16 v[32:35], a[8:11], v[136:139], 0
    v_mfma_f32_16x16x32_bf16 v[36:39], a[8:11], v[140:143], 0
    v_mfma_f32_16x16x32_bf16 v[40:43], a[12:15], v[136:139], 0
    v_mfma_f32_16x16x32_bf16 v[44:47], a[12:15], v[140:143], 0
    v_mfma_f32_16x16x32_bf16 v[48:51], v[136:139], a[16:19], 0
    v_mfma_f32_16x16x32_bf16 v[52:55], v[140:143], a[16:19], 0
    v_mfma_f32_16x16x32_bf16 v[56:59], v[136:139], a[20:23], 0
    v_mfma_f32_16x16x32_bf16 v[60:63], v[140:143], a[20:23], 0
    s_add_u32 s33, s31, 0xd800
    buffer_load_dwordx4 a[0:3], v2, s[8:11], s33 offen offset:0
    buffer_load_dwordx4 a[4:7], v2, s[8:11], s33 offen offset:1024
    buffer_load_dwordx4 a[8:11], v2, s[8:11], s33 offen offset:2048
    buffer_load_dwordx4 a[12:15], v2, s[8:11], s33 offen offset:3072
    s_add_u32 s33, s31, 0xe800
    buffer_load_dwordx4 a[16:19], v2, s[8:11], s33 offen offset:0
    buffer_load_dwordx4 a[20:23], v2, s[8:11], s33 offen offset:1024
    ds_read_b128 v[136:139], v7 offset:0
    ds_read_b128 v[140:143], v7 offset:16384
    s_waitcnt vmcnt(48)
    s_waitcnt lgkmcnt(2)
    v_mfma_f32_16x16x32_bf16 v[16:19], a[24:27], v[144:147], v[16:19]
    v_mfma_f32_16x16x32_bf16 v[20:23], a[24:27], v[148:151], v[20:23]
    v_mfma_f32_16x16x32_bf16 v[24:27], a[28:31], v[144:147], v[24:27]
    v_mfma_f32_16x16x32_bf16 v[28:31], a[28:31], v[148:151], v[28:31]
    v_mfma_f32_16x16x32_bf16 v[32:35], a[32:35], v[144:147], v[32:35]
    v_mfma_f32_16x16x32_bf16 v[36:39], a[32:35], v[148:151], v[36:39]
    v_mfma_f32_16x16x32_bf16 v[40:43], a[36:39], v[144:147], v[40:43]
    v_mfma_f32_16x16x32_bf16 v[44:47], a[36:39], v[148:151], v[44:47]
    v_mfma_f32_16x16x32_bf16 v[48:51], v[144:147], a[40:43], v[48:51]
    v_mfma_f32_16x16x32_bf16 v[52:55], v[148:151], a[40:43], v[52:55]
    v_mfma_f32_16x16x32_bf16 v[56:59], v[144:147], a[44:47], v[56:59]
    v_mfma_f32_16x16x32_bf16 v[60:63], v[148:151], a[44:47], v[60:63]
    s_add_u32 s33, s31, 0xf000
    buffer_load_dwordx4 a[24:27], v2, s[8:11], s33 offen offset:0
    buffer_load_dwordx4 a[28:31], v2, s[8:11], s33 offen offset:1024
    buffer_load_dwordx4 a[32:35], v2, s[8:11], s33 offen offset:2048
    buffer_load_dwordx4 a[36:39], v2, s[8:11], s33 offen offset:3072
    s_add_u32 s33, s31, 0x10000
    buffer_load_dwordx4 a[40:43], v2, s[8:11], s33 offen offset:0
    buffer_load_dwordx4 a[44:47], v2, s[8:11], s33 offen offset:1024
    ds_read_b128 v[144:147], v8 offset:0
    ds_read_b128 v[148:151], v8 offset:16384
    s_waitcnt vmcnt(48)
    s_waitcnt lgkmcnt(2)
    v_mfma_f32_16x16x32_bf16 v[16:19], a[48:51], v[136:139], v[16:19]
    v_mfma_f32_16x16x32_bf16 v[20:23], a[48:51], v[140:143], v[20:23]
    v_mfma_f32_16x16x32_bf16 v[24:27], a[52:55], v[136:139], v[24:27]
    v_mfma_f32_16x16x32_bf16 v[28:31], a[52:55], v[140:143], v[28:31]
    v_mfma_f32_16x16x32_bf16 v[32:35], a[56:59], v[136:139], v[32:35]
    v_mfma_f32_16x16x32_bf16 v[36:39], a[56:59], v[140:143], v[36:39]
    v_mfma_f32_16x16x32_bf16 v[40:43], a[60:63], v[136:139], v[40:43]
    v_mfma_f32_16x16x32_bf16 v[44:47], a[60:63], v[140:143], v[44:47]
    v_mfma_f32_16x16x32_bf16 v[48:51], v[136:139], a[64:67], v[48:51]
    v_mfma_f32_16x16x32_bf16 v[52:55], v[140:143], a[64:67], v[52:55]
    v_mfma_f32_16x16x32_bf16 v[56:59], v[136:139], a[68:71], v[56:59]
    v_mfma_f32_16x16x32_bf16 v[60:63], v[140:143], a[68:71], v[60:63]
    s_add_u32 s33, s31, 0x10800
    buffer_load_dwordx4 a[48:51], v2, s[8:11], s33 offen offset:0
    buffer_load_dwordx4 a[52:55], v2, s[8:11], s33 offen offset:1024
    buffer_load_dwordx4 a[56:59], v2, s[8:11], s33 offen offset:2048
    buffer_load_dwordx4 a[60:63], v2, s[8:11], s33 offen offset:3072
    s_add_u32 s33, s31, 0x11800
    buffer_load_dwordx4 a[64:67], v2, s[8:11], s33 offen offset:0
    buffer_load_dwordx4 a[68:71], v2, s[8:11], s33 offen offset:1024
    ds_read_b128 v[136:139], v5 offset:256
    ds_read_b128 v[140:143], v5 offset:16640
    s_waitcnt vmcnt(48)
    s_waitcnt lgkmcnt(2)
    v_mfma_f32_16x16x32_bf16 v[16:19], a[72:75], v[144:147], v[16:19]
    v_mfma_f32_16x16x32_bf16 v[20:23], a[72:75], v[148:151], v[20:23]
    v_mfma_f32_16x16x32_bf16 v[24:27], a[76:79], v[144:147], v[24:27]
    v_mfma_f32_16x16x32_bf16 v[28:31], a[76:79], v[148:151], v[28:31]
    v_mfma_f32_16x16x32_bf16 v[32:35], a[80:83], v[144:147], v[32:35]
    v_mfma_f32_16x16x32_bf16 v[36:39], a[80:83], v[148:151], v[36:39]
    v_mfma_f32_16x16x32_bf16 v[40:43], a[84:87], v[144:147], v[40:43]
    v_mfma_f32_16x16x32_bf16 v[44:47], a[84:87], v[148:151], v[44:47]
    v_mfma_f32_16x16x32_bf16 v[48:51], v[144:147], a[88:91], v[48:51]
    v_mfma_f32_16x16x32_bf16 v[52:55], v[148:151], a[88:91], v[52:55]
    v_mfma_f32_16x16x32_bf16 v[56:59], v[144:147], a[92:95], v[56:59]
    v_mfma_f32_16x16x32_bf16 v[60:63], v[148:151], a[92:95], v[60:63]
    s_add_u32 s33, s31, 0x12000
    buffer_load_dwordx4 a[72:75], v2, s[8:11], s33 offen offset:0
    buffer_load_dwordx4 a[76:79], v2, s[8:11], s33 offen offset:1024
    buffer_load_dwordx4 a[80:83], v2, s[8:11], s33 offen offset:2048
    buffer_load_dwordx4 a[84:87], v2, s[8:11], s33 offen offset:3072
    s_add_u32 s33, s31, 0x13000
    buffer_load_dwordx4 a[88:91], v2, s[8:11], s33 offen offset:0
    buffer_load_dwordx4 a[92:95], v2, s[8:11], s33 offen offset:1024
    ds_read_b128 v[144:147], v6 offset:256
    ds_read_b128 v[148:151], v6 offset:16640
    s_waitcnt vmcnt(48)
    s_waitcnt lgkmcnt(2)
    v_mfma_f32_16x16x32_bf16 v[16:19], a[96:99], v[136:139], v[16:19]
    v_mfma_f32_16x16x32_bf16 v[20:23], a[96:99], v[140:143], v[20:23]
    v_mfma_f32_16x16x32_bf16 v[24:27], a[100:103], v[136:139], v[24:27]
    v_mfma_f32_16x16x32_bf16 v[28:31], a[100:103], v[140:143], v[28:31]
    v_mfma_f32_16x16x32_bf16 v[32:35], a[104:107], v[136:139], v[32:35]
    v_mfma_f32_16x16x32_bf16 v[36:39], a[104:107], v[140:143], v[36:39]
    v_mfma_f32_16x16x32_bf16 v[40:43], a[108:111], v[136:139], v[40:43]
    v_mfma_f32_16x16x32_bf16 v[44:47], a[108:111], v[140:143], v[44:47]
    v_mfma_f32_16x16x32_bf16 v[48:51], v[136:139], a[112:115], v[48:51]
    v_mfma_f32_16x16x32_bf16 v[52:55], v[140:143], a[112:115], v[52:55]
    v_mfma_f32_16x16x32_bf16 v[56:59], v[136:139], a[116:119], v[56:59]
    v_mfma_f32_16x16x32_bf16 v[60:63], v[140:143], a[116:119], v[60:63]
    s_add_u32 s33, s31, 0x13800
    buffer_load_dwordx4 a[96:99], v2, s[8:11], s33 offen offset:0
    buffer_load_dwordx4 a[100:103], v2, s[8:11], s33 offen offset:1024
    buffer_load_dwordx4 a[104:107], v2, s[8:11], s33 offen offset:2048
    buffer_load_dwordx4 a[108:111], v2, s[8:11], s33 offen offset:3072
    s_add_u32 s33, s31, 0x14800
    buffer_load_dwordx4 a[112:115], v2, s[8:11], s33 offen offset:0
    buffer_load_dwordx4 a[116:119], v2, s[8:11], s33 offen offset:1024
    ds_read_b128 v[136:139], v7 offset:256
    ds_read_b128 v[140:143], v7 offset:16640
    s_waitcnt vmcnt(48)
    s_waitcnt lgkmcnt(2)
    v_mfma_f32_16x16x32_bf16 v[16:19], a[120:123], v[144:147], v[16:19]
    v_mfma_f32_16x16x32_bf16 v[20:23], a[120:123], v[148:151], v[20:23]
    v_mfma_f32_16x16x32_bf16 v[24:27], a[124:127], v[144:147], v[24:27]
    v_mfma_f32_16x16x32_bf16 v[28:31], a[124:127], v[148:151], v[28:31]
    v_mfma_f32_16x16x32_bf16 v[32:35], a[128:131], v[144:147], v[32:35]
    v_mfma_f32_16x16x32_bf16 v[36:39], a[128:131], v[148:151], v[36:39]
    v_mfma_f32_16x16x32_bf16 v[40:43], a[132:135], v[144:147], v[40:43]
    v_mfma_f32_16x16x32_bf16 v[44:47], a[132:135], v[148:151], v[44:47]
    v_mfma_f32_16x16x32_bf16 v[48:51], v[144:147], a[136:139], v[48:51]
    v_mfma_f32_16x16x32_bf16 v[52:55], v[148:151], a[136:139], v[52:55]
    v_mfma_f32_16x16x32_bf16 v[56:59], v[144:147], a[140:143], v[56:59]
    v_mfma_f32_16x16x32_bf16 v[60:63], v[148:151], a[140:143], v[60:63]
    ds_read_b128 v[144:147], v8 offset:256
    ds_read_b128 v[148:151], v8 offset:16640
    s_waitcnt vmcnt(42)
    s_waitcnt lgkmcnt(2)
    v_mfma_f32_16x16x32_bf16 v[16:19], a[144:147], v[136:139], v[16:19]
    v_mfma_f32_16x16x32_bf16 v[20:23], a[144:147], v[140:143], v[20:23]
    v_mfma_f32_16x16x32_bf16 v[24:27], a[148:151], v[136:139], v[24:27]
    v_mfma_f32_16x16x32_bf16 v[28:31], a[148:151], v[140:143], v[28:31]
    v_mfma_f32_16x16x32_bf16 v[32:35], a[152:155], v[136:139], v[32:35]
    v_mfma_f32_16x16x32_bf16 v[36:39], a[152:155], v[140:143], v[36:39]
    v_mfma_f32_16x16x32_bf16 v[40:43], a[156:159], v[136:139], v[40:43]
    v_mfma_f32_16x16x32_bf16 v[44:47], a[156:159], v[140:143], v[44:47]
    v_mfma_f32_16x16x32_bf16 v[48:51], v[136:139], a[160:163], v[48:51]
    v_mfma_f32_16x16x32_bf16 v[52:55], v[140:143], a[160:163], v[52:55]
    v_mfma_f32_16x16x32_bf16 v[56:59], v[136:139], a[164:167], v[56:59]
    v_mfma_f32_16x16x32_bf16 v[60:63], v[140:143], a[164:167], v[60:63]
    ds_read_b128 v[136:139], v5 offset:512
    ds_read_b128 v[140:143], v5 offset:16896
    s_waitcnt vmcnt(36)
    s_waitcnt lgkmcnt(2)
    v_mfma_f32_16x16x32_bf16 v[16:19], a[168:171], v[144:147], v[16:19]
    v_mfma_f32_16x16x32_bf16 v[20:23], a[168:171], v[148:151], v[20:23]
    v_mfma_f32_16x16x32_bf16 v[24:27], a[172:175], v[144:147], v[24:27]
    v_mfma_f32_16x16x32_bf16 v[28:31], a[172:175], v[148:151], v[28:31]
    v_mfma_f32_16x16x32_bf16 v[32:35], a[176:179], v[144:147], v[32:35]
    v_mfma_f32_16x16x32_bf16 v[36:39], a[176:179], v[148:151], v[36:39]
    v_mfma_f32_16x16x32_bf16 v[40:43], a[180:183], v[144:147], v[40:43]
    v_mfma_f32_16x16x32_bf16 v[44:47], a[180:183], v[148:151], v[44:47]
    v_mfma_f32_16x16x32_bf16 v[48:51], v[144:147], a[184:187], v[48:51]
    v_mfma_f32_16x16x32_bf16 v[52:55], v[148:151], a[184:187], v[52:55]
    v_mfma_f32_16x16x32_bf16 v[56:59], v[144:147], a[188:191], v[56:59]
    v_mfma_f32_16x16x32_bf16 v[60:63], v[148:151], a[188:191], v[60:63]
    ds_read_b128 v[144:147], v6 offset:512
    ds_read_b128 v[148:151], v6 offset:16896
    s_waitcnt vmcnt(30)
    s_waitcnt lgkmcnt(2)
    v_mfma_f32_16x16x32_bf16 v[16:19], a[192:195], v[136:139], v[16:19]
    v_mfma_f32_16x16x32_bf16 v[20:23], a[192:195], v[140:143], v[20:23]
    v_mfma_f32_16x16x32_bf16 v[24:27], a[196:199], v[136:139], v[24:27]
    v_mfma_f32_16x16x32_bf16 v[28:31], a[196:199], v[140:143], v[28:31]
    v_mfma_f32_16x16x32_bf16 v[32:35], a[200:203], v[136:139], v[32:35]
    v_mfma_f32_16x16x32_bf16 v[36:39], a[200:203], v[140:143], v[36:39]
    v_mfma_f32_16x16x32_bf16 v[40:43], a[204:207], v[136:139], v[40:43]
    v_mfma_f32_16x16x32_bf16 v[44:47], a[204:207], v[140:143], v[44:47]
    v_mfma_f32_16x16x32_bf16 v[48:51], v[136:139], a[208:211], v[48:51]
    v_mfma_f32_16x16x32_bf16 v[52:55], v[140:143], a[208:211], v[52:55]
    v_mfma_f32_16x16x32_bf16 v[56:59], v[136:139], a[212:215], v[56:59]
    v_mfma_f32_16x16x32_bf16 v[60:63], v[140:143], a[212:215], v[60:63]
    ds_read_b128 v[136:139], v7 offset:512
    ds_read_b128 v[140:143], v7 offset:16896
    s_waitcnt vmcnt(24)
    s_waitcnt lgkmcnt(2)
    v_mfma_f32_16x16x32_bf16 v[16:19], a[0:3], v[144:147], v[16:19]
    v_mfma_f32_16x16x32_bf16 v[20:23], a[0:3], v[148:151], v[20:23]
    v_mfma_f32_16x16x32_bf16 v[24:27], a[4:7], v[144:147], v[24:27]
    v_mfma_f32_16x16x32_bf16 v[28:31], a[4:7], v[148:151], v[28:31]
    v_mfma_f32_16x16x32_bf16 v[32:35], a[8:11], v[144:147], v[32:35]
    v_mfma_f32_16x16x32_bf16 v[36:39], a[8:11], v[148:151], v[36:39]
    v_mfma_f32_16x16x32_bf16 v[40:43], a[12:15], v[144:147], v[40:43]
    v_mfma_f32_16x16x32_bf16 v[44:47], a[12:15], v[148:151], v[44:47]
    v_mfma_f32_16x16x32_bf16 v[48:51], v[144:147], a[16:19], v[48:51]
    v_mfma_f32_16x16x32_bf16 v[52:55], v[148:151], a[16:19], v[52:55]
    v_mfma_f32_16x16x32_bf16 v[56:59], v[144:147], a[20:23], v[56:59]
    v_mfma_f32_16x16x32_bf16 v[60:63], v[148:151], a[20:23], v[60:63]
    ds_read_b128 v[144:147], v8 offset:512
    ds_read_b128 v[148:151], v8 offset:16896
    s_waitcnt vmcnt(18)
    s_waitcnt lgkmcnt(2)
    v_mfma_f32_16x16x32_bf16 v[16:19], a[24:27], v[136:139], v[16:19]
    v_mfma_f32_16x16x32_bf16 v[20:23], a[24:27], v[140:143], v[20:23]
    v_mfma_f32_16x16x32_bf16 v[24:27], a[28:31], v[136:139], v[24:27]
    v_mfma_f32_16x16x32_bf16 v[28:31], a[28:31], v[140:143], v[28:31]
    v_mfma_f32_16x16x32_bf16 v[32:35], a[32:35], v[136:139], v[32:35]
    v_mfma_f32_16x16x32_bf16 v[36:39], a[32:35], v[140:143], v[36:39]
    v_mfma_f32_16x16x32_bf16 v[40:43], a[36:39], v[136:139], v[40:43]
    v_mfma_f32_16x16x32_bf16 v[44:47], a[36:39], v[140:143], v[44:47]
    v_mfma_f32_16x16x32_bf16 v[48:51], v[136:139], a[40:43], v[48:51]
    v_mfma_f32_16x16x32_bf16 v[52:55], v[140:143], a[40:43], v[52:55]
    v_mfma_f32_16x16x32_bf16 v[56:59], v[136:139], a[44:47], v[56:59]
    v_mfma_f32_16x16x32_bf16 v[60:63], v[140:143], a[44:47], v[60:63]
    ds_read_b128 v[136:139], v5 offset:768
    ds_read_b128 v[140:143], v5 offset:17152
    s_waitcnt vmcnt(12)
    s_waitcnt lgkmcnt(2)
    v_mfma_f32_16x16x32_bf16 v[16:19], a[48:51], v[144:147], v[16:19]
    v_mfma_f32_16x16x32_bf16 v[20:23], a[48:51], v[148:151], v[20:23]
    v_mfma_f32_16x16x32_bf16 v[24:27], a[52:55], v[144:147], v[24:27]
    v_mfma_f32_16x16x32_bf16 v[28:31], a[52:55], v[148:151], v[28:31]
    v_mfma_f32_16x16x32_bf16 v[32:35], a[56:59], v[144:147], v[32:35]
    v_mfma_f32_16x16x32_bf16 v[36:39], a[56:59], v[148:151], v[36:39]
    v_mfma_f32_16x16x32_bf16 v[40:43], a[60:63], v[144:147], v[40:43]
    v_mfma_f32_16x16x32_bf16 v[44:47], a[60:63], v[148:151], v[44:47]
    v_mfma_f32_16x16x32_bf16 v[48:51], v[144:147], a[64:67], v[48:51]
    v_mfma_f32_16x16x32_bf16 v[52:55], v[148:151], a[64:67], v[52:55]
    v_mfma_f32_16x16x32_bf16 v[56:59], v[144:147], a[68:71], v[56:59]
    v_mfma_f32_16x16x32_bf16 v[60:63], v[148:151], a[68:71], v[60:63]
    ds_read_b128 v[144:147], v6 offset:768
    ds_read_b128 v[148:151], v6 offset:17152
    s_waitcnt vmcnt(6)
    s_waitcnt lgkmcnt(2)
    v_mfma_f32_16x16x32_bf16 v[16:19], a[72:75], v[136:139], v[16:19]
    v_mfma_f32_16x16x32_bf16 v[20:23], a[72:75], v[140:143], v[20:23]
    v_mfma_f32_16x16x32_bf16 v[24:27], a[76:79], v[136:139], v[24:27]
    v_mfma_f32_16x16x32_bf16 v[28:31], a[76:79], v[140:143], v[28:31]
    v_mfma_f32_16x16x32_bf16 v[32:35], a[80:83], v[136:139], v[32:35]
    v_mfma_f32_16x16x32_bf16 v[36:39], a[80:83], v[140:143], v[36:39]
    v_mfma_f32_16x16x32_bf16 v[40:43], a[84:87], v[136:139], v[40:43]
    v_mfma_f32_16x16x32_bf16 v[44:47], a[84:87], v[140:143], v[44:47]
    v_mfma_f32_16x16x32_bf16 v[48:51], v[136:139], a[88:91], v[48:51]
    v_mfma_f32_16x16x32_bf16 v[52:55], v[140:143], a[88:91], v[52:55]
    v_mfma_f32_16x16x32_bf16 v[56:59], v[136:139], a[92:95], v[56:59]
    v_mfma_f32_16x16x32_bf16 v[60:63], v[140:143], a[92:95], v[60:63]
    s_waitcnt vmcnt(0)
    s_waitcnt lgkmcnt(0)
    v_mfma_f32_16x16x32_bf16 v[16:19], a[96:99], v[144:147], v[16:19]
    v_mfma_f32_16x16x32_bf16 v[20:23], a[96:99], v[148:151], v[20:23]
    v_mfma_f32_16x16x32_bf16 v[24:27], a[100:103], v[144:147], v[24:27]
    v_mfma_f32_16x16x32_bf16 v[28:31], a[100:103], v[148:151], v[28:31]
    v_mfma_f32_16x16x32_bf16 v[32:35], a[104:107], v[144:147], v[32:35]
    v_mfma_f32_16x16x32_bf16 v[36:39], a[104:107], v[148:151], v[36:39]
    v_mfma_f32_16x16x32_bf16 v[40:43], a[108:111], v[144:147], v[40:43]
    v_mfma_f32_16x16x32_bf16 v[44:47], a[108:111], v[148:151], v[44:47]
    v_mfma_f32_16x16x32_bf16 v[48:51], v[144:147], a[112:115], v[48:51]
    v_mfma_f32_16x16x32_bf16 v[52:55], v[148:151], a[112:115], v[52:55]
    v_mfma_f32_16x16x32_bf16 v[56:59], v[144:147], a[116:119], v[56:59]
    v_mfma_f32_16x16x32_bf16 v[60:63], v[148:151], a[116:119], v[60:63]
    s_mov_b32 s36, 0
    s_mov_b32 s37, 0xffff0000
    s_mov_b32 s38, 0xf000f000
    s_mov_b32 s39, 0xf000f000
    s_mov_b32 s40, 0x10001000
    s_mov_b32 s41, 0x10001000
    s_mov_b32 s42, 0x3fb8aa3b
    s_nop 7
    s_nop 3
    v_cvt_pk_bf16_f32 v64, v16, v17
    v_cvt_pk_bf16_f32 v65, v18, v19
    v_cvt_pk_bf16_f32 v66, v24, v25
    v_cvt_pk_bf16_f32 v67, v26, v27
    v_cvt_pk_bf16_f32 v68, v20, v21
    v_cvt_pk_bf16_f32 v69, v22, v23
    v_cvt_pk_bf16_f32 v70, v28, v29
    v_cvt_pk_bf16_f32 v71, v30, v31
    v_cvt_pk_bf16_f32 v72, v32, v33
    v_cvt_pk_bf16_f32 v73, v34, v35
    v_cvt_pk_bf16_f32 v74, v40, v41
    v_cvt_pk_bf16_f32 v75, v42, v43
    v_cvt_pk_bf16_f32 v76, v36, v37
    v_cvt_pk_bf16_f32 v77, v38, v39
    v_cvt_pk_bf16_f32 v78, v44, v45
    v_cvt_pk_bf16_f32 v79, v46, v47
    s_nop 1
    v_mfma_f32_16x16x32_bf16 v[80:83], v[152:155], v[64:67], 0
    v_mfma_f32_16x16x32_bf16 v[84:87], v[156:159], v[64:67], 0
    v_mfma_f32_16x16x32_bf16 v[88:91], v[152:155], v[68:71], 0
    v_mfma_f32_16x16x32_bf16 v[92:95], v[156:159], v[68:71], 0
    v_mfma_f32_16x16x32_bf16 v[96:99], v[72:75], v[152:155], 0
    v_mfma_f32_16x16x32_bf16 v[100:103], v[72:75], v[156:159], 0
    v_mfma_f32_16x16x32_bf16 v[104:107], v[76:79], v[152:155], 0
    v_mfma_f32_16x16x32_bf16 v[108:111], v[76:79], v[156:159], 0
    s_nop 7
    s_nop 3
    v_cvt_pk_bf16_f32 v112, v80, v81
    v_lshlrev_b32 v80, 16, v112
    v_and_b32 v81, 0xffff0000, v112
    v_cvt_pk_bf16_f32 v112, v82, v83
    v_lshlrev_b32 v82, 16, v112
    v_and_b32 v83, 0xffff0000, v112
    v_cvt_pk_bf16_f32 v112, v84, v85
    v_lshlrev_b32 v84, 16, v112
    v_and_b32 v85, 0xffff0000, v112
    v_cvt_pk_bf16_f32 v112, v86, v87
    v_lshlrev_b32 v86, 16, v112
    v_and_b32 v87, 0xffff0000, v112
    v_cvt_pk_bf16_f32 v112, v88, v89
    v_lshlrev_b32 v88, 16, v112
    v_and_b32 v89, 0xffff0000, v112
    v_cvt_pk_bf16_f32 v112, v90, v91
    v_lshlrev_b32 v90, 16, v112
    v_and_b32 v91, 0xffff0000, v112
    v_cvt_pk_bf16_f32 v112, v92, v93
    v_lshlrev_b32 v92, 16, v112
    v_and_b32 v93, 0xffff0000, v112
    v_cvt_pk_bf16_f32 v112, v94, v95
    v_lshlrev_b32 v94, 16, v112
    v_and_b32 v95, 0xffff0000, v112
    v_cvt_pk_bf16_f32 v112, v96, v97
    v_lshlrev_b32 v96, 16, v112
    v_and_b32 v97, 0xffff0000, v112
    v_cvt_pk_bf16_f32 v112, v98, v99
    v_lshlrev_b32 v98, 16, v112
    v_and_b32 v99, 0xffff0000, v112
    v_cvt_pk_bf16_f32 v112, v100, v101
    v_lshlrev_b32 v100, 16, v112
    v_and_b32 v101, 0xffff0000, v112
    v_cvt_pk_bf16_f32 v112, v102, v103
    v_lshlrev_b32 v102, 16, v112
    v_and_b32 v103, 0xffff0000, v112
    v_cvt_pk_bf16_f32 v112, v104, v105
    v_lshlrev_b32 v104, 16, v112
    v_and_b32 v105, 0xffff0000, v112
    v_cvt_pk_bf16_f32 v112, v106, v107
    v_lshlrev_b32 v106, 16, v112
    v_and_b32 v107, 0xffff0000, v112
    v_cvt_pk_bf16_f32 v112, v108, v109
    v_lshlrev_b32 v108, 16, v112
    v_and_b32 v109, 0xffff0000, v112
    v_cvt_pk_bf16_f32 v112, v110, v111
    v_lshlrev_b32 v110, 16, v112
    v_and_b32 v111, 0xffff0000, v112
    v_cndmask_b32_e64 v84, v84, v80, s[36:37]
    v_cndmask_b32_e64 v85, v85, v81, s[36:37]
    v_cndmask_b32_e64 v86, v86, v82, s[36:37]
    v_cndmask_b32_e64 v87, v87, v83, s[36:37]
    v_max3_f32 v112, v80, v81, v82
    v_max3_f32 v112, v112, v83, v84
    v_max3_f32 v112, v112, v85, v86
    v_max_f32 v112, v112, v87
    v_min3_f32 v113, v80, v81, v82
    v_min3_f32 v113, v113, v83, v84
    v_min3_f32 v113, v113, v85, v86
    v_min_f32 v113, v113, v87
    v_mov_b32 v114, v112
    s_nop 1
    v_permlane16_swap_b32 v112, v114
    v_max_f32 v112, v112, v114
    v_mov_b32 v114, v112
    s_nop 1
    v_permlane32_swap_b32 v112, v114
    v_max_f32 v112, v112, v114
    v_mov_b32 v114, v113
    s_nop 1
    v_permlane16_swap_b32 v113, v114
    v_min_f32 v113, v113, v114
    v_mov_b32 v114, v113
    s_nop 1
    v_permlane32_swap_b32 v113, v114
    v_min_f32 v113, v113, v114
    v_mul_f32 v112, s42, v112
    v_mul_f32 v113, s42, v113
    v_fma_f32 v116, v80, s42, -v112
    v_fma_f32 v80, -v80, s42, v113
    v_fma_f32 v117, v81, s42, -v112
    v_fma_f32 v81, -v81, s42, v113
    v_fma_f32 v118, v82, s42, -v112
    v_fma_f32 v82, -v82, s42, v113
    v_fma_f32 v119, v83, s42, -v112
    v_fma_f32 v83, -v83, s42, v113
    v_fma_f32 v120, v84, s42, -v112
    v_fma_f32 v84, -v84, s42, v113
    v_fma_f32 v121, v85, s42, -v112
    v_fma_f32 v85, -v85, s42, v113
    v_fma_f32 v122, v86, s42, -v112
    v_fma_f32 v86, -v86, s42, v113
    v_fma_f32 v123, v87, s42, -v112
    v_fma_f32 v87, -v87, s42, v113
    v_exp_f32 v116, v116
    v_exp_f32 v80, v80
    v_exp_f32 v117, v117
    v_exp_f32 v81, v81
    v_exp_f32 v118, v118
    v_exp_f32 v82, v82
    v_exp_f32 v119, v119
    v_exp_f32 v83, v83
    v_exp_f32 v120, v120
    v_exp_f32 v84, v84
    v_exp_f32 v121, v121
    v_exp_f32 v85, v85
    v_exp_f32 v122, v122
    v_exp_f32 v86, v86
    v_exp_f32 v123, v123
    v_exp_f32 v87, v87
    s_nop 0
    v_cndmask_b32_e64 v120, v120, 0, s[36:37]
    v_cndmask_b32_e64 v84, v84, 0, s[36:37]
    v_cndmask_b32_e64 v121, v121, 0, s[36:37]
    v_cndmask_b32_e64 v85, v85, 0, s[36:37]
    v_cndmask_b32_e64 v122, v122, 0, s[36:37]
    v_cndmask_b32_e64 v86, v86, 0, s[36:37]
    v_cndmask_b32_e64 v123, v123, 0, s[36:37]
    v_cndmask_b32_e64 v87, v87, 0, s[36:37]
    v_add_f32 v112, v116, v117
    v_add_f32 v113, v80, v81
    v_add_f32 v112, v112, v118
    v_add_f32 v113, v113, v82
    v_add_f32 v112, v112, v119
    v_add_f32 v113, v113, v83
    v_add_f32 v112, v112, v120
    v_add_f32 v113, v113, v84
    v_add_f32 v112, v112, v121
    v_add_f32 v113, v113, v85
    v_add_f32 v112, v112, v122
    v_add_f32 v113, v113, v86
    v_add_f32 v112, v112, v123
    v_add_f32 v113, v113, v87
    v_mov_b32 v114, v112
    s_nop 1
    v_permlane16_swap_b32 v112, v114
    v_add_f32 v112, v112, v114
    v_mov_b32 v114, v112
    s_nop 1
    v_permlane32_swap_b32 v112, v114
    v_add_f32 v112, v112, v114
    v_mov_b32 v114, v113
    s_nop 1
    v_permlane16_swap_b32 v113, v114
    v_add_f32 v113, v113, v114
    v_mov_b32 v114, v113
    s_nop 1
    v_permlane32_swap_b32 v113, v114
    v_add_f32 v113, v113, v114
    v_rcp_f32 v112, v112
    v_rcp_f32 v113, v113
    s_nop 0
    v_mul_f32 v116, v116, v112
    v_mul_f32 v80, v80, v113
    v_mul_f32 v117, v117, v112
    v_mul_f32 v81, v81, v113
    v_mul_f32 v118, v118, v112
    v_mul_f32 v82, v82, v113
    v_mul_f32 v119, v119, v112
    v_mul_f32 v83, v83, v113
    v_mul_f32 v120, v120, v112
    v_mul_f32 v84, v84, v113
    v_mul_f32 v121, v121, v112
    v_mul_f32 v85, v85, v113
    v_mul_f32 v122, v122, v112
    v_mul_f32 v86, v86, v113
    v_mul_f32 v123, v123, v112
    v_mul_f32 v87, v87, v113
    v_cvt_pk_bf16_f32 v124, v116, v117
    v_cvt_pk_bf16_f32 v125, v118, v119
    v_cvt_pk_bf16_f32 v126, v120, v121
    v_cvt_pk_bf16_f32 v127, v122, v123
    v_cvt_pk_bf16_f32 v128, v80, v81
    v_cvt_pk_bf16_f32 v129, v82, v83
    v_cvt_pk_bf16_f32 v130, v84, v85
    v_cvt_pk_bf16_f32 v131, v86, v87
    s_lshl_b32 s43, s28, 5
    s_add_u32 s43, s43, 0
    s_add_u32 s43, s43, s29
    s_lshl_b32 s43, s43, 11
    buffer_store_dwordx4 v[124:127], v2, s[16:19], s43 offen
    buffer_store_dwordx4 v[128:131], v2, s[16:19], s43 offen offset:1024
    s_nop 1
    v_cndmask_b32_e64 v92, v92, v88, s[36:37]
    v_cndmask_b32_e64 v93, v93, v89, s[36:37]
    v_cndmask_b32_e64 v94, v94, v90, s[36:37]
    v_cndmask_b32_e64 v95, v95, v91, s[36:37]
    v_max3_f32 v112, v88, v89, v90
    v_max3_f32 v112, v112, v91, v92
    v_max3_f32 v112, v112, v93, v94
    v_max_f32 v112, v112, v95
    v_min3_f32 v113, v88, v89, v90
    v_min3_f32 v113, v113, v91, v92
    v_min3_f32 v113, v113, v93, v94
    v_min_f32 v113, v113, v95
    v_mov_b32 v114, v112
    s_nop 1
    v_permlane16_swap_b32 v112, v114
    v_max_f32 v112, v112, v114
    v_mov_b32 v114, v112
    s_nop 1
    v_permlane32_swap_b32 v112, v114
    v_max_f32 v112, v112, v114
    v_mov_b32 v114, v113
    s_nop 1
    v_permlane16_swap_b32 v113, v114
    v_min_f32 v113, v113, v114
    v_mov_b32 v114, v113
    s_nop 1
    v_permlane32_swap_b32 v113, v114
    v_min_f32 v113, v113, v114
    v_mul_f32 v112, s42, v112
    v_mul_f32 v113, s42, v113
    v_fma_f32 v116, v88, s42, -v112
    v_fma_f32 v88, -v88, s42, v113
    v_fma_f32 v117, v89, s42, -v112
    v_fma_f32 v89, -v89, s42, v113
    v_fma_f32 v118, v90, s42, -v112
    v_fma_f32 v90, -v90, s42, v113
    v_fma_f32 v119, v91, s42, -v112
    v_fma_f32 v91, -v91, s42, v113
    v_fma_f32 v120, v92, s42, -v112
    v_fma_f32 v92, -v92, s42, v113
    v_fma_f32 v121, v93, s42, -v112
    v_fma_f32 v93, -v93, s42, v113
    v_fma_f32 v122, v94, s42, -v112
    v_fma_f32 v94, -v94, s42, v113
    v_fma_f32 v123, v95, s42, -v112
    v_fma_f32 v95, -v95, s42, v113
    v_exp_f32 v116, v116
    v_exp_f32 v88, v88
    v_exp_f32 v117, v117
    v_exp_f32 v89, v89
    v_exp_f32 v118, v118
    v_exp_f32 v90, v90
    v_exp_f32 v119, v119
    v_exp_f32 v91, v91
    v_exp_f32 v120, v120
    v_exp_f32 v92, v92
    v_exp_f32 v121, v121
    v_exp_f32 v93, v93
    v_exp_f32 v122, v122
    v_exp_f32 v94, v94
    v_exp_f32 v123, v123
    v_exp_f32 v95, v95
    s_nop 0
    v_cndmask_b32_e64 v120, v120, 0, s[36:37]
    v_cndmask_b32_e64 v92, v92, 0, s[36:37]
    v_cndmask_b32_e64 v121, v121, 0, s[36:37]
    v_cndmask_b32_e64 v93, v93, 0, s[36:37]
    v_cndmask_b32_e64 v122, v122, 0, s[36:37]
    v_cndmask_b32_e64 v94, v94, 0, s[36:37]
    v_cndmask_b32_e64 v123, v123, 0, s[36:37]
    v_cndmask_b32_e64 v95, v95, 0, s[36:37]
    v_add_f32 v112, v116, v117
    v_add_f32 v113, v88, v89
    v_add_f32 v112, v112, v118
    v_add_f32 v113, v113, v90
    v_add_f32 v112, v112, v119
    v_add_f32 v113, v113, v91
    v_add_f32 v112, v112, v120
    v_add_f32 v113, v113, v92
    v_add_f32 v112, v112, v121
    v_add_f32 v113, v113, v93
    v_add_f32 v112, v112, v122
    v_add_f32 v113, v113, v94
    v_add_f32 v112, v112, v123
    v_add_f32 v113, v113, v95
    v_mov_b32 v114, v112
    s_nop 1
    v_permlane16_swap_b32 v112, v114
    v_add_f32 v112, v112, v114
    v_mov_b32 v114, v112
    s_nop 1
    v_permlane32_swap_b32 v112, v114
    v_add_f32 v112, v112, v114
    v_mov_b32 v114, v113
    s_nop 1
    v_permlane16_swap_b32 v113, v114
    v_add_f32 v113, v113, v114
    v_mov_b32 v114, v113
    s_nop 1
    v_permlane32_swap_b32 v113, v114
    v_add_f32 v113, v113, v114
    v_rcp_f32 v112, v112
    v_rcp_f32 v113, v113
    s_nop 0
    v_mul_f32 v116, v116, v112
    v_mul_f32 v88, v88, v113
    v_mul_f32 v117, v117, v112
    v_mul_f32 v89, v89, v113
    v_mul_f32 v118, v118, v112
    v_mul_f32 v90, v90, v113
    v_mul_f32 v119, v119, v112
    v_mul_f32 v91, v91, v113
    v_mul_f32 v120, v120, v112
    v_mul_f32 v92, v92, v113
    v_mul_f32 v121, v121, v112
    v_mul_f32 v93, v93, v113
    v_mul_f32 v122, v122, v112
    v_mul_f32 v94, v94, v113
    v_mul_f32 v123, v123, v112
    v_mul_f32 v95, v95, v113
    v_cvt_pk_bf16_f32 v124, v116, v117
    v_cvt_pk_bf16_f32 v125, v118, v119
    v_cvt_pk_bf16_f32 v126, v120, v121
    v_cvt_pk_bf16_f32 v127, v122, v123
    v_cvt_pk_bf16_f32 v128, v88, v89
    v_cvt_pk_bf16_f32 v129, v90, v91
    v_cvt_pk_bf16_f32 v130, v92, v93
    v_cvt_pk_bf16_f32 v131, v94, v95
    s_lshl_b32 s43, s28, 5
    s_add_u32 s43, s43, 16
    s_add_u32 s43, s43, s29
    s_lshl_b32 s43, s43, 11
    buffer_store_dwordx4 v[124:127], v2, s[16:19], s43 offen
    buffer_store_dwordx4 v[128:131], v2, s[16:19], s43 offen offset:1024
    s_nop 1
    v_cndmask_b32_e64 v100, v100, v96, s[38:39]
    v_cndmask_b32_e64 v101, v101, v97, s[38:39]
    v_cndmask_b32_e64 v102, v102, v98, s[38:39]
    v_cndmask_b32_e64 v103, v103, v99, s[38:39]
    v_max_f32 v112, v96, v100
    v_min_f32 v116, v96, v100
    v_max_f32 v113, v97, v101
    v_min_f32 v117, v97, v101
    v_max_f32 v114, v98, v102
    v_min_f32 v118, v98, v102
    v_max_f32 v115, v99, v103
    v_min_f32 v119, v99, v103
    s_nop 0
    v_max_f32_dpp v112, v112, v112 row_ror:8 row_mask:0xf bank_mask:0xf
    v_min_f32_dpp v116, v116, v116 row_ror:8 row_mask:0xf bank_mask:0xf
    v_max_f32_dpp v113, v113, v113 row_ror:8 row_mask:0xf bank_mask:0xf
    v_min_f32_dpp v117, v117, v117 row_ror:8 row_mask:0xf bank_mask:0xf
    v_max_f32_dpp v114, v114, v114 row_ror:8 row_mask:0xf bank_mask:0xf
    v_min_f32_dpp v118, v118, v118 row_ror:8 row_mask:0xf bank_mask:0xf
    v_max_f32_dpp v115, v115, v115 row_ror:8 row_mask:0xf bank_mask:0xf
    v_min_f32_dpp v119, v119, v119 row_ror:8 row_mask:0xf bank_mask:0xf
    v_max_f32_dpp v112, v112, v112 row_ror:4 row_mask:0xf bank_mask:0xf
    v_min_f32_dpp v116, v116, v116 row_ror:4 row_mask:0xf bank_mask:0xf
    v_max_f32_dpp v113, v113, v113 row_ror:4 row_mask:0xf bank_mask:0xf
    v_min_f32_dpp v117, v117, v117 row_ror:4 row_mask:0xf bank_mask:0xf
    v_max_f32_dpp v114, v114, v114 row_ror:4 row_mask:0xf bank_mask:0xf
    v_min_f32_dpp v118, v118, v118 row_ror:4 row_mask:0xf bank_mask:0xf
    v_max_f32_dpp v115, v115, v115 row_ror:4 row_mask:0xf bank_mask:0xf
    v_min_f32_dpp v119, v119, v119 row_ror:4 row_mask:0xf bank_mask:0xf
    v_max_f32_dpp v112, v112, v112 row_ror:2 row_mask:0xf bank_mask:0xf
    v_min_f32_dpp v116, v116, v116 row_ror:2 row_mask:0xf bank_mask:0xf
    v_max_f32_dpp v113, v113, v113 row_ror:2 row_mask:0xf bank_mask:0xf
    v_min_f32_dpp v117, v117, v117 row_ror:2 row_mask:0xf bank_mask:0xf
    v_max_f32_dpp v114, v114, v114 row_ror:2 row_mask:0xf bank_mask:0xf
    v_min_f32_dpp v118, v118, v118 row_ror:2 row_mask:0xf bank_mask:0xf
    v_max_f32_dpp v115, v115, v115 row_ror:2 row_mask:0xf bank_mask:0xf
    v_min_f32_dpp v119, v119, v119 row_ror:2 row_mask:0xf bank_mask:0xf
    v_max_f32_dpp v112, v112, v112 row_ror:1 row_mask:0xf bank_mask:0xf
    v_min_f32_dpp v116, v116, v116 row_ror:1 row_mask:0xf bank_mask:0xf
    v_max_f32_dpp v113, v113, v113 row_ror:1 row_mask:0xf bank_mask:0xf
    v_min_f32_dpp v117, v117, v117 row_ror:1 row_mask:0xf bank_mask:0xf
    v_max_f32_dpp v114, v114, v114 row_ror:1 row_mask:0xf bank_mask:0xf
    v_min_f32_dpp v118, v118, v118 row_ror:1 row_mask:0xf bank_mask:0xf
    v_max_f32_dpp v115, v115, v115 row_ror:1 row_mask:0xf bank_mask:0xf
    v_min_f32_dpp v119, v119, v119 row_ror:1 row_mask:0xf bank_mask:0xf
    v_mul_f32 v112, s42, v112
    v_mul_f32 v116, s42, v116
    v_mul_f32 v113, s42, v113
    v_mul_f32 v117, s42, v117
    v_mul_f32 v114, s42, v114
    v_mul_f32 v118, s42, v118
    v_mul_f32 v115, s42, v115
    v_mul_f32 v119, s42, v119
    v_fma_f32 v120, v96, s42, -v112
    v_fma_f32 v96, -v96, s42, v116
    v_fma_f32 v121, v97, s42, -v113
    v_fma_f32 v97, -v97, s42, v117
    v_fma_f32 v122, v98, s42, -v114
    v_fma_f32 v98, -v98, s42, v118
    v_fma_f32 v123, v99, s42, -v115
    v_fma_f32 v99, -v99, s42, v119
    v_fma_f32 v124, v100, s42, -v112
    v_fma_f32 v100, -v100, s42, v116
    v_fma_f32 v125, v101, s42, -v113
    v_fma_f32 v101, -v101, s42, v117
    v_fma_f32 v126, v102, s42, -v114
    v_fma_f32 v102, -v102, s42, v118
    v_fma_f32 v127, v103, s42, -v115
    v_fma_f32 v103, -v103, s42, v119
    v_exp_f32 v120, v120
    v_exp_f32 v96, v96
    v_exp_f32 v121, v121
    v_exp_f32 v97, v97
    v_exp_f32 v122, v122
    v_exp_f32 v98, v98
    v_exp_f32 v123, v123
    v_exp_f32 v99, v99
    v_exp_f32 v124, v124
    v_exp_f32 v100, v100
    v_exp_f32 v125, v125
    v_exp_f32 v101, v101
    v_exp_f32 v126, v126
    v_exp_f32 v102, v102
    v_exp_f32 v127, v127
    v_exp_f32 v103, v103
    s_nop 0
    v_cndmask_b32_e64 v124, v124, 0, s[38:39]
    v_cndmask_b32_e64 v100, v100, 0, s[38:39]
    v_cndmask_b32_e64 v125, v125, 0, s[38:39]
    v_cndmask_b32_e64 v101, v101, 0, s[38:39]
    v_cndmask_b32_e64 v126, v126, 0, s[38:39]
    v_cndmask_b32_e64 v102, v102, 0, s[38:39]
    v_cndmask_b32_e64 v127, v127, 0, s[38:39]
    v_cndmask_b32_e64 v103, v103, 0, s[38:39]
    v_add_f32 v112, v120, v124
    v_add_f32 v116, v96, v100
    v_add_f32 v113, v121, v125
    v_add_f32 v117, v97, v101
    v_add_f32 v114, v122, v126
    v_add_f32 v118, v98, v102
    v_add_f32 v115, v123, v127
    v_add_f32 v119, v99, v103
    s_nop 0
    v_add_f32_dpp v112, v112, v112 row_ror:8 row_mask:0xf bank_mask:0xf
    v_add_f32_dpp v116, v116, v116 row_ror:8 row_mask:0xf bank_mask:0xf
    v_add_f32_dpp v113, v113, v113 row_ror:8 row_mask:0xf bank_mask:0xf
    v_add_f32_dpp v117, v117, v117 row_ror:8 row_mask:0xf bank_mask:0xf
    v_add_f32_dpp v114, v114, v114 row_ror:8 row_mask:0xf bank_mask:0xf
    v_add_f32_dpp v118, v118, v118 row_ror:8 row_mask:0xf bank_mask:0xf
    v_add_f32_dpp v115, v115, v115 row_ror:8 row_mask:0xf bank_mask:0xf
    v_add_f32_dpp v119, v119, v119 row_ror:8 row_mask:0xf bank_mask:0xf
    v_add_f32_dpp v112, v112, v112 row_ror:4 row_mask:0xf bank_mask:0xf
    v_add_f32_dpp v116, v116, v116 row_ror:4 row_mask:0xf bank_mask:0xf
    v_add_f32_dpp v113, v113, v113 row_ror:4 row_mask:0xf bank_mask:0xf
    v_add_f32_dpp v117, v117, v117 row_ror:4 row_mask:0xf bank_mask:0xf
    v_add_f32_dpp v114, v114, v114 row_ror:4 row_mask:0xf bank_mask:0xf
    v_add_f32_dpp v118, v118, v118 row_ror:4 row_mask:0xf bank_mask:0xf
    v_add_f32_dpp v115, v115, v115 row_ror:4 row_mask:0xf bank_mask:0xf
    v_add_f32_dpp v119, v119, v119 row_ror:4 row_mask:0xf bank_mask:0xf
    v_add_f32_dpp v112, v112, v112 row_ror:2 row_mask:0xf bank_mask:0xf
    v_add_f32_dpp v116, v116, v116 row_ror:2 row_mask:0xf bank_mask:0xf
    v_add_f32_dpp v113, v113, v113 row_ror:2 row_mask:0xf bank_mask:0xf
    v_add_f32_dpp v117, v117, v117 row_ror:2 row_mask:0xf bank_mask:0xf
    v_add_f32_dpp v114, v114, v114 row_ror:2 row_mask:0xf bank_mask:0xf
    v_add_f32_dpp v118, v118, v118 row_ror:2 row_mask:0xf bank_mask:0xf
    v_add_f32_dpp v115, v115, v115 row_ror:2 row_mask:0xf bank_mask:0xf
    v_add_f32_dpp v119, v119, v119 row_ror:2 row_mask:0xf bank_mask:0xf
    v_add_f32_dpp v112, v112, v112 row_ror:1 row_mask:0xf bank_mask:0xf
    v_add_f32_dpp v116, v116, v116 row_ror:1 row_mask:0xf bank_mask:0xf
    v_add_f32_dpp v113, v113, v113 row_ror:1 row_mask:0xf bank_mask:0xf
    v_add_f32_dpp v117, v117, v117 row_ror:1 row_mask:0xf bank_mask:0xf
    v_add_f32_dpp v114, v114, v114 row_ror:1 row_mask:0xf bank_mask:0xf
    v_add_f32_dpp v118, v118, v118 row_ror:1 row_mask:0xf bank_mask:0xf
    v_add_f32_dpp v115, v115, v115 row_ror:1 row_mask:0xf bank_mask:0xf
    v_add_f32_dpp v119, v119, v119 row_ror:1 row_mask:0xf bank_mask:0xf
    v_rcp_f32 v112, v112
    v_rcp_f32 v116, v116
    v_rcp_f32 v113, v113
    v_rcp_f32 v117, v117
    v_rcp_f32 v114, v114
    v_rcp_f32 v118, v118
    v_rcp_f32 v115, v115
    v_rcp_f32 v119, v119
    s_nop 0
    v_mul_f32 v120, v120, v112
    v_mul_f32 v96, v96, v116
    v_mul_f32 v121, v121, v113
    v_mul_f32 v97, v97, v117
    v_mul_f32 v122, v122, v114
    v_mul_f32 v98, v98, v118
    v_mul_f32 v123, v123, v115
    v_mul_f32 v99, v99, v119
    v_mul_f32 v124, v124, v112
    v_mul_f32 v100, v100, v116
    v_mul_f32 v125, v125, v113
    v_mul_f32 v101, v101, v117
    v_mul_f32 v126, v126, v114
    v_mul_f32 v102, v102, v118
    v_mul_f32 v127, v127, v115
    v_mul_f32 v103, v103, v119
    v_cvt_pk_bf16_f32 v16, v120, v121
    v_cvt_pk_bf16_f32 v24, v96, v97
    v_cvt_pk_bf16_f32 v17, v122, v123
    v_cvt_pk_bf16_f32 v25, v98, v99
    v_cvt_pk_bf16_f32 v20, v124, v125
    v_cvt_pk_bf16_f32 v28, v100, v101
    v_cvt_pk_bf16_f32 v21, v126, v127
    v_cvt_pk_bf16_f32 v29, v102, v103
    v_cndmask_b32_e64 v108, v108, v104, s[38:39]
    v_cndmask_b32_e64 v109, v109, v105, s[38:39]
    v_cndmask_b32_e64 v110, v110, v106, s[38:39]
    v_cndmask_b32_e64 v111, v111, v107, s[38:39]
    v_max_f32 v112, v104, v108
    v_min_f32 v116, v104, v108
    v_max_f32 v113, v105, v109
    v_min_f32 v117, v105, v109
    v_max_f32 v114, v106, v110
    v_min_f32 v118, v106, v110
    v_max_f32 v115, v107, v111
    v_min_f32 v119, v107, v111
    s_nop 0
    v_max_f32_dpp v112, v112, v112 row_ror:8 row_mask:0xf bank_mask:0xf
    v_min_f32_dpp v116, v116, v116 row_ror:8 row_mask:0xf bank_mask:0xf
    v_max_f32_dpp v113, v113, v113 row_ror:8 row_mask:0xf bank_mask:0xf
    v_min_f32_dpp v117, v117, v117 row_ror:8 row_mask:0xf bank_mask:0xf
    v_max_f32_dpp v114, v114, v114 row_ror:8 row_mask:0xf bank_mask:0xf
    v_min_f32_dpp v118, v118, v118 row_ror:8 row_mask:0xf bank_mask:0xf
    v_max_f32_dpp v115, v115, v115 row_ror:8 row_mask:0xf bank_mask:0xf
    v_min_f32_dpp v119, v119, v119 row_ror:8 row_mask:0xf bank_mask:0xf
    v_max_f32_dpp v112, v112, v112 row_ror:4 row_mask:0xf bank_mask:0xf
    v_min_f32_dpp v116, v116, v116 row_ror:4 row_mask:0xf bank_mask:0xf
    v_max_f32_dpp v113, v113, v113 row_ror:4 row_mask:0xf bank_mask:0xf
    v_min_f32_dpp v117, v117, v117 row_ror:4 row_mask:0xf bank_mask:0xf
    v_max_f32_dpp v114, v114, v114 row_ror:4 row_mask:0xf bank_mask:0xf
    v_min_f32_dpp v118, v118, v118 row_ror:4 row_mask:0xf bank_mask:0xf
    v_max_f32_dpp v115, v115, v115 row_ror:4 row_mask:0xf bank_mask:0xf
    v_min_f32_dpp v119, v119, v119 row_ror:4 row_mask:0xf bank_mask:0xf
    v_max_f32_dpp v112, v112, v112 row_ror:2 row_mask:0xf bank_mask:0xf
    v_min_f32_dpp v116, v116, v116 row_ror:2 row_mask:0xf bank_mask:0xf
    v_max_f32_dpp v113, v113, v113 row_ror:2 row_mask:0xf bank_mask:0xf
    v_min_f32_dpp v117, v117, v117 row_ror:2 row_mask:0xf bank_mask:0xf
    v_max_f32_dpp v114, v114, v114 row_ror:2 row_mask:0xf bank_mask:0xf
    v_min_f32_dpp v118, v118, v118 row_ror:2 row_mask:0xf bank_mask:0xf
    v_max_f32_dpp v115, v115, v115 row_ror:2 row_mask:0xf bank_mask:0xf
    v_min_f32_dpp v119, v119, v119 row_ror:2 row_mask:0xf bank_mask:0xf
    v_max_f32_dpp v112, v112, v112 row_ror:1 row_mask:0xf bank_mask:0xf
    v_min_f32_dpp v116, v116, v116 row_ror:1 row_mask:0xf bank_mask:0xf
    v_max_f32_dpp v113, v113, v113 row_ror:1 row_mask:0xf bank_mask:0xf
    v_min_f32_dpp v117, v117, v117 row_ror:1 row_mask:0xf bank_mask:0xf
    v_max_f32_dpp v114, v114, v114 row_ror:1 row_mask:0xf bank_mask:0xf
    v_min_f32_dpp v118, v118, v118 row_ror:1 row_mask:0xf bank_mask:0xf
    v_max_f32_dpp v115, v115, v115 row_ror:1 row_mask:0xf bank_mask:0xf
    v_min_f32_dpp v119, v119, v119 row_ror:1 row_mask:0xf bank_mask:0xf
    v_mul_f32 v112, s42, v112
    v_mul_f32 v116, s42, v116
    v_mul_f32 v113, s42, v113
    v_mul_f32 v117, s42, v117
    v_mul_f32 v114, s42, v114
    v_mul_f32 v118, s42, v118
    v_mul_f32 v115, s42, v115
    v_mul_f32 v119, s42, v119
    v_fma_f32 v120, v104, s42, -v112
    v_fma_f32 v104, -v104, s42, v116
    v_fma_f32 v121, v105, s42, -v113
    v_fma_f32 v105, -v105, s42, v117
    v_fma_f32 v122, v106, s42, -v114
    v_fma_f32 v106, -v106, s42, v118
    v_fma_f32 v123, v107, s42, -v115
    v_fma_f32 v107, -v107, s42, v119
    v_fma_f32 v124, v108, s42, -v112
    v_fma_f32 v108, -v108, s42, v116
    v_fma_f32 v125, v109, s42, -v113
    v_fma_f32 v109, -v109, s42, v117
    v_fma_f32 v126, v110, s42, -v114
    v_fma_f32 v110, -v110, s42, v118
    v_fma_f32 v127, v111, s42, -v115
    v_fma_f32 v111, -v111, s42, v119
    v_exp_f32 v120, v120
    v_exp_f32 v104, v104
    v_exp_f32 v121, v121
    v_exp_f32 v105, v105
    v_exp_f32 v122, v122
    v_exp_f32 v106, v106
    v_exp_f32 v123, v123
    v_exp_f32 v107, v107
    v_exp_f32 v124, v124
    v_exp_f32 v108, v108
    v_exp_f32 v125, v125
    v_exp_f32 v109, v109
    v_exp_f32 v126, v126
    v_exp_f32 v110, v110
    v_exp_f32 v127, v127
    v_exp_f32 v111, v111
    s_nop 0
    v_cndmask_b32_e64 v124, v124, 0, s[38:39]
    v_cndmask_b32_e64 v108, v108, 0, s[38:39]
    v_cndmask_b32_e64 v125, v125, 0, s[38:39]
    v_cndmask_b32_e64 v109, v109, 0, s[38:39]
    v_cndmask_b32_e64 v126, v126, 0, s[38:39]
    v_cndmask_b32_e64 v110, v110, 0, s[38:39]
    v_cndmask_b32_e64 v127, v127, 0, s[38:39]
    v_cndmask_b32_e64 v111, v111, 0, s[38:39]
    v_add_f32 v112, v120, v124
    v_add_f32 v116, v104, v108
    v_add_f32 v113, v121, v125
    v_add_f32 v117, v105, v109
    v_add_f32 v114, v122, v126
    v_add_f32 v118, v106, v110
    v_add_f32 v115, v123, v127
    v_add_f32 v119, v107, v111
    s_nop 0
    v_add_f32_dpp v112, v112, v112 row_ror:8 row_mask:0xf bank_mask:0xf
    v_add_f32_dpp v116, v116, v116 row_ror:8 row_mask:0xf bank_mask:0xf
    v_add_f32_dpp v113, v113, v113 row_ror:8 row_mask:0xf bank_mask:0xf
    v_add_f32_dpp v117, v117, v117 row_ror:8 row_mask:0xf bank_mask:0xf
    v_add_f32_dpp v114, v114, v114 row_ror:8 row_mask:0xf bank_mask:0xf
    v_add_f32_dpp v118, v118, v118 row_ror:8 row_mask:0xf bank_mask:0xf
    v_add_f32_dpp v115, v115, v115 row_ror:8 row_mask:0xf bank_mask:0xf
    v_add_f32_dpp v119, v119, v119 row_ror:8 row_mask:0xf bank_mask:0xf
    v_add_f32_dpp v112, v112, v112 row_ror:4 row_mask:0xf bank_mask:0xf
    v_add_f32_dpp v116, v116, v116 row_ror:4 row_mask:0xf bank_mask:0xf
    v_add_f32_dpp v113, v113, v113 row_ror:4 row_mask:0xf bank_mask:0xf
    v_add_f32_dpp v117, v117, v117 row_ror:4 row_mask:0xf bank_mask:0xf
    v_add_f32_dpp v114, v114, v114 row_ror:4 row_mask:0xf bank_mask:0xf
    v_add_f32_dpp v118, v118, v118 row_ror:4 row_mask:0xf bank_mask:0xf
    v_add_f32_dpp v115, v115, v115 row_ror:4 row_mask:0xf bank_mask:0xf
    v_add_f32_dpp v119, v119, v119 row_ror:4 row_mask:0xf bank_mask:0xf
    v_add_f32_dpp v112, v112, v112 row_ror:2 row_mask:0xf bank_mask:0xf
    v_add_f32_dpp v116, v116, v116 row_ror:2 row_mask:0xf bank_mask:0xf
    v_add_f32_dpp v113, v113, v113 row_ror:2 row_mask:0xf bank_mask:0xf
    v_add_f32_dpp v117, v117, v117 row_ror:2 row_mask:0xf bank_mask:0xf
    v_add_f32_dpp v114, v114, v114 row_ror:2 row_mask:0xf bank_mask:0xf
    v_add_f32_dpp v118, v118, v118 row_ror:2 row_mask:0xf bank_mask:0xf
    v_add_f32_dpp v115, v115, v115 row_ror:2 row_mask:0xf bank_mask:0xf
    v_add_f32_dpp v119, v119, v119 row_ror:2 row_mask:0xf bank_mask:0xf
    v_add_f32_dpp v112, v112, v112 row_ror:1 row_mask:0xf bank_mask:0xf
    v_add_f32_dpp v116, v116, v116 row_ror:1 row_mask:0xf bank_mask:0xf
    v_add_f32_dpp v113, v113, v113 row_ror:1 row_mask:0xf bank_mask:0xf
    v_add_f32_dpp v117, v117, v117 row_ror:1 row_mask:0xf bank_mask:0xf
    v_add_f32_dpp v114, v114, v114 row_ror:1 row_mask:0xf bank_mask:0xf
    v_add_f32_dpp v118, v118, v118 row_ror:1 row_mask:0xf bank_mask:0xf
    v_add_f32_dpp v115, v115, v115 row_ror:1 row_mask:0xf bank_mask:0xf
    v_add_f32_dpp v119, v119, v119 row_ror:1 row_mask:0xf bank_mask:0xf
    v_rcp_f32 v112, v112
    v_rcp_f32 v116, v116
    v_rcp_f32 v113, v113
    v_rcp_f32 v117, v117
    v_rcp_f32 v114, v114
    v_rcp_f32 v118, v118
    v_rcp_f32 v115, v115
    v_rcp_f32 v119, v119
    s_nop 0
    v_mul_f32 v120, v120, v112
    v_mul_f32 v104, v104, v116
    v_mul_f32 v121, v121, v113
    v_mul_f32 v105, v105, v117
    v_mul_f32 v122, v122, v114
    v_mul_f32 v106, v106, v118
    v_mul_f32 v123, v123, v115
    v_mul_f32 v107, v107, v119
    v_mul_f32 v124, v124, v112
    v_mul_f32 v108, v108, v116
    v_mul_f32 v125, v125, v113
    v_mul_f32 v109, v109, v117
    v_mul_f32 v126, v126, v114
    v_mul_f32 v110, v110, v118
    v_mul_f32 v127, v127, v115
    v_mul_f32 v111, v111, v119
    v_cvt_pk_bf16_f32 v18, v120, v121
    v_cvt_pk_bf16_f32 v26, v104, v105
    v_cvt_pk_bf16_f32 v19, v122, v123
    v_cvt_pk_bf16_f32 v27, v106, v107
    v_cvt_pk_bf16_f32 v22, v124, v125
    v_cvt_pk_bf16_f32 v30, v108, v109
    v_cvt_pk_bf16_f32 v23, v126, v127
    v_cvt_pk_bf16_f32 v31, v110, v111
    v_cndmask_b32_e64 v56, v56, 1.0, s[40:41]
    v_cndmask_b32_e64 v57, v57, 1.0, s[40:41]
    v_cndmask_b32_e64 v58, v58, 1.0, s[40:41]
    v_cndmask_b32_e64 v59, v59, 1.0, s[40:41]
    v_cndmask_b32_e64 v60, v60, 1.0, s[40:41]
    v_cndmask_b32_e64 v61, v61, 1.0, s[40:41]
    v_cndmask_b32_e64 v62, v62, 1.0, s[40:41]
    v_cndmask_b32_e64 v63, v63, 1.0, s[40:41]
    v_cvt_pk_bf16_f32 v32, v48, v49
    v_cvt_pk_bf16_f32 v33, v50, v51
    v_cvt_pk_bf16_f32 v34, v52, v53
    v_cvt_pk_bf16_f32 v35, v54, v55
    v_cvt_pk_bf16_f32 v36, v56, v57
    v_cvt_pk_bf16_f32 v37, v58, v59
    v_cvt_pk_bf16_f32 v38, v60, v61
    v_cvt_pk_bf16_f32 v39, v62, v63
    s_nop 1
    v_mfma_f32_16x16x32_bf16 v[64:67], v[16:19], v[32:35], 0
    v_mfma_f32_16x16x32_bf16 v[68:71], v[16:19], v[36:39], 0
    v_mfma_f32_16x16x32_bf16 v[72:75], v[20:23], v[32:35], 0
    v_mfma_f32_16x16x32_bf16 v[76:79], v[20:23], v[36:39], 0
    v_mfma_f32_16x16x32_bf16 v[80:83], v[24:27], v[32:35], 0
    v_mfma_f32_16x16x32_bf16 v[84:87], v[24:27], v[36:39], 0
    v_mfma_f32_16x16x32_bf16 v[88:91], v[28:31], v[32:35], 0
    v_mfma_f32_16x16x32_bf16 v[92:95], v[28:31], v[36:39], 0
    v_lshlrev_b32 v9, 2, v1
    s_lshl_b32 s43, s28, 4
    s_add_u32 s43, s43, s29
    s_lshl_b32 s43, s43, 13
    s_add_u32 s44, s43, 4096
    s_nop 7
    s_nop 3
    buffer_store_dword v64, v9, s[20:23], s43 offen offset:0
    buffer_store_dword v65, v9, s[20:23], s43 offen offset:256
    buffer_store_dword v66, v9, s[20:23], s43 offen offset:512
    buffer_store_dword v67, v9, s[20:23], s43 offen offset:768
    buffer_store_dword v68, v9, s[20:23], s43 offen offset:1024
    buffer_store_dword v69, v9, s[20:23], s43 offen offset:1280
    buffer_store_dword v70, v9, s[20:23], s43 offen offset:1536
    buffer_store_dword v71, v9, s[20:23], s43 offen offset:1792
    buffer_store_dword v72, v9, s[20:23], s43 offen offset:2048
    buffer_store_dword v73, v9, s[20:23], s43 offen offset:2304
    buffer_store_dword v74, v9, s[20:23], s43 offen offset:2560
    buffer_store_dword v75, v9, s[20:23], s43 offen offset:2816
    buffer_store_dword v76, v9, s[20:23], s43 offen offset:3072
    buffer_store_dword v77, v9, s[20:23], s43 offen offset:3328
    buffer_store_dword v78, v9, s[20:23], s43 offen offset:3584
    buffer_store_dword v79, v9, s[20:23], s43 offen offset:3840
    buffer_store_dword v80, v9, s[20:23], s44 offen offset:0
    buffer_store_dword v81, v9, s[20:23], s44 offen offset:256
    buffer_store_dword v82, v9, s[20:23], s44 offen offset:512
    buffer_store_dword v83, v9, s[20:23], s44 offen offset:768
    buffer_store_dword v84, v9, s[20:23], s44 offen offset:1024
    buffer_store_dword v85, v9, s[20:23], s44 offen offset:1280
    buffer_store_dword v86, v9, s[20:23], s44 offen offset:1536
    buffer_store_dword v87, v9, s[20:23], s44 offen offset:1792
    buffer_store_dword v88, v9, s[20:23], s44 offen offset:2048
    buffer_store_dword v89, v9, s[20:23], s44 offen offset:2304
    buffer_store_dword v90, v9, s[20:23], s44 offen offset:2560
    buffer_store_dword v91, v9, s[20:23], s44 offen offset:2816
    buffer_store_dword v92, v9, s[20:23], s44 offen offset:3072
    buffer_store_dword v93, v9, s[20:23], s44 offen offset:3328
    buffer_store_dword v94, v9, s[20:23], s44 offen offset:3584
    buffer_store_dword v95, v9, s[20:23], s44 offen offset:3840
k1l2_kernel_done:
    s_endpgm
.globl krl2_kernel
.p2align 8
.type krl2_kernel,@function
krl2_kernel:
    s_cmp_ge_u32 s2, 128
    s_cbranch_scc1 krl2_kernel_done
    s_load_dwordx2 s[4:5], s[0:1], 88
    s_lshl_b32 s3, s2, 8
    v_add_u32 v1, s3, v0
    v_lshlrev_b32 v2, 2, v1
    s_waitcnt lgkmcnt(0)
    s_add_u32 s8, s4, 0x528000
    s_addc_u32 s9, s5, 0
    s_mov_b32 s10, 0x800000
    s_mov_b32 s11, 0x00020000
    s_add_u32 s12, s4, 0xd28000
    s_addc_u32 s13, s5, 0
    s_mov_b32 s14, 0x10000
    s_mov_b32 s15, 0x00020000
    s_mov_b32 s16, 0x0
    buffer_load_dword v8, v2, s[8:11], s16 offen
    s_mov_b32 s16, 0x20000
    buffer_load_dword v9, v2, s[8:11], s16 offen
    s_mov_b32 s16, 0x40000
    buffer_load_dword v10, v2, s[8:11], s16 offen
    s_mov_b32 s16, 0x60000
    buffer_load_dword v11, v2, s[8:11], s16 offen
    s_mov_b32 s16, 0x80000
    buffer_load_dword v12, v2, s[8:11], s16 offen
    s_mov_b32 s16, 0xa0000
    buffer_load_dword v13, v2, s[8:11], s16 offen
    s_mov_b32 s16, 0xc0000
    buffer_load_dword v14, v2, s[8:11], s16 offen
    s_mov_b32 s16, 0xe0000
    buffer_load_dword v15, v2, s[8:11], s16 offen
    s_mov_b32 s16, 0x100000
    buffer_load_dword v16, v2, s[8:11], s16 offen
    s_mov_b32 s16, 0x120000
    buffer_load_dword v17, v2, s[8:11], s16 offen
    s_mov_b32 s16, 0x140000
    buffer_load_dword v18, v2, s[8:11], s16 offen
    s_mov_b32 s16, 0x160000
    buffer_load_dword v19, v2, s[8:11], s16 offen
    s_mov_b32 s16, 0x180000
    buffer_load_dword v20, v2, s[8:11], s16 offen
    s_mov_b32 s16, 0x1a0000
    buffer_load_dword v21, v2, s[8:11], s16 offen
    s_mov_b32 s16, 0x1c0000
    buffer_load_dword v22, v2, s[8:11], s16 offen
    s_mov_b32 s16, 0x1e0000
    buffer_load_dword v23, v2, s[8:11], s16 offen
    s_mov_b32 s16, 0x200000
    buffer_load_dword v24, v2, s[8:11], s16 offen
    s_mov_b32 s16, 0x220000
    buffer_load_dword v25, v2, s[8:11], s16 offen
    s_mov_b32 s16, 0x240000
    buffer_load_dword v26, v2, s[8:11], s16 offen
    s_mov_b32 s16, 0x260000
    buffer_load_dword v27, v2, s[8:11], s16 offen
    s_mov_b32 s16, 0x280000
    buffer_load_dword v28, v2, s[8:11], s16 offen
    s_mov_b32 s16, 0x2a0000
    buffer_load_dword v29, v2, s[8:11], s16 offen
    s_mov_b32 s16, 0x2c0000
    buffer_load_dword v30, v2, s[8:11], s16 offen
    s_mov_b32 s16, 0x2e0000
    buffer_load_dword v31, v2, s[8:11], s16 offen
    s_mov_b32 s16, 0x300000
    buffer_load_dword v32, v2, s[8:11], s16 offen
    s_mov_b32 s16, 0x320000
    buffer_load_dword v33, v2, s[8:11], s16 offen
    s_mov_b32 s16, 0x340000
    buffer_load_dword v34, v2, s[8:11], s16 offen
    s_mov_b32 s16, 0x360000
    buffer_load_dword v35, v2, s[8:11], s16 offen
    s_mov_b32 s16, 0x380000
    buffer_load_dword v36, v2, s[8:11], s16 offen
    s_mov_b32 s16, 0x3a0000
    buffer_load_dword v37, v2, s[8:11], s16 offen
    s_mov_b32 s16, 0x3c0000
    buffer_load_dword v38, v2, s[8:11], s16 offen
    s_mov_b32 s16, 0x3e0000
    buffer_load_dword v39, v2, s[8:11], s16 offen
    s_mov_b32 s16, 0x400000
    buffer_load_dword v40, v2, s[8:11], s16 offen
    s_mov_b32 s16, 0x420000
    buffer_load_dword v41, v2, s[8:11], s16 offen
    s_mov_b32 s16, 0x440000
    buffer_load_dword v42, v2, s[8:11], s16 offen
    s_mov_b32 s16, 0x460000
    buffer_load_dword v43, v2, s[8:11], s16 offen
    s_mov_b32 s16, 0x480000
    buffer_load_dword v44, v2, s[8:11], s16 offen
    s_mov_b32 s16, 0x4a0000
    buffer_load_dword v45, v2, s[8:11], s16 offen
    s_mov_b32 s16, 0x4c0000
    buffer_load_dword v46, v2, s[8:11], s16 offen
    s_mov_b32 s16, 0x4e0000
    buffer_load_dword v47, v2, s[8:11], s16 offen
    s_mov_b32 s16, 0x500000
    buffer_load_dword v48, v2, s[8:11], s16 offen
    s_mov_b32 s16, 0x520000
    buffer_load_dword v49, v2, s[8:11], s16 offen
    s_mov_b32 s16, 0x540000
    buffer_load_dword v50, v2, s[8:11], s16 offen
    s_mov_b32 s16, 0x560000
    buffer_load_dword v51, v2, s[8:11], s16 offen
    s_mov_b32 s16, 0x580000
    buffer_load_dword v52, v2, s[8:11], s16 offen
    s_mov_b32 s16, 0x5a0000
    buffer_load_dword v53, v2, s[8:11], s16 offen
    s_mov_b32 s16, 0x5c0000
    buffer_load_dword v54, v2, s[8:11], s16 offen
    s_mov_b32 s16, 0x5e0000
    buffer_load_dword v55, v2, s[8:11], s16 offen
    s_mov_b32 s16, 0x600000
    buffer_load_dword v56, v2, s[8:11], s16 offen
    s_mov_b32 s16, 0x620000
    buffer_load_dword v57, v2, s[8:11], s16 offen
    s_mov_b32 s16, 0x640000
    buffer_load_dword v58, v2, s[8:11], s16 offen
    s_mov_b32 s16, 0x660000
    buffer_load_dword v59, v2, s[8:11], s16 offen
    s_mov_b32 s16, 0x680000
    buffer_load_dword v60, v2, s[8:11], s16 offen
    s_mov_b32 s16, 0x6a0000
    buffer_load_dword v61, v2, s[8:11], s16 offen
    s_mov_b32 s16, 0x6c0000
    buffer_load_dword v62, v2, s[8:11], s16 offen
    s_mov_b32 s16, 0x6e0000
    buffer_load_dword v63, v2, s[8:11], s16 offen
    s_mov_b32 s16, 0x700000
    buffer_load_dword v64, v2, s[8:11], s16 offen
    s_mov_b32 s16, 0x720000
    buffer_load_dword v65, v2, s[8:11], s16 offen
    s_mov_b32 s16, 0x740000
    buffer_load_dword v66, v2, s[8:11], s16 offen
    s_mov_b32 s16, 0x760000
    buffer_load_dword v67, v2, s[8:11], s16 offen
    s_mov_b32 s16, 0x780000
    buffer_load_dword v68, v2, s[8:11], s16 offen
    s_mov_b32 s16, 0x7a0000
    buffer_load_dword v69, v2, s[8:11], s16 offen
    s_mov_b32 s16, 0x7c0000
    buffer_load_dword v70, v2, s[8:11], s16 offen
    s_mov_b32 s16, 0x7e0000
    buffer_load_dword v71, v2, s[8:11], s16 offen
    v_and_b32 v3, 63, v1
    v_bfe_u32 v4, v1, 6, 2
    v_bfe_u32 v5, v1, 8, 1
    v_bfe_u32 v6, v1, 9, 1
    v_bfe_u32 v7, v1, 10, 1
    v_lshrrev_b32 v72, 11, v1
    v_lshl_add_u32 v72, v72, 1, v7
    v_lshl_add_u32 v72, v72, 1, v5
    v_lshl_add_u32 v72, v72, 6, v3
    v_lshlrev_b32 v72, 4, v72
    v_lshl_add_u32 v4, v6, 2, v4
    v_lshl_add_u32 v72, v4, 1, v72
    s_waitcnt vmcnt(0)
    v_add_f32 v8, v8, v40
    v_add_f32 v9, v9, v41
    v_add_f32 v10, v10, v42
    v_add_f32 v11, v11, v43
    v_add_f32 v12, v12, v44
    v_add_f32 v13, v13, v45
    v_add_f32 v14, v14, v46
    v_add_f32 v15, v15, v47
    v_add_f32 v16, v16, v48
    v_add_f32 v17, v17, v49
    v_add_f32 v18, v18, v50
    v_add_f32 v19, v19, v51
    v_add_f32 v20, v20, v52
    v_add_f32 v21, v21, v53
    v_add_f32 v22, v22, v54
    v_add_f32 v23, v23, v55
    v_add_f32 v24, v24, v56
    v_add_f32 v25, v25, v57
    v_add_f32 v26, v26, v58
    v_add_f32 v27, v27, v59
    v_add_f32 v28, v28, v60
    v_add_f32 v29, v29, v61
    v_add_f32 v30, v30, v62
    v_add_f32 v31, v31, v63
    v_add_f32 v32, v32, v64
    v_add_f32 v33, v33, v65
    v_add_f32 v34, v34, v66
    v_add_f32 v35, v35, v67
    v_add_f32 v36, v36, v68
    v_add_f32 v37, v37, v69
    v_add_f32 v38, v38, v70
    v_add_f32 v39, v39, v71
    v_add_f32 v8, v8, v24
    v_add_f32 v9, v9, v25
    v_add_f32 v10, v10, v26
    v_add_f32 v11, v11, v27
    v_add_f32 v12, v12, v28
    v_add_f32 v13, v13, v29
    v_add_f32 v14, v14, v30
    v_add_f32 v15, v15, v31
    v_add_f32 v16, v16, v32
    v_add_f32 v17, v17, v33
    v_add_f32 v18, v18, v34
    v_add_f32 v19, v19, v35
    v_add_f32 v20, v20, v36
    v_add_f32 v21, v21, v37
    v_add_f32 v22, v22, v38
    v_add_f32 v23, v23, v39
    v_add_f32 v8, v8, v16
    v_add_f32 v9, v9, v17
    v_add_f32 v10, v10, v18
    v_add_f32 v11, v11, v19
    v_add_f32 v12, v12, v20
    v_add_f32 v13, v13, v21
    v_add_f32 v14, v14, v22
    v_add_f32 v15, v15, v23
    v_add_f32 v8, v8, v12
    v_add_f32 v9, v9, v13
    v_add_f32 v10, v10, v14
    v_add_f32 v11, v11, v15
    v_add_f32 v8, v8, v10
    v_add_f32 v9, v9, v11
    v_add_f32 v8, v8, v9
    v_cvt_pk_bf16_f32 v8, v8, v8
    buffer_store_short v8, v72, s[12:15], 0 offen
krl2_kernel_done:
    s_endpgm
.globl k2l2_kernel
.p2align 8
.type k2l2_kernel,@function
k2l2_kernel:
    s_cmp_ge_u32 s2, 256
    s_cbranch_scc1 k2l2_kernel_done
    s_load_dwordx2 s[24:25], s[0:1], 88
    s_load_dwordx2 s[26:27], s[0:1], 0
    v_lshrrev_b32 v9, 6, v0
    v_and_b32 v1, 63, v0
    v_lshlrev_b32 v2, 4, v1
    v_and_b32 v3, 15, v1
    v_lshrrev_b32 v4, 4, v1
    v_readfirstlane_b32 s3, v9
    v_add_u32 v9, 0, v4
    v_xor_b32 v9, v9, v3
    v_lshlrev_b32 v9, 4, v9
    v_lshl_add_u32 v5, v3, 10, v9
    v_add_u32 v9, 4, v4
    v_xor_b32 v9, v9, v3
    v_lshlrev_b32 v9, 4, v9
    v_lshl_add_u32 v6, v3, 10, v9
    v_add_u32 v9, 8, v4
    v_xor_b32 v9, v9, v3
    v_lshlrev_b32 v9, 4, v9
    v_lshl_add_u32 v7, v3, 10, v9
    v_add_u32 v9, 12, v4
    v_xor_b32 v9, v9, v3
    v_lshlrev_b32 v9, 4, v9
    v_lshl_add_u32 v8, v3, 10, v9
    s_and_b32 s28, s2, 7
    s_lshl_b32 s28, s28, 4
    s_lshr_b32 s29, s2, 4
    s_add_u32 s28, s28, s29
    s_lshr_b32 s29, s2, 3
    s_and_b32 s29, s29, 1
    s_lshl_b32 s30, s29, 4
    s_lshl_b32 s31, s3, 2
    s_add_u32 s30, s30, s31
    s_lshl_b32 s31, s30, 10
    s_waitcnt lgkmcnt(0)
    s_add_u32 s4, s24, 0xef8000
    s_addc_u32 s5, s25, 0
    s_mov_b32 s6, 0x1c0000
    s_mov_b32 s7, 0x00020000
    s_add_u32 s8, s24, 0x150000
    s_addc_u32 s9, s25, 0
    s_mov_b32 s10, 0x80000
    s_mov_b32 s11, 0x00020000
    s_add_u32 s12, s24, 0x1278000
    s_addc_u32 s13, s25, 0
    s_mov_b32 s14, 0x400000
    s_mov_b32 s15, 0x00020000
    s_add_u32 s16, s24, 0xd28000
    s_addc_u32 s17, s25, 0
    s_mov_b32 s18, 0x10000
    s_mov_b32 s19, 0x00020000
    s_add_u32 s20, s24, 0x10b8000
    s_addc_u32 s21, s25, 0
    s_mov_b32 s22, 0x1c0000
    s_mov_b32 s23, 0x00020000
    v_lshlrev_b32 v10, 2, v1
    s_lshl_b32 s33, s3, 2
    s_add_u32 s33, s33, 0
    s_lshl_b32 s34, s28, 4
    s_add_u32 s34, s34, s33
    s_lshl_b32 s34, s34, 11
    buffer_load_dwordx4 v[104:107], v2, s[12:15], s34 offen
    buffer_load_dwordx4 v[108:111], v2, s[12:15], s34 offen offset:1024
    s_lshl_b32 s34, s33, 12
    buffer_load_dwordx4 v[112:115], v2, s[16:19], s34 offen offset:0
    buffer_load_dwordx4 v[116:119], v2, s[16:19], s34 offen offset:1024
    buffer_load_dwordx4 v[120:123], v2, s[16:19], s34 offen offset:2048
    buffer_load_dwordx4 v[124:127], v2, s[16:19], s34 offen offset:3072
    s_lshl_b32 s33, s3, 2
    s_add_u32 s33, s33, 1
    s_lshl_b32 s34, s28, 4
    s_add_u32 s34, s34, s33
    s_lshl_b32 s34, s34, 11
    buffer_load_dwordx4 v[128:131], v2, s[12:15], s34 offen
    buffer_load_dwordx4 v[132:135], v2, s[12:15], s34 offen offset:1024
    s_lshl_b32 s34, s33, 12
    buffer_load_dwordx4 v[136:139], v2, s[16:19], s34 offen offset:0
    buffer_load_dwordx4 v[140:143], v2, s[16:19], s34 offen offset:1024
    buffer_load_dwordx4 v[144:147], v2, s[16:19], s34 offen offset:2048
    buffer_load_dwordx4 v[148:151], v2, s[16:19], s34 offen offset:3072
    s_lshl_b32 s33, s3, 2
    s_add_u32 s33, s33, 2
    s_lshl_b32 s34, s28, 4
    s_add_u32 s34, s34, s33
    s_lshl_b32 s34, s34, 11
    buffer_load_dwordx4 v[152:155], v2, s[12:15], s34 offen
    buffer_load_dwordx4 v[156:159], v2, s[12:15], s34 offen offset:1024
    s_lshl_b32 s34, s33, 12
    buffer_load_dwordx4 v[160:163], v2, s[16:19], s34 offen offset:0
    buffer_load_dwordx4 v[164:167], v2, s[16:19], s34 offen offset:1024
    buffer_load_dwordx4 v[168:171], v2, s[16:19], s34 offen offset:2048
    buffer_load_dwordx4 v[172:175], v2, s[16:19], s34 offen offset:3072
    s_lshl_b32 s33, s3, 2
    s_add_u32 s33, s33, 3
    s_lshl_b32 s34, s28, 4
    s_add_u32 s34, s34, s33
    s_lshl_b32 s34, s34, 11
    buffer_load_dwordx4 v[176:179], v2, s[12:15], s34 offen
    buffer_load_dwordx4 v[180:183], v2, s[12:15], s34 offen offset:1024
    s_lshl_b32 s34, s33, 12
    buffer_load_dwordx4 v[184:187], v2, s[16:19], s34 offen offset:0
    buffer_load_dwordx4 v[188:191], v2, s[16:19], s34 offen offset:1024
    buffer_load_dwordx4 v[192:195], v2, s[16:19], s34 offen offset:2048
    buffer_load_dwordx4 v[196:199], v2, s[16:19], s34 offen offset:3072
    s_add_u32 s32, s31, 0x0
    buffer_load_dwordx4 a[0:3], v2, s[8:11], s32 offen offset:0
    buffer_load_dwordx4 a[4:7], v2, s[8:11], s32 offen offset:1024
    buffer_load_dwordx4 a[8:11], v2, s[8:11], s32 offen offset:2048
    buffer_load_dwordx4 a[12:15], v2, s[8:11], s32 offen offset:3072
    s_add_u32 s32, s31, 0x8000
    buffer_load_dwordx4 a[16:19], v2, s[8:11], s32 offen offset:0
    buffer_load_dwordx4 a[20:23], v2, s[8:11], s32 offen offset:1024
    buffer_load_dwordx4 a[24:27], v2, s[8:11], s32 offen offset:2048
    buffer_load_dwordx4 a[28:31], v2, s[8:11], s32 offen offset:3072
    s_add_u32 s32, s31, 0x10000
    buffer_load_dwordx4 a[32:35], v2, s[8:11], s32 offen offset:0
    buffer_load_dwordx4 a[36:39], v2, s[8:11], s32 offen offset:1024
    buffer_load_dwordx4 a[40:43], v2, s[8:11], s32 offen offset:2048
    buffer_load_dwordx4 a[44:47], v2, s[8:11], s32 offen offset:3072
    s_add_u32 s32, s31, 0x18000
    buffer_load_dwordx4 a[48:51], v2, s[8:11], s32 offen offset:0
    buffer_load_dwordx4 a[52:55], v2, s[8:11], s32 offen offset:1024
    buffer_load_dwordx4 a[56:59], v2, s[8:11], s32 offen offset:2048
    buffer_load_dwordx4 a[60:63], v2, s[8:11], s32 offen offset:3072
    s_add_u32 s32, s31, 0x20000
    buffer_load_dwordx4 a[64:67], v2, s[8:11], s32 offen offset:0
    buffer_load_dwordx4 a[68:71], v2, s[8:11], s32 offen offset:1024
    buffer_load_dwordx4 a[72:75], v2, s[8:11], s32 offen offset:2048
    buffer_load_dwordx4 a[76:79], v2, s[8:11], s32 offen offset:3072
    s_add_u32 s32, s31, 0x28000
    buffer_load_dwordx4 a[80:83], v2, s[8:11], s32 offen offset:0
    buffer_load_dwordx4 a[84:87], v2, s[8:11], s32 offen offset:1024
    buffer_load_dwordx4 a[88:91], v2, s[8:11], s32 offen offset:2048
    buffer_load_dwordx4 a[92:95], v2, s[8:11], s32 offen offset:3072
    s_add_u32 s32, s31, 0x30000
    buffer_load_dwordx4 a[96:99], v2, s[8:11], s32 offen offset:0
    buffer_load_dwordx4 a[100:103], v2, s[8:11], s32 offen offset:1024
    buffer_load_dwordx4 a[104:107], v2, s[8:11], s32 offen offset:2048
    buffer_load_dwordx4 a[108:111], v2, s[8:11], s32 offen offset:3072
    s_add_u32 s32, s31, 0x38000
    buffer_load_dwordx4 a[112:115], v2, s[8:11], s32 offen offset:0
    buffer_load_dwordx4 a[116:119], v2, s[8:11], s32 offen offset:1024
    buffer_load_dwordx4 a[120:123], v2, s[8:11], s32 offen offset:2048
    buffer_load_dwordx4 a[124:127], v2, s[8:11], s32 offen offset:3072
    v_lshlrev_b32 v11, 2, v3
    v_add_u32 v11, 192, v11
    s_mov_b32 s36, 0
    s_mov_b32 s37, 0xffff0000
    s_mov_b32 s38, 0x358637bd
    s_waitcnt vmcnt(50)
    v_mfma_f32_16x16x32_bf16 v[200:203], v[112:115], v[104:107], 0
    v_mfma_f32_16x16x32_bf16 v[204:207], v[116:119], v[104:107], 0
    v_mfma_f32_16x16x32_bf16 v[200:203], v[120:123], v[108:111], v[200:203]
    v_mfma_f32_16x16x32_bf16 v[204:207], v[124:127], v[108:111], v[204:207]
    s_nop 7
    s_nop 3
    ds_bpermute_b32 v208, v11, v204
    v_cvt_pk_bf16_f32 v209, v200, v201
    v_lshlrev_b32 v200, 16, v209
    v_and_b32 v201, 0xffff0000, v209
    v_cvt_pk_bf16_f32 v209, v202, v203
    v_lshlrev_b32 v202, 16, v209
    v_and_b32 v203, 0xffff0000, v209
    v_cvt_pk_bf16_f32 v209, v204, v205
    v_lshlrev_b32 v204, 16, v209
    v_and_b32 v205, 0xffff0000, v209
    v_cvt_pk_bf16_f32 v209, v206, v207
    v_lshlrev_b32 v206, 16, v209
    v_and_b32 v207, 0xffff0000, v209
    s_waitcnt lgkmcnt(0)
    v_cvt_pk_bf16_f32 v208, v208, v208
    v_lshlrev_b32 v208, 16, v208
    v_add_f32 v208, s38, v208
    v_cvt_pk_bf16_f32 v208, v208, v208
    v_lshlrev_b32 v208, 16, v208
    v_rcp_f32 v208, v208
    s_nop 0
    v_mul_f32 v200, v200, v208
    v_mul_f32 v201, v201, v208
    v_mul_f32 v202, v202, v208
    v_mul_f32 v203, v203, v208
    v_mul_f32 v204, v204, v208
    v_mul_f32 v205, v205, v208
    v_mul_f32 v206, v206, v208
    v_mul_f32 v207, v207, v208
    v_cvt_pk_bf16_f32 v210, v200, v201
    v_cvt_pk_bf16_f32 v211, v202, v203
    v_cvt_pk_bf16_f32 v212, v204, v205
    v_cvt_pk_bf16_f32 v213, v206, v207
    v_cndmask_b32_e64 v212, v212, 0, s[36:37]
    v_cndmask_b32_e64 v213, v213, 0, s[36:37]
    v_lshrrev_b32 v12, 1, v4
    v_add_u32 v12, 0, v12
    v_xor_b32 v12, v12, v3
    v_lshlrev_b32 v12, 4, v12
    v_lshl_add_u32 v12, v3, 10, v12
    v_and_b32 v13, 1, v4
    v_lshl_add_u32 v12, v13, 3, v12
    s_lshl_b32 s39, s3, 8
    v_add_u32 v12, s39, v12
    ds_write_b64 v12, v[210:211]
    v_lshrrev_b32 v12, 1, v4
    v_add_u32 v12, 2, v12
    v_xor_b32 v12, v12, v3
    v_lshlrev_b32 v12, 4, v12
    v_lshl_add_u32 v12, v3, 10, v12
    v_and_b32 v13, 1, v4
    v_lshl_add_u32 v12, v13, 3, v12
    s_lshl_b32 s39, s3, 8
    v_add_u32 v12, s39, v12
    ds_write_b64 v12, v[212:213]
    s_waitcnt vmcnt(44)
    v_mfma_f32_16x16x32_bf16 v[200:203], v[136:139], v[128:131], 0
    v_mfma_f32_16x16x32_bf16 v[204:207], v[140:143], v[128:131], 0
    v_mfma_f32_16x16x32_bf16 v[200:203], v[144:147], v[132:135], v[200:203]
    v_mfma_f32_16x16x32_bf16 v[204:207], v[148:151], v[132:135], v[204:207]
    s_nop 7
    s_nop 3
    ds_bpermute_b32 v208, v11, v204
    v_cvt_pk_bf16_f32 v209, v200, v201
    v_lshlrev_b32 v200, 16, v209
    v_and_b32 v201, 0xffff0000, v209
    v_cvt_pk_bf16_f32 v209, v202, v203
    v_lshlrev_b32 v202, 16, v209
    v_and_b32 v203, 0xffff0000, v209
    v_cvt_pk_bf16_f32 v209, v204, v205
    v_lshlrev_b32 v204, 16, v209
    v_and_b32 v205, 0xffff0000, v209
    v_cvt_pk_bf16_f32 v209, v206, v207
    v_lshlrev_b32 v206, 16, v209
    v_and_b32 v207, 0xffff0000, v209
    s_waitcnt lgkmcnt(0)
    v_cvt_pk_bf16_f32 v208, v208, v208
    v_lshlrev_b32 v208, 16, v208
    v_add_f32 v208, s38, v208
    v_cvt_pk_bf16_f32 v208, v208, v208
    v_lshlrev_b32 v208, 16, v208
    v_rcp_f32 v208, v208
    s_nop 0
    v_mul_f32 v200, v200, v208
    v_mul_f32 v201, v201, v208
    v_mul_f32 v202, v202, v208
    v_mul_f32 v203, v203, v208
    v_mul_f32 v204, v204, v208
    v_mul_f32 v205, v205, v208
    v_mul_f32 v206, v206, v208
    v_mul_f32 v207, v207, v208
    v_cvt_pk_bf16_f32 v210, v200, v201
    v_cvt_pk_bf16_f32 v211, v202, v203
    v_cvt_pk_bf16_f32 v212, v204, v205
    v_cvt_pk_bf16_f32 v213, v206, v207
    v_cndmask_b32_e64 v212, v212, 0, s[36:37]
    v_cndmask_b32_e64 v213, v213, 0, s[36:37]
    v_lshrrev_b32 v12, 1, v4
    v_add_u32 v12, 4, v12
    v_xor_b32 v12, v12, v3
    v_lshlrev_b32 v12, 4, v12
    v_lshl_add_u32 v12, v3, 10, v12
    v_and_b32 v13, 1, v4
    v_lshl_add_u32 v12, v13, 3, v12
    s_lshl_b32 s39, s3, 8
    v_add_u32 v12, s39, v12
    ds_write_b64 v12, v[210:211]
    v_lshrrev_b32 v12, 1, v4
    v_add_u32 v12, 6, v12
    v_xor_b32 v12, v12, v3
    v_lshlrev_b32 v12, 4, v12
    v_lshl_add_u32 v12, v3, 10, v12
    v_and_b32 v13, 1, v4
    v_lshl_add_u32 v12, v13, 3, v12
    s_lshl_b32 s39, s3, 8
    v_add_u32 v12, s39, v12
    ds_write_b64 v12, v[212:213]
    s_waitcnt vmcnt(38)
    v_mfma_f32_16x16x32_bf16 v[200:203], v[160:163], v[152:155], 0
    v_mfma_f32_16x16x32_bf16 v[204:207], v[164:167], v[152:155], 0
    v_mfma_f32_16x16x32_bf16 v[200:203], v[168:171], v[156:159], v[200:203]
    v_mfma_f32_16x16x32_bf16 v[204:207], v[172:175], v[156:159], v[204:207]
    s_nop 7
    s_nop 3
    ds_bpermute_b32 v208, v11, v204
    v_cvt_pk_bf16_f32 v209, v200, v201
    v_lshlrev_b32 v200, 16, v209
    v_and_b32 v201, 0xffff0000, v209
    v_cvt_pk_bf16_f32 v209, v202, v203
    v_lshlrev_b32 v202, 16, v209
    v_and_b32 v203, 0xffff0000, v209
    v_cvt_pk_bf16_f32 v209, v204, v205
    v_lshlrev_b32 v204, 16, v209
    v_and_b32 v205, 0xffff0000, v209
    v_cvt_pk_bf16_f32 v209, v206, v207
    v_lshlrev_b32 v206, 16, v209
    v_and_b32 v207, 0xffff0000, v209
    s_waitcnt lgkmcnt(0)
    v_cvt_pk_bf16_f32 v208, v208, v208
    v_lshlrev_b32 v208, 16, v208
    v_add_f32 v208, s38, v208
    v_cvt_pk_bf16_f32 v208, v208, v208
    v_lshlrev_b32 v208, 16, v208
    v_rcp_f32 v208, v208
    s_nop 0
    v_mul_f32 v200, v200, v208
    v_mul_f32 v201, v201, v208
    v_mul_f32 v202, v202, v208
    v_mul_f32 v203, v203, v208
    v_mul_f32 v204, v204, v208
    v_mul_f32 v205, v205, v208
    v_mul_f32 v206, v206, v208
    v_mul_f32 v207, v207, v208
    v_cvt_pk_bf16_f32 v210, v200, v201
    v_cvt_pk_bf16_f32 v211, v202, v203
    v_cvt_pk_bf16_f32 v212, v204, v205
    v_cvt_pk_bf16_f32 v213, v206, v207
    v_cndmask_b32_e64 v212, v212, 0, s[36:37]
    v_cndmask_b32_e64 v213, v213, 0, s[36:37]
    v_lshrrev_b32 v12, 1, v4
    v_add_u32 v12, 8, v12
    v_xor_b32 v12, v12, v3
    v_lshlrev_b32 v12, 4, v12
    v_lshl_add_u32 v12, v3, 10, v12
    v_and_b32 v13, 1, v4
    v_lshl_add_u32 v12, v13, 3, v12
    s_lshl_b32 s39, s3, 8
    v_add_u32 v12, s39, v12
    ds_write_b64 v12, v[210:211]
    v_lshrrev_b32 v12, 1, v4
    v_add_u32 v12, 10, v12
    v_xor_b32 v12, v12, v3
    v_lshlrev_b32 v12, 4, v12
    v_lshl_add_u32 v12, v3, 10, v12
    v_and_b32 v13, 1, v4
    v_lshl_add_u32 v12, v13, 3, v12
    s_lshl_b32 s39, s3, 8
    v_add_u32 v12, s39, v12
    ds_write_b64 v12, v[212:213]
    s_waitcnt vmcnt(32)
    v_mfma_f32_16x16x32_bf16 v[200:203], v[184:187], v[176:179], 0
    v_mfma_f32_16x16x32_bf16 v[204:207], v[188:191], v[176:179], 0
    v_mfma_f32_16x16x32_bf16 v[200:203], v[192:195], v[180:183], v[200:203]
    v_mfma_f32_16x16x32_bf16 v[204:207], v[196:199], v[180:183], v[204:207]
    s_nop 7
    s_nop 3
    ds_bpermute_b32 v208, v11, v204
    v_cvt_pk_bf16_f32 v209, v200, v201
    v_lshlrev_b32 v200, 16, v209
    v_and_b32 v201, 0xffff0000, v209
    v_cvt_pk_bf16_f32 v209, v202, v203
    v_lshlrev_b32 v202, 16, v209
    v_and_b32 v203, 0xffff0000, v209
    v_cvt_pk_bf16_f32 v209, v204, v205
    v_lshlrev_b32 v204, 16, v209
    v_and_b32 v205, 0xffff0000, v209
    v_cvt_pk_bf16_f32 v209, v206, v207
    v_lshlrev_b32 v206, 16, v209
    v_and_b32 v207, 0xffff0000, v209
    s_waitcnt lgkmcnt(0)
    v_cvt_pk_bf16_f32 v208, v208, v208
    v_lshlrev_b32 v208, 16, v208
    v_add_f32 v208, s38, v208
    v_cvt_pk_bf16_f32 v208, v208, v208
    v_lshlrev_b32 v208, 16, v208
    v_rcp_f32 v208, v208
    s_nop 0
    v_mul_f32 v200, v200, v208
    v_mul_f32 v201, v201, v208
    v_mul_f32 v202, v202, v208
    v_mul_f32 v203, v203, v208
    v_mul_f32 v204, v204, v208
    v_mul_f32 v205, v205, v208
    v_mul_f32 v206, v206, v208
    v_mul_f32 v207, v207, v208
    v_cvt_pk_bf16_f32 v210, v200, v201
    v_cvt_pk_bf16_f32 v211, v202, v203
    v_cvt_pk_bf16_f32 v212, v204, v205
    v_cvt_pk_bf16_f32 v213, v206, v207
    v_cndmask_b32_e64 v212, v212, 0, s[36:37]
    v_cndmask_b32_e64 v213, v213, 0, s[36:37]
    v_lshrrev_b32 v12, 1, v4
    v_add_u32 v12, 12, v12
    v_xor_b32 v12, v12, v3
    v_lshlrev_b32 v12, 4, v12
    v_lshl_add_u32 v12, v3, 10, v12
    v_and_b32 v13, 1, v4
    v_lshl_add_u32 v12, v13, 3, v12
    s_lshl_b32 s39, s3, 8
    v_add_u32 v12, s39, v12
    ds_write_b64 v12, v[210:211]
    v_lshrrev_b32 v12, 1, v4
    v_add_u32 v12, 14, v12
    v_xor_b32 v12, v12, v3
    v_lshlrev_b32 v12, 4, v12
    v_lshl_add_u32 v12, v3, 10, v12
    v_and_b32 v13, 1, v4
    v_lshl_add_u32 v12, v13, 3, v12
    s_lshl_b32 s39, s3, 8
    v_add_u32 v12, s39, v12
    ds_write_b64 v12, v[212:213]
    s_waitcnt lgkmcnt(0)
    s_barrier
    ds_read_b128 v[96:99], v5 offset:0
    ds_read_b128 v[100:103], v6 offset:0
    s_waitcnt vmcnt(28)
    s_waitcnt lgkmcnt(1)
    v_mfma_f32_16x16x32_bf16 v[16:19], a[0:3], v[96:99], 0
    v_mfma_f32_16x16x32_bf16 v[20:23], a[4:7], v[96:99], 0
    v_mfma_f32_16x16x32_bf16 v[24:27], a[8:11], v[96:99], 0
    v_mfma_f32_16x16x32_bf16 v[28:31], a[12:15], v[96:99], 0
    s_add_u32 s32, s31, 0x40000
    buffer_load_dwordx4 a[0:3], v2, s[8:11], s32 offen offset:0
    buffer_load_dwordx4 a[4:7], v2, s[8:11], s32 offen offset:1024
    buffer_load_dwordx4 a[8:11], v2, s[8:11], s32 offen offset:2048
    buffer_load_dwordx4 a[12:15], v2, s[8:11], s32 offen offset:3072
    ds_read_b128 v[96:99], v7 offset:0
    s_waitcnt vmcnt(28)
    s_waitcnt lgkmcnt(1)
    v_mfma_f32_16x16x32_bf16 v[16:19], a[16:19], v[100:103], v[16:19]
    v_mfma_f32_16x16x32_bf16 v[20:23], a[20:23], v[100:103], v[20:23]
    v_mfma_f32_16x16x32_bf16 v[24:27], a[24:27], v[100:103], v[24:27]
    v_mfma_f32_16x16x32_bf16 v[28:31], a[28:31], v[100:103], v[28:31]
    s_add_u32 s32, s31, 0x48000
    buffer_load_dwordx4 a[16:19], v2, s[8:11], s32 offen offset:0
    buffer_load_dwordx4 a[20:23], v2, s[8:11], s32 offen offset:1024
    buffer_load_dwordx4 a[24:27], v2, s[8:11], s32 offen offset:2048
    buffer_load_dwordx4 a[28:31], v2, s[8:11], s32 offen offset:3072
    ds_read_b128 v[100:103], v8 offset:0
    s_waitcnt vmcnt(28)
    s_waitcnt lgkmcnt(1)
    v_mfma_f32_16x16x32_bf16 v[16:19], a[32:35], v[96:99], v[16:19]
    v_mfma_f32_16x16x32_bf16 v[20:23], a[36:39], v[96:99], v[20:23]
    v_mfma_f32_16x16x32_bf16 v[24:27], a[40:43], v[96:99], v[24:27]
    v_mfma_f32_16x16x32_bf16 v[28:31], a[44:47], v[96:99], v[28:31]
    s_add_u32 s32, s31, 0x50000
    buffer_load_dwordx4 a[32:35], v2, s[8:11], s32 offen offset:0
    buffer_load_dwordx4 a[36:39], v2, s[8:11], s32 offen offset:1024
    buffer_load_dwordx4 a[40:43], v2, s[8:11], s32 offen offset:2048
    buffer_load_dwordx4 a[44:47], v2, s[8:11], s32 offen offset:3072
    ds_read_b128 v[96:99], v5 offset:256
    s_waitcnt vmcnt(28)
    s_waitcnt lgkmcnt(1)
    v_mfma_f32_16x16x32_bf16 v[16:19], a[48:51], v[100:103], v[16:19]
    v_mfma_f32_16x16x32_bf16 v[20:23], a[52:55], v[100:103], v[20:23]
    v_mfma_f32_16x16x32_bf16 v[24:27], a[56:59], v[100:103], v[24:27]
    v_mfma_f32_16x16x32_bf16 v[28:31], a[60:63], v[100:103], v[28:31]
    s_add_u32 s32, s31, 0x58000
    buffer_load_dwordx4 a[48:51], v2, s[8:11], s32 offen offset:0
    buffer_load_dwordx4 a[52:55], v2, s[8:11], s32 offen offset:1024
    buffer_load_dwordx4 a[56:59], v2, s[8:11], s32 offen offset:2048
    buffer_load_dwordx4 a[60:63], v2, s[8:11], s32 offen offset:3072
    ds_read_b128 v[100:103], v6 offset:256
    s_waitcnt vmcnt(28)
    s_waitcnt lgkmcnt(1)
    v_mfma_f32_16x16x32_bf16 v[16:19], a[64:67], v[96:99], v[16:19]
    v_mfma_f32_16x16x32_bf16 v[20:23], a[68:71], v[96:99], v[20:23]
    v_mfma_f32_16x16x32_bf16 v[24:27], a[72:75], v[96:99], v[24:27]
    v_mfma_f32_16x16x32_bf16 v[28:31], a[76:79], v[96:99], v[28:31]
    s_add_u32 s32, s31, 0x60000
    buffer_load_dwordx4 a[64:67], v2, s[8:11], s32 offen offset:0
    buffer_load_dwordx4 a[68:71], v2, s[8:11], s32 offen offset:1024
    buffer_load_dwordx4 a[72:75], v2, s[8:11], s32 offen offset:2048
    buffer_load_dwordx4 a[76:79], v2, s[8:11], s32 offen offset:3072
    ds_read_b128 v[96:99], v7 offset:256
    s_waitcnt vmcnt(28)
    s_waitcnt lgkmcnt(1)
    v_mfma_f32_16x16x32_bf16 v[16:19], a[80:83], v[100:103], v[16:19]
    v_mfma_f32_16x16x32_bf16 v[20:23], a[84:87], v[100:103], v[20:23]
    v_mfma_f32_16x16x32_bf16 v[24:27], a[88:91], v[100:103], v[24:27]
    v_mfma_f32_16x16x32_bf16 v[28:31], a[92:95], v[100:103], v[28:31]
    s_add_u32 s32, s31, 0x68000
    buffer_load_dwordx4 a[80:83], v2, s[8:11], s32 offen offset:0
    buffer_load_dwordx4 a[84:87], v2, s[8:11], s32 offen offset:1024
    buffer_load_dwordx4 a[88:91], v2, s[8:11], s32 offen offset:2048
    buffer_load_dwordx4 a[92:95], v2, s[8:11], s32 offen offset:3072
    ds_read_b128 v[100:103], v8 offset:256
    s_waitcnt vmcnt(28)
    s_waitcnt lgkmcnt(1)
    v_mfma_f32_16x16x32_bf16 v[16:19], a[96:99], v[96:99], v[16:19]
    v_mfma_f32_16x16x32_bf16 v[20:23], a[100:103], v[96:99], v[20:23]
    v_mfma_f32_16x16x32_bf16 v[24:27], a[104:107], v[96:99], v[24:27]
    v_mfma_f32_16x16x32_bf16 v[28:31], a[108:111], v[96:99], v[28:31]
    s_add_u32 s32, s31, 0x70000
    buffer_load_dwordx4 a[96:99], v2, s[8:11], s32 offen offset:0
    buffer_load_dwordx4 a[100:103], v2, s[8:11], s32 offen offset:1024
    buffer_load_dwordx4 a[104:107], v2, s[8:11], s32 offen offset:2048
    buffer_load_dwordx4 a[108:111], v2, s[8:11], s32 offen offset:3072
    ds_read_b128 v[96:99], v5 offset:512
    s_waitcnt vmcnt(28)
    s_waitcnt lgkmcnt(1)
    v_mfma_f32_16x16x32_bf16 v[16:19], a[112:115], v[100:103], v[16:19]
    v_mfma_f32_16x16x32_bf16 v[20:23], a[116:119], v[100:103], v[20:23]
    v_mfma_f32_16x16x32_bf16 v[24:27], a[120:123], v[100:103], v[24:27]
    v_mfma_f32_16x16x32_bf16 v[28:31], a[124:127], v[100:103], v[28:31]
    s_add_u32 s32, s31, 0x78000
    buffer_load_dwordx4 a[112:115], v2, s[8:11], s32 offen offset:0
    buffer_load_dwordx4 a[116:119], v2, s[8:11], s32 offen offset:1024
    buffer_load_dwordx4 a[120:123], v2, s[8:11], s32 offen offset:2048
    buffer_load_dwordx4 a[124:127], v2, s[8:11], s32 offen offset:3072
    ds_read_b128 v[100:103], v6 offset:512
    s_waitcnt vmcnt(28)
    s_waitcnt lgkmcnt(1)
    v_mfma_f32_16x16x32_bf16 v[16:19], a[0:3], v[96:99], v[16:19]
    v_mfma_f32_16x16x32_bf16 v[20:23], a[4:7], v[96:99], v[20:23]
    v_mfma_f32_16x16x32_bf16 v[24:27], a[8:11], v[96:99], v[24:27]
    v_mfma_f32_16x16x32_bf16 v[28:31], a[12:15], v[96:99], v[28:31]
    ds_read_b128 v[96:99], v7 offset:512
    s_waitcnt vmcnt(24)
    s_waitcnt lgkmcnt(1)
    v_mfma_f32_16x16x32_bf16 v[16:19], a[16:19], v[100:103], v[16:19]
    v_mfma_f32_16x16x32_bf16 v[20:23], a[20:23], v[100:103], v[20:23]
    v_mfma_f32_16x16x32_bf16 v[24:27], a[24:27], v[100:103], v[24:27]
    v_mfma_f32_16x16x32_bf16 v[28:31], a[28:31], v[100:103], v[28:31]
    ds_read_b128 v[100:103], v8 offset:512
    s_waitcnt vmcnt(20)
    s_waitcnt lgkmcnt(1)
    v_mfma_f32_16x16x32_bf16 v[16:19], a[32:35], v[96:99], v[16:19]
    v_mfma_f32_16x16x32_bf16 v[20:23], a[36:39], v[96:99], v[20:23]
    v_mfma_f32_16x16x32_bf16 v[24:27], a[40:43], v[96:99], v[24:27]
    v_mfma_f32_16x16x32_bf16 v[28:31], a[44:47], v[96:99], v[28:31]
    ds_read_b128 v[96:99], v5 offset:768
    s_waitcnt vmcnt(16)
    s_waitcnt lgkmcnt(1)
    v_mfma_f32_16x16x32_bf16 v[16:19], a[48:51], v[100:103], v[16:19]
    v_mfma_f32_16x16x32_bf16 v[20:23], a[52:55], v[100:103], v[20:23]
    v_mfma_f32_16x16x32_bf16 v[24:27], a[56:59], v[100:103], v[24:27]
    v_mfma_f32_16x16x32_bf16 v[28:31], a[60:63], v[100:103], v[28:31]
    ds_read_b128 v[100:103], v6 offset:768
    s_waitcnt vmcnt(12)
    s_waitcnt lgkmcnt(1)
    v_mfma_f32_16x16x32_bf16 v[16:19], a[64:67], v[96:99], v[16:19]
    v_mfma_f32_16x16x32_bf16 v[20:23], a[68:71], v[96:99], v[20:23]
    v_mfma_f32_16x16x32_bf16 v[24:27], a[72:75], v[96:99], v[24:27]
    v_mfma_f32_16x16x32_bf16 v[28:31], a[76:79], v[96:99], v[28:31]
    ds_read_b128 v[96:99], v7 offset:768
    s_waitcnt vmcnt(8)
    s_waitcnt lgkmcnt(1)
    v_mfma_f32_16x16x32_bf16 v[16:19], a[80:83], v[100:103], v[16:19]
    v_mfma_f32_16x16x32_bf16 v[20:23], a[84:87], v[100:103], v[20:23]
    v_mfma_f32_16x16x32_bf16 v[24:27], a[88:91], v[100:103], v[24:27]
    v_mfma_f32_16x16x32_bf16 v[28:31], a[92:95], v[100:103], v[28:31]
    ds_read_b128 v[100:103], v8 offset:768
    s_waitcnt vmcnt(4)
    s_waitcnt lgkmcnt(1)
    v_mfma_f32_16x16x32_bf16 v[16:19], a[96:99], v[96:99], v[16:19]
    v_mfma_f32_16x16x32_bf16 v[20:23], a[100:103], v[96:99], v[20:23]
    v_mfma_f32_16x16x32_bf16 v[24:27], a[104:107], v[96:99], v[24:27]
    v_mfma_f32_16x16x32_bf16 v[28:31], a[108:111], v[96:99], v[28:31]
    s_waitcnt vmcnt(0)
    s_waitcnt lgkmcnt(0)
    v_mfma_f32_16x16x32_bf16 v[16:19], a[112:115], v[100:103], v[16:19]
    v_mfma_f32_16x16x32_bf16 v[20:23], a[116:119], v[100:103], v[20:23]
    v_mfma_f32_16x16x32_bf16 v[24:27], a[120:123], v[100:103], v[24:27]
    v_mfma_f32_16x16x32_bf16 v[28:31], a[124:127], v[100:103], v[28:31]
    s_cmp_ge_u32 s30, 28
    s_cbranch_scc1 k2l2_kernel_done
    v_mul_u32_u24 v12, 896, v3
    v_lshl_add_u32 v12, v4, 3, v12
    s_mul_i32 s40, s28, 14336
    s_lshl_b32 s41, s30, 5
    s_add_u32 s40, s40, s41
    buffer_load_dwordx2 v[32:33], v12, s[4:7], s40 offen offset:0
    buffer_load_dwordx2 v[34:35], v12, s[4:7], s40 offen offset:32
    buffer_load_dwordx2 v[36:37], v12, s[4:7], s40 offen offset:64
    buffer_load_dwordx2 v[38:39], v12, s[4:7], s40 offen offset:96
    s_nop 7
    s_waitcnt vmcnt(0)
    v_cvt_pk_bf16_f32 v208, v16, v17
    v_lshlrev_b32 v209, 16, v208
    v_and_b32 v210, 0xffff0000, v208
    v_lshlrev_b32 v211, 16, v32
    v_and_b32 v212, 0xffff0000, v32
    v_add_f32 v209, v209, v211
    v_add_f32 v210, v210, v212
    v_cvt_pk_bf16_f32 v32, v209, v210
    v_cvt_pk_bf16_f32 v208, v18, v19
    v_lshlrev_b32 v209, 16, v208
    v_and_b32 v210, 0xffff0000, v208
    v_lshlrev_b32 v211, 16, v33
    v_and_b32 v212, 0xffff0000, v33
    v_add_f32 v209, v209, v211
    v_add_f32 v210, v210, v212
    v_cvt_pk_bf16_f32 v33, v209, v210
    buffer_store_dwordx2 v[32:33], v12, s[20:23], s40 offen offset:0
    v_cvt_pk_bf16_f32 v208, v20, v21
    v_lshlrev_b32 v209, 16, v208
    v_and_b32 v210, 0xffff0000, v208
    v_lshlrev_b32 v211, 16, v34
    v_and_b32 v212, 0xffff0000, v34
    v_add_f32 v209, v209, v211
    v_add_f32 v210, v210, v212
    v_cvt_pk_bf16_f32 v34, v209, v210
    v_cvt_pk_bf16_f32 v208, v22, v23
    v_lshlrev_b32 v209, 16, v208
    v_and_b32 v210, 0xffff0000, v208
    v_lshlrev_b32 v211, 16, v35
    v_and_b32 v212, 0xffff0000, v35
    v_add_f32 v209, v209, v211
    v_add_f32 v210, v210, v212
    v_cvt_pk_bf16_f32 v35, v209, v210
    buffer_store_dwordx2 v[34:35], v12, s[20:23], s40 offen offset:32
    v_cvt_pk_bf16_f32 v208, v24, v25
    v_lshlrev_b32 v209, 16, v208
    v_and_b32 v210, 0xffff0000, v208
    v_lshlrev_b32 v211, 16, v36
    v_and_b32 v212, 0xffff0000, v36
    v_add_f32 v209, v209, v211
    v_add_f32 v210, v210, v212
    v_cvt_pk_bf16_f32 v36, v209, v210
    v_cvt_pk_bf16_f32 v208, v26, v27
    v_lshlrev_b32 v209, 16, v208
    v_and_b32 v210, 0xffff0000, v208
    v_lshlrev_b32 v211, 16, v37
    v_and_b32 v212, 0xffff0000, v37
    v_add_f32 v209, v209, v211
    v_add_f32 v210, v210, v212
    v_cvt_pk_bf16_f32 v37, v209, v210
    buffer_store_dwordx2 v[36:37], v12, s[20:23], s40 offen offset:64
    v_cvt_pk_bf16_f32 v208, v28, v29
    v_lshlrev_b32 v209, 16, v208
    v_and_b32 v210, 0xffff0000, v208
    v_lshlrev_b32 v211, 16, v38
    v_and_b32 v212, 0xffff0000, v38
    v_add_f32 v209, v209, v211
    v_add_f32 v210, v210, v212
    v_cvt_pk_bf16_f32 v38, v209, v210
    v_cvt_pk_bf16_f32 v208, v30, v31
    v_lshlrev_b32 v209, 16, v208
    v_and_b32 v210, 0xffff0000, v208
    v_lshlrev_b32 v211, 16, v39
    v_and_b32 v212, 0xffff0000, v39
    v_add_f32 v209, v209, v211
    v_add_f32 v210, v210, v212
    v_cvt_pk_bf16_f32 v39, v209, v210
    buffer_store_dwordx2 v[38:39], v12, s[20:23], s40 offen offset:96
k2l2_kernel_done:
    s_endpgm
.globl k3l2_kernel
.p2align 8
.type k3l2_kernel,@function
k3l2_kernel:
    s_cmp_ge_u32 s2, 256
    s_cbranch_scc1 k3l2_kernel_done
    s_load_dwordx2 s[24:25], s[0:1], 88
    s_load_dwordx2 s[26:27], s[0:1], 48
    v_lshrrev_b32 v9, 6, v0
    v_and_b32 v1, 63, v0
    v_lshlrev_b32 v2, 4, v1
    v_and_b32 v3, 15, v1
    v_lshrrev_b32 v4, 4, v1
    v_readfirstlane_b32 s3, v9
    v_add_u32 v9, 0, v4
    v_xor_b32 v9, v9, v3
    v_lshlrev_b32 v9, 4, v9
    v_lshl_add_u32 v5, v3, 10, v9
    v_add_u32 v9, 4, v4
    v_xor_b32 v9, v9, v3
    v_lshlrev_b32 v9, 4, v9
    v_lshl_add_u32 v6, v3, 10, v9
    v_add_u32 v9, 8, v4
    v_xor_b32 v9, v9, v3
    v_lshlrev_b32 v9, 4, v9
    v_lshl_add_u32 v7, v3, 10, v9
    v_add_u32 v9, 12, v4
    v_xor_b32 v9, v9, v3
    v_lshlrev_b32 v9, 4, v9
    v_lshl_add_u32 v8, v3, 10, v9
    s_and_b32 s28, s2, 7
    s_lshl_b32 s28, s28, 3
    s_lshr_b32 s29, s2, 5
    s_add_u32 s28, s28, s29
    s_lshr_b32 s29, s2, 3
    s_and_b32 s29, s29, 3
    s_mul_i32 s29, s29, 28
    s_mul_i32 s35, s3, 7
    s_add_u32 s29, s29, s35
    v_lshlrev_b32 v12, 3, v4
    s_lshl_b32 s36, s29, 5
    v_mul_u32_u24 v13, 3584, v3
    v_lshl_add_u32 v13, v4, 3, v13
    s_mul_i32 s37, s28, 114688
    s_add_u32 s37, s37, s36
    s_add_u32 s38, s37, 57344
    s_waitcnt lgkmcnt(0)
    s_add_u32 s4, s24, 0x10b8000
    s_addc_u32 s5, s25, 0
    s_mov_b32 s6, 0x1c0000
    s_mov_b32 s7, 0x00020000
    s_add_u32 s8, s24, 0x1d0000
    s_addc_u32 s9, s25, 0
    s_mov_b32 s10, 0x188000
    s_mov_b32 s11, 0x00020000
    s_mov_b32 s12, s26
    s_mov_b32 s13, s27
    s_mov_b32 s14, 0xe00
    s_mov_b32 s15, 0x00020000
    s_add_u32 s16, s24, 0x1678000
    s_addc_u32 s17, s25, 0
    s_mov_b32 s18, 0x700000
    s_mov_b32 s19, 0x00020000
    s_mul_i32 s30, s28, 28672
    s_lshl_b32 s31, s29, 10
    v_lshrrev_b32 v9, 3, v0
    v_mul_u32_u24 v9, 896, v9
    v_and_b32 v10, 7, v0
    v_lshl_add_u32 v10, v10, 4, v9
    buffer_load_dwordx4 v[88:91], v10, s[4:7], s30 offen offset:0
    buffer_load_dwordx4 v[92:95], v10, s[4:7], s30 offen offset:128
    buffer_load_dwordx4 v[96:99], v10, s[4:7], s30 offen offset:256
    buffer_load_dwordx4 v[100:103], v10, s[4:7], s30 offen offset:384
    buffer_load_dwordx4 v[104:107], v10, s[4:7], s30 offen offset:512
    buffer_load_dwordx4 v[108:111], v10, s[4:7], s30 offen offset:640
    buffer_load_dwordx4 v[112:115], v10, s[4:7], s30 offen offset:768
    buffer_load_dwordx2 v[140:141], v12, s[12:15], s36 offen offset:0
    buffer_load_dwordx2 v[142:143], v12, s[12:15], s36 offen offset:32
    buffer_load_dwordx2 v[144:145], v12, s[12:15], s36 offen offset:64
    buffer_load_dwordx2 v[146:147], v12, s[12:15], s36 offen offset:96
    buffer_load_dwordx2 v[148:149], v12, s[12:15], s36 offen offset:128
    buffer_load_dwordx2 v[150:151], v12, s[12:15], s36 offen offset:160
    buffer_load_dwordx2 v[152:153], v12, s[12:15], s36 offen offset:192
    s_add_u32 s33, s31, 0x0
    buffer_load_dwordx4 a[0:3], v2, s[8:11], s33 offen offset:0
    buffer_load_dwordx4 a[4:7], v2, s[8:11], s33 offen offset:1024
    buffer_load_dwordx4 a[8:11], v2, s[8:11], s33 offen offset:2048
    buffer_load_dwordx4 a[12:15], v2, s[8:11], s33 offen offset:3072
    s_add_u32 s33, s31, 0x1000
    buffer_load_dwordx4 a[16:19], v2, s[8:11], s33 offen offset:0
    buffer_load_dwordx4 a[20:23], v2, s[8:11], s33 offen offset:1024
    buffer_load_dwordx4 a[24:27], v2, s[8:11], s33 offen offset:2048
    s_add_u32 s33, s31, 0x1c000
    buffer_load_dwordx4 a[28:31], v2, s[8:11], s33 offen offset:0
    buffer_load_dwordx4 a[32:35], v2, s[8:11], s33 offen offset:1024
    buffer_load_dwordx4 a[36:39], v2, s[8:11], s33 offen offset:2048
    buffer_load_dwordx4 a[40:43], v2, s[8:11], s33 offen offset:3072
    s_add_u32 s33, s31, 0x1d000
    buffer_load_dwordx4 a[44:47], v2, s[8:11], s33 offen offset:0
    buffer_load_dwordx4 a[48:51], v2, s[8:11], s33 offen offset:1024
    buffer_load_dwordx4 a[52:55], v2, s[8:11], s33 offen offset:2048
    s_add_u32 s33, s31, 0x38000
    buffer_load_dwordx4 a[56:59], v2, s[8:11], s33 offen offset:0
    buffer_load_dwordx4 a[60:63], v2, s[8:11], s33 offen offset:1024
    buffer_load_dwordx4 a[64:67], v2, s[8:11], s33 offen offset:2048
    buffer_load_dwordx4 a[68:71], v2, s[8:11], s33 offen offset:3072
    s_add_u32 s33, s31, 0x39000
    buffer_load_dwordx4 a[72:75], v2, s[8:11], s33 offen offset:0
    buffer_load_dwordx4 a[76:79], v2, s[8:11], s33 offen offset:1024
    buffer_load_dwordx4 a[80:83], v2, s[8:11], s33 offen offset:2048
    s_add_u32 s33, s31, 0x54000
    buffer_load_dwordx4 a[84:87], v2, s[8:11], s33 offen offset:0
    buffer_load_dwordx4 a[88:91], v2, s[8:11], s33 offen offset:1024
    buffer_load_dwordx4 a[92:95], v2, s[8:11], s33 offen offset:2048
    buffer_load_dwordx4 a[96:99], v2, s[8:11], s33 offen offset:3072
    s_add_u32 s33, s31, 0x55000
    buffer_load_dwordx4 a[100:103], v2, s[8:11], s33 offen offset:0
    buffer_load_dwordx4 a[104:107], v2, s[8:11], s33 offen offset:1024
    buffer_load_dwordx4 a[108:111], v2, s[8:11], s33 offen offset:2048
    s_add_u32 s33, s31, 0x70000
    buffer_load_dwordx4 a[112:115], v2, s[8:11], s33 offen offset:0
    buffer_load_dwordx4 a[116:119], v2, s[8:11], s33 offen offset:1024
    buffer_load_dwordx4 a[120:123], v2, s[8:11], s33 offen offset:2048
    buffer_load_dwordx4 a[124:127], v2, s[8:11], s33 offen offset:3072
    s_add_u32 s33, s31, 0x71000
    buffer_load_dwordx4 a[128:131], v2, s[8:11], s33 offen offset:0
    buffer_load_dwordx4 a[132:135], v2, s[8:11], s33 offen offset:1024
    buffer_load_dwordx4 a[136:139], v2, s[8:11], s33 offen offset:2048
    s_add_u32 s33, s31, 0x8c000
    buffer_load_dwordx4 a[140:143], v2, s[8:11], s33 offen offset:0
    buffer_load_dwordx4 a[144:147], v2, s[8:11], s33 offen offset:1024
    buffer_load_dwordx4 a[148:151], v2, s[8:11], s33 offen offset:2048
    buffer_load_dwordx4 a[152:155], v2, s[8:11], s33 offen offset:3072
    s_add_u32 s33, s31, 0x8d000
    buffer_load_dwordx4 a[156:159], v2, s[8:11], s33 offen offset:0
    buffer_load_dwordx4 a[160:163], v2, s[8:11], s33 offen offset:1024
    buffer_load_dwordx4 a[164:167], v2, s[8:11], s33 offen offset:2048
    s_add_u32 s33, s31, 0xa8000
    buffer_load_dwordx4 a[168:171], v2, s[8:11], s33 offen offset:0
    buffer_load_dwordx4 a[172:175], v2, s[8:11], s33 offen offset:1024
    buffer_load_dwordx4 a[176:179], v2, s[8:11], s33 offen offset:2048
    buffer_load_dwordx4 a[180:183], v2, s[8:11], s33 offen offset:3072
    s_add_u32 s33, s31, 0xa9000
    buffer_load_dwordx4 a[184:187], v2, s[8:11], s33 offen offset:0
    buffer_load_dwordx4 a[188:191], v2, s[8:11], s33 offen offset:1024
    buffer_load_dwordx4 a[192:195], v2, s[8:11], s33 offen offset:2048
    s_add_u32 s33, s31, 0xc4000
    buffer_load_dwordx4 a[196:199], v2, s[8:11], s33 offen offset:0
    buffer_load_dwordx4 a[200:203], v2, s[8:11], s33 offen offset:1024
    buffer_load_dwordx4 a[204:207], v2, s[8:11], s33 offen offset:2048
    buffer_load_dwordx4 a[208:211], v2, s[8:11], s33 offen offset:3072
    s_add_u32 s33, s31, 0xc5000
    buffer_load_dwordx4 a[212:215], v2, s[8:11], s33 offen offset:0
    buffer_load_dwordx4 a[216:219], v2, s[8:11], s33 offen offset:1024
    buffer_load_dwordx4 a[220:223], v2, s[8:11], s33 offen offset:2048
    s_waitcnt vmcnt(63)
    s_mov_b32 s34, 0x3f803f80
    v_mov_b32 v116, 0
    v_mov_b32 v117, 0
    v_mov_b32 v118, 0
    v_mov_b32 v119, 0
    v_dot2_f32_bf16 v116, v88, s34, v116
    v_dot2_f32_bf16 v118, v88, v88, v118
    v_dot2_f32_bf16 v117, v89, s34, v117
    v_dot2_f32_bf16 v119, v89, v89, v119
    v_dot2_f32_bf16 v116, v90, s34, v116
    v_dot2_f32_bf16 v118, v90, v90, v118
    v_dot2_f32_bf16 v117, v91, s34, v117
    v_dot2_f32_bf16 v119, v91, v91, v119
    v_dot2_f32_bf16 v116, v92, s34, v116
    v_dot2_f32_bf16 v118, v92, v92, v118
    v_dot2_f32_bf16 v117, v93, s34, v117
    v_dot2_f32_bf16 v119, v93, v93, v119
    v_dot2_f32_bf16 v116, v94, s34, v116
    v_dot2_f32_bf16 v118, v94, v94, v118
    v_dot2_f32_bf16 v117, v95, s34, v117
    v_dot2_f32_bf16 v119, v95, v95, v119
    v_dot2_f32_bf16 v116, v96, s34, v116
    v_dot2_f32_bf16 v118, v96, v96, v118
    v_dot2_f32_bf16 v117, v97, s34, v117
    v_dot2_f32_bf16 v119, v97, v97, v119
    v_dot2_f32_bf16 v116, v98, s34, v116
    v_dot2_f32_bf16 v118, v98, v98, v118
    v_dot2_f32_bf16 v117, v99, s34, v117
    v_dot2_f32_bf16 v119, v99, v99, v119
    v_dot2_f32_bf16 v116, v100, s34, v116
    v_dot2_f32_bf16 v118, v100, v100, v118
    v_dot2_f32_bf16 v117, v101, s34, v117
    v_dot2_f32_bf16 v119, v101, v101, v119
    v_dot2_f32_bf16 v116, v102, s34, v116
    v_dot2_f32_bf16 v118, v102, v102, v118
    v_dot2_f32_bf16 v117, v103, s34, v117
    v_dot2_f32_bf16 v119, v103, v103, v119
    v_dot2_f32_bf16 v116, v104, s34, v116
    v_dot2_f32_bf16 v118, v104, v104, v118
    v_dot2_f32_bf16 v117, v105, s34, v117
    v_dot2_f32_bf16 v119, v105, v105, v119
    v_dot2_f32_bf16 v116, v106, s34, v116
    v_dot2_f32_bf16 v118, v106, v106, v118
    v_dot2_f32_bf16 v117, v107, s34, v117
    v_dot2_f32_bf16 v119, v107, v107, v119
    v_dot2_f32_bf16 v116, v108, s34, v116
    v_dot2_f32_bf16 v118, v108, v108, v118
    v_dot2_f32_bf16 v117, v109, s34, v117
    v_dot2_f32_bf16 v119, v109, v109, v119
    v_dot2_f32_bf16 v116, v110, s34, v116
    v_dot2_f32_bf16 v118, v110, v110, v118
    v_dot2_f32_bf16 v117, v111, s34, v117
    v_dot2_f32_bf16 v119, v111, v111, v119
    v_dot2_f32_bf16 v116, v112, s34, v116
    v_dot2_f32_bf16 v118, v112, v112, v118
    v_dot2_f32_bf16 v117, v113, s34, v117
    v_dot2_f32_bf16 v119, v113, v113, v119
    v_dot2_f32_bf16 v116, v114, s34, v116
    v_dot2_f32_bf16 v118, v114, v114, v118
    v_dot2_f32_bf16 v117, v115, s34, v117
    v_dot2_f32_bf16 v119, v115, v115, v119
    s_nop 3
    v_add_f32 v116, v116, v117
    v_add_f32 v118, v118, v119
    s_nop 1
    v_add_f32_dpp v117, v116, v116 quad_perm:[1,0,3,2] row_mask:0xf bank_mask:0xf
    v_add_f32_dpp v119, v118, v118 quad_perm:[1,0,3,2] row_mask:0xf bank_mask:0xf
    v_mov_b32 v116, v117
    v_mov_b32 v118, v119
    s_nop 1
    v_add_f32_dpp v117, v116, v116 quad_perm:[2,3,0,1] row_mask:0xf bank_mask:0xf
    v_add_f32_dpp v119, v118, v118 quad_perm:[2,3,0,1] row_mask:0xf bank_mask:0xf
    v_mov_b32 v116, v117
    v_mov_b32 v118, v119
    s_nop 1
    v_add_f32_dpp v117, v116, v116 row_half_mirror row_mask:0xf bank_mask:0xf
    v_add_f32_dpp v119, v118, v118 row_half_mirror row_mask:0xf bank_mask:0xf
    v_mov_b32 v116, v117
    v_mov_b32 v118, v119
    s_mov_b32 s34, 0x3b124925
    v_mul_f32 v120, s34, v116
    v_mul_f32 v121, s34, v118
    v_fma_f32 v121, -v120, v120, v121
    v_max_f32 v121, 0, v121
    v_cvt_pk_bf16_f32 v122, v120, v121
    v_lshlrev_b32 v124, 16, v122
    v_sub_f32 v124, 0, v124
    v_mov_b32 v125, v124
    v_and_b32 v121, 0xffff0000, v122
    s_mov_b32 s34, 0x3727c5ac
    v_add_f32 v121, s34, v121
    v_cvt_pk_bf16_f32 v122, v121, v121
    v_lshlrev_b32 v121, 16, v122
    v_sqrt_f32 v121, v121
    s_nop 0
    v_cvt_pk_bf16_f32 v122, v121, v121
    v_lshlrev_b32 v121, 16, v122
    v_rcp_f32 v126, v121
    s_nop 0
    v_mov_b32 v127, v126
    v_lshlrev_b32 v128, 16, v88
    v_and_b32 v129, 0xffff0000, v88
    v_lshlrev_b32 v130, 16, v89
    v_and_b32 v131, 0xffff0000, v89
    v_lshlrev_b32 v132, 16, v90
    v_and_b32 v133, 0xffff0000, v90
    v_lshlrev_b32 v134, 16, v91
    v_and_b32 v135, 0xffff0000, v91
    v_pk_add_f32 v[128:129], v[128:129], v[124:125]
    v_pk_add_f32 v[130:131], v[130:131], v[124:125]
    v_pk_add_f32 v[132:133], v[132:133], v[124:125]
    v_pk_add_f32 v[134:135], v[134:135], v[124:125]
    v_cvt_pk_bf16_f32 v88, v128, v129
    v_cvt_pk_bf16_f32 v89, v130, v131
    v_cvt_pk_bf16_f32 v90, v132, v133
    v_cvt_pk_bf16_f32 v91, v134, v135
    v_lshlrev_b32 v128, 16, v88
    v_and_b32 v129, 0xffff0000, v88
    v_lshlrev_b32 v130, 16, v89
    v_and_b32 v131, 0xffff0000, v89
    v_lshlrev_b32 v132, 16, v90
    v_and_b32 v133, 0xffff0000, v90
    v_lshlrev_b32 v134, 16, v91
    v_and_b32 v135, 0xffff0000, v91
    v_pk_mul_f32 v[128:129], v[128:129], v[126:127]
    v_pk_mul_f32 v[130:131], v[130:131], v[126:127]
    v_pk_mul_f32 v[132:133], v[132:133], v[126:127]
    v_pk_mul_f32 v[134:135], v[134:135], v[126:127]
    v_cvt_pk_bf16_f32 v88, v128, v129
    v_cvt_pk_bf16_f32 v89, v130, v131
    v_cvt_pk_bf16_f32 v90, v132, v133
    v_cvt_pk_bf16_f32 v91, v134, v135
    v_lshlrev_b32 v128, 16, v92
    v_and_b32 v129, 0xffff0000, v92
    v_lshlrev_b32 v130, 16, v93
    v_and_b32 v131, 0xffff0000, v93
    v_lshlrev_b32 v132, 16, v94
    v_and_b32 v133, 0xffff0000, v94
    v_lshlrev_b32 v134, 16, v95
    v_and_b32 v135, 0xffff0000, v95
    v_pk_add_f32 v[128:129], v[128:129], v[124:125]
    v_pk_add_f32 v[130:131], v[130:131], v[124:125]
    v_pk_add_f32 v[132:133], v[132:133], v[124:125]
    v_pk_add_f32 v[134:135], v[134:135], v[124:125]
    v_cvt_pk_bf16_f32 v92, v128, v129
    v_cvt_pk_bf16_f32 v93, v130, v131
    v_cvt_pk_bf16_f32 v94, v132, v133
    v_cvt_pk_bf16_f32 v95, v134, v135
    v_lshlrev_b32 v128, 16, v92
    v_and_b32 v129, 0xffff0000, v92
    v_lshlrev_b32 v130, 16, v93
    v_and_b32 v131, 0xffff0000, v93
    v_lshlrev_b32 v132, 16, v94
    v_and_b32 v133, 0xffff0000, v94
    v_lshlrev_b32 v134, 16, v95
    v_and_b32 v135, 0xffff0000, v95
    v_pk_mul_f32 v[128:129], v[128:129], v[126:127]
    v_pk_mul_f32 v[130:131], v[130:131], v[126:127]
    v_pk_mul_f32 v[132:133], v[132:133], v[126:127]
    v_pk_mul_f32 v[134:135], v[134:135], v[126:127]
    v_cvt_pk_bf16_f32 v92, v128, v129
    v_cvt_pk_bf16_f32 v93, v130, v131
    v_cvt_pk_bf16_f32 v94, v132, v133
    v_cvt_pk_bf16_f32 v95, v134, v135
    v_lshlrev_b32 v128, 16, v96
    v_and_b32 v129, 0xffff0000, v96
    v_lshlrev_b32 v130, 16, v97
    v_and_b32 v131, 0xffff0000, v97
    v_lshlrev_b32 v132, 16, v98
    v_and_b32 v133, 0xffff0000, v98
    v_lshlrev_b32 v134, 16, v99
    v_and_b32 v135, 0xffff0000, v99
    v_pk_add_f32 v[128:129], v[128:129], v[124:125]
    v_pk_add_f32 v[130:131], v[130:131], v[124:125]
    v_pk_add_f32 v[132:133], v[132:133], v[124:125]
    v_pk_add_f32 v[134:135], v[134:135], v[124:125]
    v_cvt_pk_bf16_f32 v96, v128, v129
    v_cvt_pk_bf16_f32 v97, v130, v131
    v_cvt_pk_bf16_f32 v98, v132, v133
    v_cvt_pk_bf16_f32 v99, v134, v135
    v_lshlrev_b32 v128, 16, v96
    v_and_b32 v129, 0xffff0000, v96
    v_lshlrev_b32 v130, 16, v97
    v_and_b32 v131, 0xffff0000, v97
    v_lshlrev_b32 v132, 16, v98
    v_and_b32 v133, 0xffff0000, v98
    v_lshlrev_b32 v134, 16, v99
    v_and_b32 v135, 0xffff0000, v99
    v_pk_mul_f32 v[128:129], v[128:129], v[126:127]
    v_pk_mul_f32 v[130:131], v[130:131], v[126:127]
    v_pk_mul_f32 v[132:133], v[132:133], v[126:127]
    v_pk_mul_f32 v[134:135], v[134:135], v[126:127]
    v_cvt_pk_bf16_f32 v96, v128, v129
    v_cvt_pk_bf16_f32 v97, v130, v131
    v_cvt_pk_bf16_f32 v98, v132, v133
    v_cvt_pk_bf16_f32 v99, v134, v135
    v_lshlrev_b32 v128, 16, v100
    v_and_b32 v129, 0xffff0000, v100
    v_lshlrev_b32 v130, 16, v101
    v_and_b32 v131, 0xffff0000, v101
    v_lshlrev_b32 v132, 16, v102
    v_and_b32 v133, 0xffff0000, v102
    v_lshlrev_b32 v134, 16, v103
    v_and_b32 v135, 0xffff0000, v103
    v_pk_add_f32 v[128:129], v[128:129], v[124:125]
    v_pk_add_f32 v[130:131], v[130:131], v[124:125]
    v_pk_add_f32 v[132:133], v[132:133], v[124:125]
    v_pk_add_f32 v[134:135], v[134:135], v[124:125]
    v_cvt_pk_bf16_f32 v100, v128, v129
    v_cvt_pk_bf16_f32 v101, v130, v131
    v_cvt_pk_bf16_f32 v102, v132, v133
    v_cvt_pk_bf16_f32 v103, v134, v135
    v_lshlrev_b32 v128, 16, v100
    v_and_b32 v129, 0xffff0000, v100
    v_lshlrev_b32 v130, 16, v101
    v_and_b32 v131, 0xffff0000, v101
    v_lshlrev_b32 v132, 16, v102
    v_and_b32 v133, 0xffff0000, v102
    v_lshlrev_b32 v134, 16, v103
    v_and_b32 v135, 0xffff0000, v103
    v_pk_mul_f32 v[128:129], v[128:129], v[126:127]
    v_pk_mul_f32 v[130:131], v[130:131], v[126:127]
    v_pk_mul_f32 v[132:133], v[132:133], v[126:127]
    v_pk_mul_f32 v[134:135], v[134:135], v[126:127]
    v_cvt_pk_bf16_f32 v100, v128, v129
    v_cvt_pk_bf16_f32 v101, v130, v131
    v_cvt_pk_bf16_f32 v102, v132, v133
    v_cvt_pk_bf16_f32 v103, v134, v135
    v_lshlrev_b32 v128, 16, v104
    v_and_b32 v129, 0xffff0000, v104
    v_lshlrev_b32 v130, 16, v105
    v_and_b32 v131, 0xffff0000, v105
    v_lshlrev_b32 v132, 16, v106
    v_and_b32 v133, 0xffff0000, v106
    v_lshlrev_b32 v134, 16, v107
    v_and_b32 v135, 0xffff0000, v107
    v_pk_add_f32 v[128:129], v[128:129], v[124:125]
    v_pk_add_f32 v[130:131], v[130:131], v[124:125]
    v_pk_add_f32 v[132:133], v[132:133], v[124:125]
    v_pk_add_f32 v[134:135], v[134:135], v[124:125]
    v_cvt_pk_bf16_f32 v104, v128, v129
    v_cvt_pk_bf16_f32 v105, v130, v131
    v_cvt_pk_bf16_f32 v106, v132, v133
    v_cvt_pk_bf16_f32 v107, v134, v135
    v_lshlrev_b32 v128, 16, v104
    v_and_b32 v129, 0xffff0000, v104
    v_lshlrev_b32 v130, 16, v105
    v_and_b32 v131, 0xffff0000, v105
    v_lshlrev_b32 v132, 16, v106
    v_and_b32 v133, 0xffff0000, v106
    v_lshlrev_b32 v134, 16, v107
    v_and_b32 v135, 0xffff0000, v107
    v_pk_mul_f32 v[128:129], v[128:129], v[126:127]
    v_pk_mul_f32 v[130:131], v[130:131], v[126:127]
    v_pk_mul_f32 v[132:133], v[132:133], v[126:127]
    v_pk_mul_f32 v[134:135], v[134:135], v[126:127]
    v_cvt_pk_bf16_f32 v104, v128, v129
    v_cvt_pk_bf16_f32 v105, v130, v131
    v_cvt_pk_bf16_f32 v106, v132, v133
    v_cvt_pk_bf16_f32 v107, v134, v135
    v_lshlrev_b32 v128, 16, v108
    v_and_b32 v129, 0xffff0000, v108
    v_lshlrev_b32 v130, 16, v109
    v_and_b32 v131, 0xffff0000, v109
    v_lshlrev_b32 v132, 16, v110
    v_and_b32 v133, 0xffff0000, v110
    v_lshlrev_b32 v134, 16, v111
    v_and_b32 v135, 0xffff0000, v111
    v_pk_add_f32 v[128:129], v[128:129], v[124:125]
    v_pk_add_f32 v[130:131], v[130:131], v[124:125]
    v_pk_add_f32 v[132:133], v[132:133], v[124:125]
    v_pk_add_f32 v[134:135], v[134:135], v[124:125]
    v_cvt_pk_bf16_f32 v108, v128, v129
    v_cvt_pk_bf16_f32 v109, v130, v131
    v_cvt_pk_bf16_f32 v110, v132, v133
    v_cvt_pk_bf16_f32 v111, v134, v135
    v_lshlrev_b32 v128, 16, v108
    v_and_b32 v129, 0xffff0000, v108
    v_lshlrev_b32 v130, 16, v109
    v_and_b32 v131, 0xffff0000, v109
    v_lshlrev_b32 v132, 16, v110
    v_and_b32 v133, 0xffff0000, v110
    v_lshlrev_b32 v134, 16, v111
    v_and_b32 v135, 0xffff0000, v111
    v_pk_mul_f32 v[128:129], v[128:129], v[126:127]
    v_pk_mul_f32 v[130:131], v[130:131], v[126:127]
    v_pk_mul_f32 v[132:133], v[132:133], v[126:127]
    v_pk_mul_f32 v[134:135], v[134:135], v[126:127]
    v_cvt_pk_bf16_f32 v108, v128, v129
    v_cvt_pk_bf16_f32 v109, v130, v131
    v_cvt_pk_bf16_f32 v110, v132, v133
    v_cvt_pk_bf16_f32 v111, v134, v135
    v_lshlrev_b32 v128, 16, v112
    v_and_b32 v129, 0xffff0000, v112
    v_lshlrev_b32 v130, 16, v113
    v_and_b32 v131, 0xffff0000, v113
    v_lshlrev_b32 v132, 16, v114
    v_and_b32 v133, 0xffff0000, v114
    v_lshlrev_b32 v134, 16, v115
    v_and_b32 v135, 0xffff0000, v115
    v_pk_add_f32 v[128:129], v[128:129], v[124:125]
    v_pk_add_f32 v[130:131], v[130:131], v[124:125]
    v_pk_add_f32 v[132:133], v[132:133], v[124:125]
    v_pk_add_f32 v[134:135], v[134:135], v[124:125]
    v_cvt_pk_bf16_f32 v112, v128, v129
    v_cvt_pk_bf16_f32 v113, v130, v131
    v_cvt_pk_bf16_f32 v114, v132, v133
    v_cvt_pk_bf16_f32 v115, v134, v135
    v_lshlrev_b32 v128, 16, v112
    v_and_b32 v129, 0xffff0000, v112
    v_lshlrev_b32 v130, 16, v113
    v_and_b32 v131, 0xffff0000, v113
    v_lshlrev_b32 v132, 16, v114
    v_and_b32 v133, 0xffff0000, v114
    v_lshlrev_b32 v134, 16, v115
    v_and_b32 v135, 0xffff0000, v115
    v_pk_mul_f32 v[128:129], v[128:129], v[126:127]
    v_pk_mul_f32 v[130:131], v[130:131], v[126:127]
    v_pk_mul_f32 v[132:133], v[132:133], v[126:127]
    v_pk_mul_f32 v[134:135], v[134:135], v[126:127]
    v_cvt_pk_bf16_f32 v112, v128, v129
    v_cvt_pk_bf16_f32 v113, v130, v131
    v_cvt_pk_bf16_f32 v114, v132, v133
    v_cvt_pk_bf16_f32 v115, v134, v135
    v_lshrrev_b32 v116, 3, v0
    v_and_b32 v117, 7, v0
    v_and_b32 v118, 15, v116
    v_xor_b32 v119, v117, v118
    v_lshlrev_b32 v119, 4, v119
    v_add_u32 v117, 8, v117
    v_xor_b32 v118, v117, v118
    v_lshlrev_b32 v118, 4, v118
    v_lshlrev_b32 v116, 10, v116
    v_add_u32 v119, v119, v116
    v_add_u32 v118, v118, v116
    ds_write_b128 v119, v[88:91] offset:0
    ds_write_b128 v118, v[92:95] offset:0
    ds_write_b128 v119, v[96:99] offset:256
    ds_write_b128 v118, v[100:103] offset:256
    ds_write_b128 v119, v[104:107] offset:512
    ds_write_b128 v118, v[108:111] offset:512
    ds_write_b128 v119, v[112:115] offset:768
    s_waitcnt lgkmcnt(0)
    s_barrier
    ds_read_b128 v[72:75], v5 offset:0
    ds_read_b128 v[76:79], v5 offset:16384
    ds_read_b128 v[80:83], v6 offset:0
    ds_read_b128 v[84:87], v6 offset:16384
    s_waitcnt vmcnt(49)
    s_waitcnt lgkmcnt(2)
    v_mfma_f32_16x16x32_bf16 v[16:19], a[0:3], v[72:75], 0
    v_mfma_f32_16x16x32_bf16 v[20:23], a[0:3], v[76:79], 0
    v_mfma_f32_16x16x32_bf16 v[24:27], a[4:7], v[72:75], 0
    v_mfma_f32_16x16x32_bf16 v[28:31], a[4:7], v[76:79], 0
    v_mfma_f32_16x16x32_bf16 v[32:35], a[8:11], v[72:75], 0
    v_mfma_f32_16x16x32_bf16 v[36:39], a[8:11], v[76:79], 0
    v_mfma_f32_16x16x32_bf16 v[40:43], a[12:15], v[72:75], 0
    v_mfma_f32_16x16x32_bf16 v[44:47], a[12:15], v[76:79], 0
    v_mfma_f32_16x16x32_bf16 v[48:51], a[16:19], v[72:75], 0
    v_mfma_f32_16x16x32_bf16 v[52:55], a[16:19], v[76:79], 0
    v_mfma_f32_16x16x32_bf16 v[56:59], a[20:23], v[72:75], 0
    v_mfma_f32_16x16x32_bf16 v[60:63], a[20:23], v[76:79], 0
    v_mfma_f32_16x16x32_bf16 v[64:67], a[24:27], v[72:75], 0
    v_mfma_f32_16x16x32_bf16 v[68:71], a[24:27], v[76:79], 0
    s_add_u32 s33, s31, 0xe0000
    buffer_load_dwordx4 a[0:3], v2, s[8:11], s33 offen offset:0
    buffer_load_dwordx4 a[4:7], v2, s[8:11], s33 offen offset:1024
    buffer_load_dwordx4 a[8:11], v2, s[8:11], s33 offen offset:2048
    buffer_load_dwordx4 a[12:15], v2, s[8:11], s33 offen offset:3072
    s_add_u32 s33, s31, 0xe1000
    buffer_load_dwordx4 a[16:19], v2, s[8:11], s33 offen offset:0
    buffer_load_dwordx4 a[20:23], v2, s[8:11], s33 offen offset:1024
    buffer_load_dwordx4 a[24:27], v2, s[8:11], s33 offen offset:2048
    ds_read_b128 v[72:75], v7 offset:0
    ds_read_b128 v[76:79], v7 offset:16384
    s_waitcnt vmcnt(49)
    s_waitcnt lgkmcnt(2)
    v_mfma_f32_16x16x32_bf16 v[16:19], a[28:31], v[80:83], v[16:19]
    v_mfma_f32_16x16x32_bf16 v[20:23], a[28:31], v[84:87], v[20:23]
    v_mfma_f32_16x16x32_bf16 v[24:27], a[32:35], v[80:83], v[24:27]
    v_mfma_f32_16x16x32_bf16 v[28:31], a[32:35], v[84:87], v[28:31]
    v_mfma_f32_16x16x32_bf16 v[32:35], a[36:39], v[80:83], v[32:35]
    v_mfma_f32_16x16x32_bf16 v[36:39], a[36:39], v[84:87], v[36:39]
    v_mfma_f32_16x16x32_bf16 v[40:43], a[40:43], v[80:83], v[40:43]
    v_mfma_f32_16x16x32_bf16 v[44:47], a[40:43], v[84:87], v[44:47]
    v_mfma_f32_16x16x32_bf16 v[48:51], a[44:47], v[80:83], v[48:51]
    v_mfma_f32_16x16x32_bf16 v[52:55], a[44:47], v[84:87], v[52:55]
    v_mfma_f32_16x16x32_bf16 v[56:59], a[48:51], v[80:83], v[56:59]
    v_mfma_f32_16x16x32_bf16 v[60:63], a[48:51], v[84:87], v[60:63]
    v_mfma_f32_16x16x32_bf16 v[64:67], a[52:55], v[80:83], v[64:67]
    v_mfma_f32_16x16x32_bf16 v[68:71], a[52:55], v[84:87], v[68:71]
    s_add_u32 s33, s31, 0xfc000
    buffer_load_dwordx4 a[28:31], v2, s[8:11], s33 offen offset:0
    buffer_load_dwordx4 a[32:35], v2, s[8:11], s33 offen offset:1024
    buffer_load_dwordx4 a[36:39], v2, s[8:11], s33 offen offset:2048
    buffer_load_dwordx4 a[40:43], v2, s[8:11], s33 offen offset:3072
    s_add_u32 s33, s31, 0xfd000
    buffer_load_dwordx4 a[44:47], v2, s[8:11], s33 offen offset:0
    buffer_load_dwordx4 a[48:51], v2, s[8:11], s33 offen offset:1024
    buffer_load_dwordx4 a[52:55], v2, s[8:11], s33 offen offset:2048
    ds_read_b128 v[80:83], v8 offset:0
    ds_read_b128 v[84:87], v8 offset:16384
    s_waitcnt vmcnt(49)
    s_waitcnt lgkmcnt(2)
    v_mfma_f32_16x16x32_bf16 v[16:19], a[56:59], v[72:75], v[16:19]
    v_mfma_f32_16x16x32_bf16 v[20:23], a[56:59], v[76:79], v[20:23]
    v_mfma_f32_16x16x32_bf16 v[24:27], a[60:63], v[72:75], v[24:27]
    v_mfma_f32_16x16x32_bf16 v[28:31], a[60:63], v[76:79], v[28:31]
    v_mfma_f32_16x16x32_bf16 v[32:35], a[64:67], v[72:75], v[32:35]
    v_mfma_f32_16x16x32_bf16 v[36:39], a[64:67], v[76:79], v[36:39]
    v_mfma_f32_16x16x32_bf16 v[40:43], a[68:71], v[72:75], v[40:43]
    v_mfma_f32_16x16x32_bf16 v[44:47], a[68:71], v[76:79], v[44:47]
    v_mfma_f32_16x16x32_bf16 v[48:51], a[72:75], v[72:75], v[48:51]
    v_mfma_f32_16x16x32_bf16 v[52:55], a[72:75], v[76:79], v[52:55]
    v_mfma_f32_16x16x32_bf16 v[56:59], a[76:79], v[72:75], v[56:59]
    v_mfma_f32_16x16x32_bf16 v[60:63], a[76:79], v[76:79], v[60:63]
    v_mfma_f32_16x16x32_bf16 v[64:67], a[80:83], v[72:75], v[64:67]
    v_mfma_f32_16x16x32_bf16 v[68:71], a[80:83], v[76:79], v[68:71]
    s_add_u32 s33, s31, 0x118000
    buffer_load_dwordx4 a[56:59], v2, s[8:11], s33 offen offset:0
    buffer_load_dwordx4 a[60:63], v2, s[8:11], s33 offen offset:1024
    buffer_load_dwordx4 a[64:67], v2, s[8:11], s33 offen offset:2048
    buffer_load_dwordx4 a[68:71], v2, s[8:11], s33 offen offset:3072
    s_add_u32 s33, s31, 0x119000
    buffer_load_dwordx4 a[72:75], v2, s[8:11], s33 offen offset:0
    buffer_load_dwordx4 a[76:79], v2, s[8:11], s33 offen offset:1024
    buffer_load_dwordx4 a[80:83], v2, s[8:11], s33 offen offset:2048
    ds_read_b128 v[72:75], v5 offset:256
    ds_read_b128 v[76:79], v5 offset:16640
    s_waitcnt vmcnt(49)
    s_waitcnt lgkmcnt(2)
    v_mfma_f32_16x16x32_bf16 v[16:19], a[84:87], v[80:83], v[16:19]
    v_mfma_f32_16x16x32_bf16 v[20:23], a[84:87], v[84:87], v[20:23]
    v_mfma_f32_16x16x32_bf16 v[24:27], a[88:91], v[80:83], v[24:27]
    v_mfma_f32_16x16x32_bf16 v[28:31], a[88:91], v[84:87], v[28:31]
    v_mfma_f32_16x16x32_bf16 v[32:35], a[92:95], v[80:83], v[32:35]
    v_mfma_f32_16x16x32_bf16 v[36:39], a[92:95], v[84:87], v[36:39]
    v_mfma_f32_16x16x32_bf16 v[40:43], a[96:99], v[80:83], v[40:43]
    v_mfma_f32_16x16x32_bf16 v[44:47], a[96:99], v[84:87], v[44:47]
    v_mfma_f32_16x16x32_bf16 v[48:51], a[100:103], v[80:83], v[48:51]
    v_mfma_f32_16x16x32_bf16 v[52:55], a[100:103], v[84:87], v[52:55]
    v_mfma_f32_16x16x32_bf16 v[56:59], a[104:107], v[80:83], v[56:59]
    v_mfma_f32_16x16x32_bf16 v[60:63], a[104:107], v[84:87], v[60:63]
    v_mfma_f32_16x16x32_bf16 v[64:67], a[108:111], v[80:83], v[64:67]
    v_mfma_f32_16x16x32_bf16 v[68:71], a[108:111], v[84:87], v[68:71]
    s_add_u32 s33, s31, 0x134000
    buffer_load_dwordx4 a[84:87], v2, s[8:11], s33 offen offset:0
    buffer_load_dwordx4 a[88:91], v2, s[8:11], s33 offen offset:1024
    buffer_load_dwordx4 a[92:95], v2, s[8:11], s33 offen offset:2048
    buffer_load_dwordx4 a[96:99], v2, s[8:11], s33 offen offset:3072
    s_add_u32 s33, s31, 0x135000
    buffer_load_dwordx4 a[100:103], v2, s[8:11], s33 offen offset:0
    buffer_load_dwordx4 a[104:107], v2, s[8:11], s33 offen offset:1024
    buffer_load_dwordx4 a[108:111], v2, s[8:11], s33 offen offset:2048
    ds_read_b128 v[80:83], v6 offset:256
    ds_read_b128 v[84:87], v6 offset:16640
    s_waitcnt vmcnt(49)
    s_waitcnt lgkmcnt(2)
    v_mfma_f32_16x16x32_bf16 v[16:19], a[112:115], v[72:75], v[16:19]
    v_mfma_f32_16x16x32_bf16 v[20:23], a[112:115], v[76:79], v[20:23]
    v_mfma_f32_16x16x32_bf16 v[24:27], a[116:119], v[72:75], v[24:27]
    v_mfma_f32_16x16x32_bf16 v[28:31], a[116:119], v[76:79], v[28:31]
    v_mfma_f32_16x16x32_bf16 v[32:35], a[120:123], v[72:75], v[32:35]
    v_mfma_f32_16x16x32_bf16 v[36:39], a[120:123], v[76:79], v[36:39]
    v_mfma_f32_16x16x32_bf16 v[40:43], a[124:127], v[72:75], v[40:43]
    v_mfma_f32_16x16x32_bf16 v[44:47], a[124:127], v[76:79], v[44:47]
    v_mfma_f32_16x16x32_bf16 v[48:51], a[128:131], v[72:75], v[48:51]
    v_mfma_f32_16x16x32_bf16 v[52:55], a[128:131], v[76:79], v[52:55]
    v_mfma_f32_16x16x32_bf16 v[56:59], a[132:135], v[72:75], v[56:59]
    v_mfma_f32_16x16x32_bf16 v[60:63], a[132:135], v[76:79], v[60:63]
    v_mfma_f32_16x16x32_bf16 v[64:67], a[136:139], v[72:75], v[64:67]
    v_mfma_f32_16x16x32_bf16 v[68:71], a[136:139], v[76:79], v[68:71]
    s_add_u32 s33, s31, 0x150000
    buffer_load_dwordx4 a[112:115], v2, s[8:11], s33 offen offset:0
    buffer_load_dwordx4 a[116:119], v2, s[8:11], s33 offen offset:1024
    buffer_load_dwordx4 a[120:123], v2, s[8:11], s33 offen offset:2048
    buffer_load_dwordx4 a[124:127], v2, s[8:11], s33 offen offset:3072
    s_add_u32 s33, s31, 0x151000
    buffer_load_dwordx4 a[128:131], v2, s[8:11], s33 offen offset:0
    buffer_load_dwordx4 a[132:135], v2, s[8:11], s33 offen offset:1024
    buffer_load_dwordx4 a[136:139], v2, s[8:11], s33 offen offset:2048
    ds_read_b128 v[72:75], v7 offset:256
    ds_read_b128 v[76:79], v7 offset:16640
    s_waitcnt vmcnt(49)
    s_waitcnt lgkmcnt(2)
    v_mfma_f32_16x16x32_bf16 v[16:19], a[140:143], v[80:83], v[16:19]
    v_mfma_f32_16x16x32_bf16 v[20:23], a[140:143], v[84:87], v[20:23]
    v_mfma_f32_16x16x32_bf16 v[24:27], a[144:147], v[80:83], v[24:27]
    v_mfma_f32_16x16x32_bf16 v[28:31], a[144:147], v[84:87], v[28:31]
    v_mfma_f32_16x16x32_bf16 v[32:35], a[148:151], v[80:83], v[32:35]
    v_mfma_f32_16x16x32_bf16 v[36:39], a[148:151], v[84:87], v[36:39]
    v_mfma_f32_16x16x32_bf16 v[40:43], a[152:155], v[80:83], v[40:43]
    v_mfma_f32_16x16x32_bf16 v[44:47], a[152:155], v[84:87], v[44:47]
    v_mfma_f32_16x16x32_bf16 v[48:51], a[156:159], v[80:83], v[48:51]
    v_mfma_f32_16x16x32_bf16 v[52:55], a[156:159], v[84:87], v[52:55]
    v_mfma_f32_16x16x32_bf16 v[56:59], a[160:163], v[80:83], v[56:59]
    v_mfma_f32_16x16x32_bf16 v[60:63], a[160:163], v[84:87], v[60:63]
    v_mfma_f32_16x16x32_bf16 v[64:67], a[164:167], v[80:83], v[64:67]
    v_mfma_f32_16x16x32_bf16 v[68:71], a[164:167], v[84:87], v[68:71]
    s_add_u32 s33, s31, 0x16c000
    buffer_load_dwordx4 a[140:143], v2, s[8:11], s33 offen offset:0
    buffer_load_dwordx4 a[144:147], v2, s[8:11], s33 offen offset:1024
    buffer_load_dwordx4 a[148:151], v2, s[8:11], s33 offen offset:2048
    buffer_load_dwordx4 a[152:155], v2, s[8:11], s33 offen offset:3072
    s_add_u32 s33, s31, 0x16d000
    buffer_load_dwordx4 a[156:159], v2, s[8:11], s33 offen offset:0
    buffer_load_dwordx4 a[160:163], v2, s[8:11], s33 offen offset:1024
    buffer_load_dwordx4 a[164:167], v2, s[8:11], s33 offen offset:2048
    ds_read_b128 v[80:83], v8 offset:256
    ds_read_b128 v[84:87], v8 offset:16640
    s_waitcnt vmcnt(49)
    s_waitcnt lgkmcnt(2)
    v_mfma_f32_16x16x32_bf16 v[16:19], a[168:171], v[72:75], v[16:19]
    v_mfma_f32_16x16x32_bf16 v[20:23], a[168:171], v[76:79], v[20:23]
    v_mfma_f32_16x16x32_bf16 v[24:27], a[172:175], v[72:75], v[24:27]
    v_mfma_f32_16x16x32_bf16 v[28:31], a[172:175], v[76:79], v[28:31]
    v_mfma_f32_16x16x32_bf16 v[32:35], a[176:179], v[72:75], v[32:35]
    v_mfma_f32_16x16x32_bf16 v[36:39], a[176:179], v[76:79], v[36:39]
    v_mfma_f32_16x16x32_bf16 v[40:43], a[180:183], v[72:75], v[40:43]
    v_mfma_f32_16x16x32_bf16 v[44:47], a[180:183], v[76:79], v[44:47]
    v_mfma_f32_16x16x32_bf16 v[48:51], a[184:187], v[72:75], v[48:51]
    v_mfma_f32_16x16x32_bf16 v[52:55], a[184:187], v[76:79], v[52:55]
    v_mfma_f32_16x16x32_bf16 v[56:59], a[188:191], v[72:75], v[56:59]
    v_mfma_f32_16x16x32_bf16 v[60:63], a[188:191], v[76:79], v[60:63]
    v_mfma_f32_16x16x32_bf16 v[64:67], a[192:195], v[72:75], v[64:67]
    v_mfma_f32_16x16x32_bf16 v[68:71], a[192:195], v[76:79], v[68:71]
    ds_read_b128 v[72:75], v5 offset:512
    ds_read_b128 v[76:79], v5 offset:16896
    s_waitcnt vmcnt(42)
    s_waitcnt lgkmcnt(2)
    v_mfma_f32_16x16x32_bf16 v[16:19], a[196:199], v[80:83], v[16:19]
    v_mfma_f32_16x16x32_bf16 v[20:23], a[196:199], v[84:87], v[20:23]
    v_mfma_f32_16x16x32_bf16 v[24:27], a[200:203], v[80:83], v[24:27]
    v_mfma_f32_16x16x32_bf16 v[28:31], a[200:203], v[84:87], v[28:31]
    v_mfma_f32_16x16x32_bf16 v[32:35], a[204:207], v[80:83], v[32:35]
    v_mfma_f32_16x16x32_bf16 v[36:39], a[204:207], v[84:87], v[36:39]
    v_mfma_f32_16x16x32_bf16 v[40:43], a[208:211], v[80:83], v[40:43]
    v_mfma_f32_16x16x32_bf16 v[44:47], a[208:211], v[84:87], v[44:47]
    v_mfma_f32_16x16x32_bf16 v[48:51], a[212:215], v[80:83], v[48:51]
    v_mfma_f32_16x16x32_bf16 v[52:55], a[212:215], v[84:87], v[52:55]
    v_mfma_f32_16x16x32_bf16 v[56:59], a[216:219], v[80:83], v[56:59]
    v_mfma_f32_16x16x32_bf16 v[60:63], a[216:219], v[84:87], v[60:63]
    v_mfma_f32_16x16x32_bf16 v[64:67], a[220:223], v[80:83], v[64:67]
    v_mfma_f32_16x16x32_bf16 v[68:71], a[220:223], v[84:87], v[68:71]
    ds_read_b128 v[80:83], v6 offset:512
    ds_read_b128 v[84:87], v6 offset:16896
    s_waitcnt vmcnt(35)
    s_waitcnt lgkmcnt(2)
    v_mfma_f32_16x16x32_bf16 v[16:19], a[0:3], v[72:75], v[16:19]
    v_mfma_f32_16x16x32_bf16 v[20:23], a[0:3], v[76:79], v[20:23]
    v_mfma_f32_16x16x32_bf16 v[24:27], a[4:7], v[72:75], v[24:27]
    v_mfma_f32_16x16x32_bf16 v[28:31], a[4:7], v[76:79], v[28:31]
    v_mfma_f32_16x16x32_bf16 v[32:35], a[8:11], v[72:75], v[32:35]
    v_mfma_f32_16x16x32_bf16 v[36:39], a[8:11], v[76:79], v[36:39]
    v_mfma_f32_16x16x32_bf16 v[40:43], a[12:15], v[72:75], v[40:43]
    v_mfma_f32_16x16x32_bf16 v[44:47], a[12:15], v[76:79], v[44:47]
    v_mfma_f32_16x16x32_bf16 v[48:51], a[16:19], v[72:75], v[48:51]
    v_mfma_f32_16x16x32_bf16 v[52:55], a[16:19], v[76:79], v[52:55]
    v_mfma_f32_16x16x32_bf16 v[56:59], a[20:23], v[72:75], v[56:59]
    v_mfma_f32_16x16x32_bf16 v[60:63], a[20:23], v[76:79], v[60:63]
    v_mfma_f32_16x16x32_bf16 v[64:67], a[24:27], v[72:75], v[64:67]
    v_mfma_f32_16x16x32_bf16 v[68:71], a[24:27], v[76:79], v[68:71]
    ds_read_b128 v[72:75], v7 offset:512
    ds_read_b128 v[76:79], v7 offset:16896
    s_waitcnt vmcnt(28)
    s_waitcnt lgkmcnt(2)
    v_mfma_f32_16x16x32_bf16 v[16:19], a[28:31], v[80:83], v[16:19]
    v_mfma_f32_16x16x32_bf16 v[20:23], a[28:31], v[84:87], v[20:23]
    v_mfma_f32_16x16x32_bf16 v[24:27], a[32:35], v[80:83], v[24:27]
    v_mfma_f32_16x16x32_bf16 v[28:31], a[32:35], v[84:87], v[28:31]
    v_mfma_f32_16x16x32_bf16 v[32:35], a[36:39], v[80:83], v[32:35]
    v_mfma_f32_16x16x32_bf16 v[36:39], a[36:39], v[84:87], v[36:39]
    v_mfma_f32_16x16x32_bf16 v[40:43], a[40:43], v[80:83], v[40:43]
    v_mfma_f32_16x16x32_bf16 v[44:47], a[40:43], v[84:87], v[44:47]
    v_mfma_f32_16x16x32_bf16 v[48:51], a[44:47], v[80:83], v[48:51]
    v_mfma_f32_16x16x32_bf16 v[52:55], a[44:47], v[84:87], v[52:55]
    v_mfma_f32_16x16x32_bf16 v[56:59], a[48:51], v[80:83], v[56:59]
    v_mfma_f32_16x16x32_bf16 v[60:63], a[48:51], v[84:87], v[60:63]
    v_mfma_f32_16x16x32_bf16 v[64:67], a[52:55], v[80:83], v[64:67]
    v_mfma_f32_16x16x32_bf16 v[68:71], a[52:55], v[84:87], v[68:71]
    ds_read_b128 v[80:83], v8 offset:512
    ds_read_b128 v[84:87], v8 offset:16896
    s_waitcnt vmcnt(21)
    s_waitcnt lgkmcnt(2)
    v_mfma_f32_16x16x32_bf16 v[16:19], a[56:59], v[72:75], v[16:19]
    v_mfma_f32_16x16x32_bf16 v[20:23], a[56:59], v[76:79], v[20:23]
    v_mfma_f32_16x16x32_bf16 v[24:27], a[60:63], v[72:75], v[24:27]
    v_mfma_f32_16x16x32_bf16 v[28:31], a[60:63], v[76:79], v[28:31]
    v_mfma_f32_16x16x32_bf16 v[32:35], a[64:67], v[72:75], v[32:35]
    v_mfma_f32_16x16x32_bf16 v[36:39], a[64:67], v[76:79], v[36:39]
    v_mfma_f32_16x16x32_bf16 v[40:43], a[68:71], v[72:75], v[40:43]
    v_mfma_f32_16x16x32_bf16 v[44:47], a[68:71], v[76:79], v[44:47]
    v_mfma_f32_16x16x32_bf16 v[48:51], a[72:75], v[72:75], v[48:51]
    v_mfma_f32_16x16x32_bf16 v[52:55], a[72:75], v[76:79], v[52:55]
    v_mfma_f32_16x16x32_bf16 v[56:59], a[76:79], v[72:75], v[56:59]
    v_mfma_f32_16x16x32_bf16 v[60:63], a[76:79], v[76:79], v[60:63]
    v_mfma_f32_16x16x32_bf16 v[64:67], a[80:83], v[72:75], v[64:67]
    v_mfma_f32_16x16x32_bf16 v[68:71], a[80:83], v[76:79], v[68:71]
    ds_read_b128 v[72:75], v5 offset:768
    ds_read_b128 v[76:79], v5 offset:17152
    s_waitcnt vmcnt(14)
    s_waitcnt lgkmcnt(2)
    v_mfma_f32_16x16x32_bf16 v[16:19], a[84:87], v[80:83], v[16:19]
    v_mfma_f32_16x16x32_bf16 v[20:23], a[84:87], v[84:87], v[20:23]
    v_mfma_f32_16x16x32_bf16 v[24:27], a[88:91], v[80:83], v[24:27]
    v_mfma_f32_16x16x32_bf16 v[28:31], a[88:91], v[84:87], v[28:31]
    v_mfma_f32_16x16x32_bf16 v[32:35], a[92:95], v[80:83], v[32:35]
    v_mfma_f32_16x16x32_bf16 v[36:39], a[92:95], v[84:87], v[36:39]
    v_mfma_f32_16x16x32_bf16 v[40:43], a[96:99], v[80:83], v[40:43]
    v_mfma_f32_16x16x32_bf16 v[44:47], a[96:99], v[84:87], v[44:47]
    v_mfma_f32_16x16x32_bf16 v[48:51], a[100:103], v[80:83], v[48:51]
    v_mfma_f32_16x16x32_bf16 v[52:55], a[100:103], v[84:87], v[52:55]
    v_mfma_f32_16x16x32_bf16 v[56:59], a[104:107], v[80:83], v[56:59]
    v_mfma_f32_16x16x32_bf16 v[60:63], a[104:107], v[84:87], v[60:63]
    v_mfma_f32_16x16x32_bf16 v[64:67], a[108:111], v[80:83], v[64:67]
    v_mfma_f32_16x16x32_bf16 v[68:71], a[108:111], v[84:87], v[68:71]
    ds_read_b128 v[80:83], v6 offset:768
    ds_read_b128 v[84:87], v6 offset:17152
    s_waitcnt vmcnt(7)
    s_waitcnt lgkmcnt(2)
    v_mfma_f32_16x16x32_bf16 v[16:19], a[112:115], v[72:75], v[16:19]
    v_mfma_f32_16x16x32_bf16 v[20:23], a[112:115], v[76:79], v[20:23]
    v_mfma_f32_16x16x32_bf16 v[24:27], a[116:119], v[72:75], v[24:27]
    v_mfma_f32_16x16x32_bf16 v[28:31], a[116:119], v[76:79], v[28:31]
    v_mfma_f32_16x16x32_bf16 v[32:35], a[120:123], v[72:75], v[32:35]
    v_mfma_f32_16x16x32_bf16 v[36:39], a[120:123], v[76:79], v[36:39]
    v_mfma_f32_16x16x32_bf16 v[40:43], a[124:127], v[72:75], v[40:43]
    v_mfma_f32_16x16x32_bf16 v[44:47], a[124:127], v[76:79], v[44:47]
    v_mfma_f32_16x16x32_bf16 v[48:51], a[128:131], v[72:75], v[48:51]
    v_mfma_f32_16x16x32_bf16 v[52:55], a[128:131], v[76:79], v[52:55]
    v_mfma_f32_16x16x32_bf16 v[56:59], a[132:135], v[72:75], v[56:59]
    v_mfma_f32_16x16x32_bf16 v[60:63], a[132:135], v[76:79], v[60:63]
    v_mfma_f32_16x16x32_bf16 v[64:67], a[136:139], v[72:75], v[64:67]
    v_mfma_f32_16x16x32_bf16 v[68:71], a[136:139], v[76:79], v[68:71]
    s_waitcnt vmcnt(0)
    s_waitcnt lgkmcnt(0)
    v_mfma_f32_16x16x32_bf16 v[16:19], a[140:143], v[80:83], v[16:19]
    v_mfma_f32_16x16x32_bf16 v[20:23], a[140:143], v[84:87], v[20:23]
    v_mfma_f32_16x16x32_bf16 v[24:27], a[144:147], v[80:83], v[24:27]
    v_mfma_f32_16x16x32_bf16 v[28:31], a[144:147], v[84:87], v[28:31]
    v_mfma_f32_16x16x32_bf16 v[32:35], a[148:151], v[80:83], v[32:35]
    v_mfma_f32_16x16x32_bf16 v[36:39], a[148:151], v[84:87], v[36:39]
    v_mfma_f32_16x16x32_bf16 v[40:43], a[152:155], v[80:83], v[40:43]
    v_mfma_f32_16x16x32_bf16 v[44:47], a[152:155], v[84:87], v[44:47]
    v_mfma_f32_16x16x32_bf16 v[48:51], a[156:159], v[80:83], v[48:51]
    v_mfma_f32_16x16x32_bf16 v[52:55], a[156:159], v[84:87], v[52:55]
    v_mfma_f32_16x16x32_bf16 v[56:59], a[160:163], v[80:83], v[56:59]
    v_mfma_f32_16x16x32_bf16 v[60:63], a[160:163], v[84:87], v[60:63]
    v_mfma_f32_16x16x32_bf16 v[64:67], a[164:167], v[80:83], v[64:67]
    v_mfma_f32_16x16x32_bf16 v[68:71], a[164:167], v[84:87], v[68:71]
    s_nop 7
    s_nop 1
    v_cvt_pk_bf16_f32 v88, v16, v17
    v_lshlrev_b32 v91, 16, v140
    v_and_b32 v92, 0xffff0000, v140
    v_cvt_pk_bf16_f32 v93, v18, v19
    v_lshlrev_b32 v96, 16, v141
    v_and_b32 v97, 0xffff0000, v141
    v_cvt_pk_bf16_f32 v98, v20, v21
    v_lshlrev_b32 v101, 16, v140
    v_and_b32 v102, 0xffff0000, v140
    v_cvt_pk_bf16_f32 v103, v22, v23
    v_lshlrev_b32 v106, 16, v141
    v_and_b32 v107, 0xffff0000, v141
    v_lshlrev_b32 v89, 16, v88
    v_and_b32 v90, 0xffff0000, v88
    v_lshlrev_b32 v94, 16, v93
    v_and_b32 v95, 0xffff0000, v93
    v_lshlrev_b32 v99, 16, v98
    v_and_b32 v100, 0xffff0000, v98
    v_lshlrev_b32 v104, 16, v103
    v_and_b32 v105, 0xffff0000, v103
    v_add_f32 v89, v89, v91
    v_add_f32 v90, v90, v92
    v_add_f32 v94, v94, v96
    v_add_f32 v95, v95, v97
    v_add_f32 v99, v99, v101
    v_add_f32 v100, v100, v102
    v_add_f32 v104, v104, v106
    v_add_f32 v105, v105, v107
    v_cvt_pk_bf16_f32 v88, v89, v90
    v_cvt_pk_bf16_f32 v93, v94, v95
    v_cvt_pk_bf16_f32 v98, v99, v100
    v_cvt_pk_bf16_f32 v103, v104, v105
    v_lshlrev_b32 v89, 16, v88
    v_and_b32 v90, 0xffff0000, v88
    v_lshlrev_b32 v94, 16, v93
    v_and_b32 v95, 0xffff0000, v93
    v_lshlrev_b32 v99, 16, v98
    v_and_b32 v100, 0xffff0000, v98
    v_lshlrev_b32 v104, 16, v103
    v_and_b32 v105, 0xffff0000, v103
    v_max_f32 v89, 0, v89
    v_max_f32 v90, 0, v90
    v_max_f32 v94, 0, v94
    v_max_f32 v95, 0, v95
    v_max_f32 v99, 0, v99
    v_max_f32 v100, 0, v100
    v_max_f32 v104, 0, v104
    v_max_f32 v105, 0, v105
    v_mul_f32 v89, v89, v89
    v_mul_f32 v90, v90, v90
    v_mul_f32 v94, v94, v94
    v_mul_f32 v95, v95, v95
    v_mul_f32 v99, v99, v99
    v_mul_f32 v100, v100, v100
    v_mul_f32 v104, v104, v104
    v_mul_f32 v105, v105, v105
    v_cvt_pk_bf16_f32 v16, v89, v90
    v_cvt_pk_bf16_f32 v17, v94, v95
    v_cvt_pk_bf16_f32 v20, v99, v100
    v_cvt_pk_bf16_f32 v21, v104, v105
    buffer_store_dwordx2 v[16:17], v13, s[16:19], s37 offen offset:0
    buffer_store_dwordx2 v[20:21], v13, s[16:19], s38 offen offset:0
    v_cvt_pk_bf16_f32 v88, v24, v25
    v_lshlrev_b32 v91, 16, v142
    v_and_b32 v92, 0xffff0000, v142
    v_cvt_pk_bf16_f32 v93, v26, v27
    v_lshlrev_b32 v96, 16, v143
    v_and_b32 v97, 0xffff0000, v143
    v_cvt_pk_bf16_f32 v98, v28, v29
    v_lshlrev_b32 v101, 16, v142
    v_and_b32 v102, 0xffff0000, v142
    v_cvt_pk_bf16_f32 v103, v30, v31
    v_lshlrev_b32 v106, 16, v143
    v_and_b32 v107, 0xffff0000, v143
    v_lshlrev_b32 v89, 16, v88
    v_and_b32 v90, 0xffff0000, v88
    v_lshlrev_b32 v94, 16, v93
    v_and_b32 v95, 0xffff0000, v93
    v_lshlrev_b32 v99, 16, v98
    v_and_b32 v100, 0xffff0000, v98
    v_lshlrev_b32 v104, 16, v103
    v_and_b32 v105, 0xffff0000, v103
    v_add_f32 v89, v89, v91
    v_add_f32 v90, v90, v92
    v_add_f32 v94, v94, v96
    v_add_f32 v95, v95, v97
    v_add_f32 v99, v99, v101
    v_add_f32 v100, v100, v102
    v_add_f32 v104, v104, v106
    v_add_f32 v105, v105, v107
    v_cvt_pk_bf16_f32 v88, v89, v90
    v_cvt_pk_bf16_f32 v93, v94, v95
    v_cvt_pk_bf16_f32 v98, v99, v100
    v_cvt_pk_bf16_f32 v103, v104, v105
    v_lshlrev_b32 v89, 16, v88
    v_and_b32 v90, 0xffff0000, v88
    v_lshlrev_b32 v94, 16, v93
    v_and_b32 v95, 0xffff0000, v93
    v_lshlrev_b32 v99, 16, v98
    v_and_b32 v100, 0xffff0000, v98
    v_lshlrev_b32 v104, 16, v103
    v_and_b32 v105, 0xffff0000, v103
    v_max_f32 v89, 0, v89
    v_max_f32 v90, 0, v90
    v_max_f32 v94, 0, v94
    v_max_f32 v95, 0, v95
    v_max_f32 v99, 0, v99
    v_max_f32 v100, 0, v100
    v_max_f32 v104, 0, v104
    v_max_f32 v105, 0, v105
    v_mul_f32 v89, v89, v89
    v_mul_f32 v90, v90, v90
    v_mul_f32 v94, v94, v94
    v_mul_f32 v95, v95, v95
    v_mul_f32 v99, v99, v99
    v_mul_f32 v100, v100, v100
    v_mul_f32 v104, v104, v104
    v_mul_f32 v105, v105, v105
    v_cvt_pk_bf16_f32 v24, v89, v90
    v_cvt_pk_bf16_f32 v25, v94, v95
    v_cvt_pk_bf16_f32 v28, v99, v100
    v_cvt_pk_bf16_f32 v29, v104, v105
    buffer_store_dwordx2 v[24:25], v13, s[16:19], s37 offen offset:32
    buffer_store_dwordx2 v[28:29], v13, s[16:19], s38 offen offset:32
    v_cvt_pk_bf16_f32 v88, v32, v33
    v_lshlrev_b32 v91, 16, v144
    v_and_b32 v92, 0xffff0000, v144
    v_cvt_pk_bf16_f32 v93, v34, v35
    v_lshlrev_b32 v96, 16, v145
    v_and_b32 v97, 0xffff0000, v145
    v_cvt_pk_bf16_f32 v98, v36, v37
    v_lshlrev_b32 v101, 16, v144
    v_and_b32 v102, 0xffff0000, v144
    v_cvt_pk_bf16_f32 v103, v38, v39
    v_lshlrev_b32 v106, 16, v145
    v_and_b32 v107, 0xffff0000, v145
    v_lshlrev_b32 v89, 16, v88
    v_and_b32 v90, 0xffff0000, v88
    v_lshlrev_b32 v94, 16, v93
    v_and_b32 v95, 0xffff0000, v93
    v_lshlrev_b32 v99, 16, v98
    v_and_b32 v100, 0xffff0000, v98
    v_lshlrev_b32 v104, 16, v103
    v_and_b32 v105, 0xffff0000, v103
    v_add_f32 v89, v89, v91
    v_add_f32 v90, v90, v92
    v_add_f32 v94, v94, v96
    v_add_f32 v95, v95, v97
    v_add_f32 v99, v99, v101
    v_add_f32 v100, v100, v102
    v_add_f32 v104, v104, v106
    v_add_f32 v105, v105, v107
    v_cvt_pk_bf16_f32 v88, v89, v90
    v_cvt_pk_bf16_f32 v93, v94, v95
    v_cvt_pk_bf16_f32 v98, v99, v100
    v_cvt_pk_bf16_f32 v103, v104, v105
    v_lshlrev_b32 v89, 16, v88
    v_and_b32 v90, 0xffff0000, v88
    v_lshlrev_b32 v94, 16, v93
    v_and_b32 v95, 0xffff0000, v93
    v_lshlrev_b32 v99, 16, v98
    v_and_b32 v100, 0xffff0000, v98
    v_lshlrev_b32 v104, 16, v103
    v_and_b32 v105, 0xffff0000, v103
    v_max_f32 v89, 0, v89
    v_max_f32 v90, 0, v90
    v_max_f32 v94, 0, v94
    v_max_f32 v95, 0, v95
    v_max_f32 v99, 0, v99
    v_max_f32 v100, 0, v100
    v_max_f32 v104, 0, v104
    v_max_f32 v105, 0, v105
    v_mul_f32 v89, v89, v89
    v_mul_f32 v90, v90, v90
    v_mul_f32 v94, v94, v94
    v_mul_f32 v95, v95, v95
    v_mul_f32 v99, v99, v99
    v_mul_f32 v100, v100, v100
    v_mul_f32 v104, v104, v104
    v_mul_f32 v105, v105, v105
    v_cvt_pk_bf16_f32 v32, v89, v90
    v_cvt_pk_bf16_f32 v33, v94, v95
    v_cvt_pk_bf16_f32 v36, v99, v100
    v_cvt_pk_bf16_f32 v37, v104, v105
    buffer_store_dwordx2 v[32:33], v13, s[16:19], s37 offen offset:64
    buffer_store_dwordx2 v[36:37], v13, s[16:19], s38 offen offset:64
    v_cvt_pk_bf16_f32 v88, v40, v41
    v_lshlrev_b32 v91, 16, v146
    v_and_b32 v92, 0xffff0000, v146
    v_cvt_pk_bf16_f32 v93, v42, v43
    v_lshlrev_b32 v96, 16, v147
    v_and_b32 v97, 0xffff0000, v147
    v_cvt_pk_bf16_f32 v98, v44, v45
    v_lshlrev_b32 v101, 16, v146
    v_and_b32 v102, 0xffff0000, v146
    v_cvt_pk_bf16_f32 v103, v46, v47
    v_lshlrev_b32 v106, 16, v147
    v_and_b32 v107, 0xffff0000, v147
    v_lshlrev_b32 v89, 16, v88
    v_and_b32 v90, 0xffff0000, v88
    v_lshlrev_b32 v94, 16, v93
    v_and_b32 v95, 0xffff0000, v93
    v_lshlrev_b32 v99, 16, v98
    v_and_b32 v100, 0xffff0000, v98
    v_lshlrev_b32 v104, 16, v103
    v_and_b32 v105, 0xffff0000, v103
    v_add_f32 v89, v89, v91
    v_add_f32 v90, v90, v92
    v_add_f32 v94, v94, v96
    v_add_f32 v95, v95, v97
    v_add_f32 v99, v99, v101
    v_add_f32 v100, v100, v102
    v_add_f32 v104, v104, v106
    v_add_f32 v105, v105, v107
    v_cvt_pk_bf16_f32 v88, v89, v90
    v_cvt_pk_bf16_f32 v93, v94, v95
    v_cvt_pk_bf16_f32 v98, v99, v100
    v_cvt_pk_bf16_f32 v103, v104, v105
    v_lshlrev_b32 v89, 16, v88
    v_and_b32 v90, 0xffff0000, v88
    v_lshlrev_b32 v94, 16, v93
    v_and_b32 v95, 0xffff0000, v93
    v_lshlrev_b32 v99, 16, v98
    v_and_b32 v100, 0xffff0000, v98
    v_lshlrev_b32 v104, 16, v103
    v_and_b32 v105, 0xffff0000, v103
    v_max_f32 v89, 0, v89
    v_max_f32 v90, 0, v90
    v_max_f32 v94, 0, v94
    v_max_f32 v95, 0, v95
    v_max_f32 v99, 0, v99
    v_max_f32 v100, 0, v100
    v_max_f32 v104, 0, v104
    v_max_f32 v105, 0, v105
    v_mul_f32 v89, v89, v89
    v_mul_f32 v90, v90, v90
    v_mul_f32 v94, v94, v94
    v_mul_f32 v95, v95, v95
    v_mul_f32 v99, v99, v99
    v_mul_f32 v100, v100, v100
    v_mul_f32 v104, v104, v104
    v_mul_f32 v105, v105, v105
    v_cvt_pk_bf16_f32 v40, v89, v90
    v_cvt_pk_bf16_f32 v41, v94, v95
    v_cvt_pk_bf16_f32 v44, v99, v100
    v_cvt_pk_bf16_f32 v45, v104, v105
    buffer_store_dwordx2 v[40:41], v13, s[16:19], s37 offen offset:96
    buffer_store_dwordx2 v[44:45], v13, s[16:19], s38 offen offset:96
    v_cvt_pk_bf16_f32 v88, v48, v49
    v_lshlrev_b32 v91, 16, v148
    v_and_b32 v92, 0xffff0000, v148
    v_cvt_pk_bf16_f32 v93, v50, v51
    v_lshlrev_b32 v96, 16, v149
    v_and_b32 v97, 0xffff0000, v149
    v_cvt_pk_bf16_f32 v98, v52, v53
    v_lshlrev_b32 v101, 16, v148
    v_and_b32 v102, 0xffff0000, v148
    v_cvt_pk_bf16_f32 v103, v54, v55
    v_lshlrev_b32 v106, 16, v149
    v_and_b32 v107, 0xffff0000, v149
    v_lshlrev_b32 v89, 16, v88
    v_and_b32 v90, 0xffff0000, v88
    v_lshlrev_b32 v94, 16, v93
    v_and_b32 v95, 0xffff0000, v93
    v_lshlrev_b32 v99, 16, v98
    v_and_b32 v100, 0xffff0000, v98
    v_lshlrev_b32 v104, 16, v103
    v_and_b32 v105, 0xffff0000, v103
    v_add_f32 v89, v89, v91
    v_add_f32 v90, v90, v92
    v_add_f32 v94, v94, v96
    v_add_f32 v95, v95, v97
    v_add_f32 v99, v99, v101
    v_add_f32 v100, v100, v102
    v_add_f32 v104, v104, v106
    v_add_f32 v105, v105, v107
    v_cvt_pk_bf16_f32 v88, v89, v90
    v_cvt_pk_bf16_f32 v93, v94, v95
    v_cvt_pk_bf16_f32 v98, v99, v100
    v_cvt_pk_bf16_f32 v103, v104, v105
    v_lshlrev_b32 v89, 16, v88
    v_and_b32 v90, 0xffff0000, v88
    v_lshlrev_b32 v94, 16, v93
    v_and_b32 v95, 0xffff0000, v93
    v_lshlrev_b32 v99, 16, v98
    v_and_b32 v100, 0xffff0000, v98
    v_lshlrev_b32 v104, 16, v103
    v_and_b32 v105, 0xffff0000, v103
    v_max_f32 v89, 0, v89
    v_max_f32 v90, 0, v90
    v_max_f32 v94, 0, v94
    v_max_f32 v95, 0, v95
    v_max_f32 v99, 0, v99
    v_max_f32 v100, 0, v100
    v_max_f32 v104, 0, v104
    v_max_f32 v105, 0, v105
    v_mul_f32 v89, v89, v89
    v_mul_f32 v90, v90, v90
    v_mul_f32 v94, v94, v94
    v_mul_f32 v95, v95, v95
    v_mul_f32 v99, v99, v99
    v_mul_f32 v100, v100, v100
    v_mul_f32 v104, v104, v104
    v_mul_f32 v105, v105, v105
    v_cvt_pk_bf16_f32 v48, v89, v90
    v_cvt_pk_bf16_f32 v49, v94, v95
    v_cvt_pk_bf16_f32 v52, v99, v100
    v_cvt_pk_bf16_f32 v53, v104, v105
    buffer_store_dwordx2 v[48:49], v13, s[16:19], s37 offen offset:128
    buffer_store_dwordx2 v[52:53], v13, s[16:19], s38 offen offset:128
    v_cvt_pk_bf16_f32 v88, v56, v57
    v_lshlrev_b32 v91, 16, v150
    v_and_b32 v92, 0xffff0000, v150
    v_cvt_pk_bf16_f32 v93, v58, v59
    v_lshlrev_b32 v96, 16, v151
    v_and_b32 v97, 0xffff0000, v151
    v_cvt_pk_bf16_f32 v98, v60, v61
    v_lshlrev_b32 v101, 16, v150
    v_and_b32 v102, 0xffff0000, v150
    v_cvt_pk_bf16_f32 v103, v62, v63
    v_lshlrev_b32 v106, 16, v151
    v_and_b32 v107, 0xffff0000, v151
    v_lshlrev_b32 v89, 16, v88
    v_and_b32 v90, 0xffff0000, v88
    v_lshlrev_b32 v94, 16, v93
    v_and_b32 v95, 0xffff0000, v93
    v_lshlrev_b32 v99, 16, v98
    v_and_b32 v100, 0xffff0000, v98
    v_lshlrev_b32 v104, 16, v103
    v_and_b32 v105, 0xffff0000, v103
    v_add_f32 v89, v89, v91
    v_add_f32 v90, v90, v92
    v_add_f32 v94, v94, v96
    v_add_f32 v95, v95, v97
    v_add_f32 v99, v99, v101
    v_add_f32 v100, v100, v102
    v_add_f32 v104, v104, v106
    v_add_f32 v105, v105, v107
    v_cvt_pk_bf16_f32 v88, v89, v90
    v_cvt_pk_bf16_f32 v93, v94, v95
    v_cvt_pk_bf16_f32 v98, v99, v100
    v_cvt_pk_bf16_f32 v103, v104, v105
    v_lshlrev_b32 v89, 16, v88
    v_and_b32 v90, 0xffff0000, v88
    v_lshlrev_b32 v94, 16, v93
    v_and_b32 v95, 0xffff0000, v93
    v_lshlrev_b32 v99, 16, v98
    v_and_b32 v100, 0xffff0000, v98
    v_lshlrev_b32 v104, 16, v103
    v_and_b32 v105, 0xffff0000, v103
    v_max_f32 v89, 0, v89
    v_max_f32 v90, 0, v90
    v_max_f32 v94, 0, v94
    v_max_f32 v95, 0, v95
    v_max_f32 v99, 0, v99
    v_max_f32 v100, 0, v100
    v_max_f32 v104, 0, v104
    v_max_f32 v105, 0, v105
    v_mul_f32 v89, v89, v89
    v_mul_f32 v90, v90, v90
    v_mul_f32 v94, v94, v94
    v_mul_f32 v95, v95, v95
    v_mul_f32 v99, v99, v99
    v_mul_f32 v100, v100, v100
    v_mul_f32 v104, v104, v104
    v_mul_f32 v105, v105, v105
    v_cvt_pk_bf16_f32 v56, v89, v90
    v_cvt_pk_bf16_f32 v57, v94, v95
    v_cvt_pk_bf16_f32 v60, v99, v100
    v_cvt_pk_bf16_f32 v61, v104, v105
    buffer_store_dwordx2 v[56:57], v13, s[16:19], s37 offen offset:160
    buffer_store_dwordx2 v[60:61], v13, s[16:19], s38 offen offset:160
    v_cvt_pk_bf16_f32 v88, v64, v65
    v_lshlrev_b32 v91, 16, v152
    v_and_b32 v92, 0xffff0000, v152
    v_cvt_pk_bf16_f32 v93, v66, v67
    v_lshlrev_b32 v96, 16, v153
    v_and_b32 v97, 0xffff0000, v153
    v_cvt_pk_bf16_f32 v98, v68, v69
    v_lshlrev_b32 v101, 16, v152
    v_and_b32 v102, 0xffff0000, v152
    v_cvt_pk_bf16_f32 v103, v70, v71
    v_lshlrev_b32 v106, 16, v153
    v_and_b32 v107, 0xffff0000, v153
    v_lshlrev_b32 v89, 16, v88
    v_and_b32 v90, 0xffff0000, v88
    v_lshlrev_b32 v94, 16, v93
    v_and_b32 v95, 0xffff0000, v93
    v_lshlrev_b32 v99, 16, v98
    v_and_b32 v100, 0xffff0000, v98
    v_lshlrev_b32 v104, 16, v103
    v_and_b32 v105, 0xffff0000, v103
    v_add_f32 v89, v89, v91
    v_add_f32 v90, v90, v92
    v_add_f32 v94, v94, v96
    v_add_f32 v95, v95, v97
    v_add_f32 v99, v99, v101
    v_add_f32 v100, v100, v102
    v_add_f32 v104, v104, v106
    v_add_f32 v105, v105, v107
    v_cvt_pk_bf16_f32 v88, v89, v90
    v_cvt_pk_bf16_f32 v93, v94, v95
    v_cvt_pk_bf16_f32 v98, v99, v100
    v_cvt_pk_bf16_f32 v103, v104, v105
    v_lshlrev_b32 v89, 16, v88
    v_and_b32 v90, 0xffff0000, v88
    v_lshlrev_b32 v94, 16, v93
    v_and_b32 v95, 0xffff0000, v93
    v_lshlrev_b32 v99, 16, v98
    v_and_b32 v100, 0xffff0000, v98
    v_lshlrev_b32 v104, 16, v103
    v_and_b32 v105, 0xffff0000, v103
    v_max_f32 v89, 0, v89
    v_max_f32 v90, 0, v90
    v_max_f32 v94, 0, v94
    v_max_f32 v95, 0, v95
    v_max_f32 v99, 0, v99
    v_max_f32 v100, 0, v100
    v_max_f32 v104, 0, v104
    v_max_f32 v105, 0, v105
    v_mul_f32 v89, v89, v89
    v_mul_f32 v90, v90, v90
    v_mul_f32 v94, v94, v94
    v_mul_f32 v95, v95, v95
    v_mul_f32 v99, v99, v99
    v_mul_f32 v100, v100, v100
    v_mul_f32 v104, v104, v104
    v_mul_f32 v105, v105, v105
    v_cvt_pk_bf16_f32 v64, v89, v90
    v_cvt_pk_bf16_f32 v65, v94, v95
    v_cvt_pk_bf16_f32 v68, v99, v100
    v_cvt_pk_bf16_f32 v69, v104, v105
    buffer_store_dwordx2 v[64:65], v13, s[16:19], s37 offen offset:192
    buffer_store_dwordx2 v[68:69], v13, s[16:19], s38 offen offset:192
k3l2_kernel_done:
    s_endpgm
.globl k4l2_kernel
.p2align 8
.type k4l2_kernel,@function
k4l2_kernel:
    s_cmp_ge_u32 s2, 224
    s_cbranch_scc1 k4l2_kernel_done
    s_load_dwordx2 s[24:25], s[0:1], 88
    s_load_dwordx2 s[26:27], s[0:1], 64
    s_load_dwordx2 s[44:45], s[0:1], 72
    v_lshrrev_b32 v9, 6, v0
    v_and_b32 v1, 63, v0
    v_lshlrev_b32 v2, 4, v1
    v_and_b32 v3, 15, v1
    v_lshrrev_b32 v4, 4, v1
    v_readfirstlane_b32 s3, v9
    v_add_u32 v9, 0, v4
    v_xor_b32 v9, v9, v3
    v_lshlrev_b32 v9, 4, v9
    v_lshl_add_u32 v5, v3, 10, v9
    v_add_u32 v9, 4, v4
    v_xor_b32 v9, v9, v3
    v_lshlrev_b32 v9, 4, v9
    v_lshl_add_u32 v6, v3, 10, v9
    v_add_u32 v9, 8, v4
    v_xor_b32 v9, v9, v3
    v_lshlrev_b32 v9, 4, v9
    v_lshl_add_u32 v7, v3, 10, v9
    v_add_u32 v9, 12, v4
    v_xor_b32 v9, v9, v3
    v_lshlrev_b32 v9, 4, v9
    v_lshl_add_u32 v8, v3, 10, v9
    v_add_u32 v10, 0x10000, v5
    v_add_u32 v11, 0x10000, v6
    v_add_u32 v12, 0x10000, v7
    v_add_u32 v13, 0x10000, v8
    s_lshr_b32 s29, s2, 3
    s_mul_hi_u32 s28, s29, 0x24924925
    s_mul_i32 s30, s28, 7
    s_sub_u32 s29, s29, s30
    s_and_b32 s30, s2, 7
    s_lshl_b32 s30, s30, 2
    s_add_u32 s28, s28, s30
    s_lshl_b32 s29, s29, 2
    s_add_u32 s29, s29, s3
    s_waitcnt lgkmcnt(0)
    s_add_u32 s4, s24, 0x1678000
    s_addc_u32 s5, s25, 0
    s_mov_b32 s6, 0x700000
    s_mov_b32 s7, 0x00020000
    s_add_u32 s8, s24, 0x358000
    s_addc_u32 s9, s25, 0
    s_mov_b32 s10, 0x188000
    s_mov_b32 s11, 0x00020000
    s_mov_b32 s12, s26
    s_mov_b32 s13, s27
    s_mov_b32 s14, 0x380
    s_mov_b32 s15, 0x00020000
    s_add_u32 s16, s24, 0x10b8000
    s_addc_u32 s17, s25, 0
    s_mov_b32 s18, 0x1c0000
    s_mov_b32 s19, 0x00020000
    s_mov_b32 s20, s44
    s_mov_b32 s21, s45
    s_mov_b32 s22, 0x1c0000
    s_mov_b32 s23, 0x00020000
    s_mul_i32 s30, s28, 229376
    s_lshl_b32 s31, s29, 10
    v_lshrrev_b32 v14, 3, v0
    v_mul_u32_u24 v14, 3584, v14
    v_and_b32 v15, 7, v0
    v_lshl_add_u32 v14, v15, 4, v14
    v_lshrrev_b32 v16, 3, v0
    v_and_b32 v17, 15, v16
    v_xor_b32 v18, v15, v17
    v_lshlrev_b32 v18, 4, v18
    v_add_u32 v15, 8, v15
    v_xor_b32 v19, v15, v17
    v_lshlrev_b32 v19, 4, v19
    v_lshlrev_b32 v16, 10, v16
    v_add_u32 v18, v18, v16
    v_add_u32 v19, v19, v16
    v_add_u32 v158, 0x10000, v18
    v_add_u32 v159, 0x10000, v19
    s_add_u32 s34, s30, 0
    buffer_load_dwordx4 v[100:103], v14, s[4:7], s34 offen offset:0
    buffer_load_dwordx4 v[104:107], v14, s[4:7], s34 offen offset:128
    buffer_load_dwordx4 v[108:111], v14, s[4:7], s34 offen offset:256
    buffer_load_dwordx4 v[112:115], v14, s[4:7], s34 offen offset:384
    buffer_load_dwordx4 v[116:119], v14, s[4:7], s34 offen offset:512
    buffer_load_dwordx4 v[120:123], v14, s[4:7], s34 offen offset:640
    buffer_load_dwordx4 v[124:127], v14, s[4:7], s34 offen offset:768
    s_add_u32 s34, s30, 114688
    buffer_load_dwordx4 v[128:131], v14, s[4:7], s34 offen offset:0
    buffer_load_dwordx4 v[132:135], v14, s[4:7], s34 offen offset:128
    buffer_load_dwordx4 v[136:139], v14, s[4:7], s34 offen offset:256
    buffer_load_dwordx4 v[140:143], v14, s[4:7], s34 offen offset:384
    buffer_load_dwordx4 v[144:147], v14, s[4:7], s34 offen offset:512
    buffer_load_dwordx4 v[148:151], v14, s[4:7], s34 offen offset:640
    buffer_load_dwordx4 v[152:155], v14, s[4:7], s34 offen offset:768
    s_add_u32 s33, s31, 0x0
    buffer_load_dwordx4 a[0:3], v2, s[8:11], s33 offen offset:0
    s_add_u32 s33, s31, 0x7000
    buffer_load_dwordx4 a[4:7], v2, s[8:11], s33 offen offset:0
    s_add_u32 s33, s31, 0xe000
    buffer_load_dwordx4 a[8:11], v2, s[8:11], s33 offen offset:0
    s_add_u32 s33, s31, 0x15000
    buffer_load_dwordx4 a[12:15], v2, s[8:11], s33 offen offset:0
    s_add_u32 s33, s31, 0x1c000
    buffer_load_dwordx4 a[16:19], v2, s[8:11], s33 offen offset:0
    s_add_u32 s33, s31, 0x23000
    buffer_load_dwordx4 a[20:23], v2, s[8:11], s33 offen offset:0
    s_add_u32 s33, s31, 0x2a000
    buffer_load_dwordx4 a[24:27], v2, s[8:11], s33 offen offset:0
    s_add_u32 s33, s31, 0x31000
    buffer_load_dwordx4 a[28:31], v2, s[8:11], s33 offen offset:0
    s_add_u32 s33, s31, 0x38000
    buffer_load_dwordx4 a[32:35], v2, s[8:11], s33 offen offset:0
    s_add_u32 s33, s31, 0x3f000
    buffer_load_dwordx4 a[36:39], v2, s[8:11], s33 offen offset:0
    s_add_u32 s33, s31, 0x46000
    buffer_load_dwordx4 a[40:43], v2, s[8:11], s33 offen offset:0
    s_add_u32 s33, s31, 0x4d000
    buffer_load_dwordx4 a[44:47], v2, s[8:11], s33 offen offset:0
    s_add_u32 s33, s31, 0x54000
    buffer_load_dwordx4 a[48:51], v2, s[8:11], s33 offen offset:0
    s_add_u32 s33, s31, 0x5b000
    buffer_load_dwordx4 a[52:55], v2, s[8:11], s33 offen offset:0
    s_add_u32 s33, s31, 0x62000
    buffer_load_dwordx4 a[56:59], v2, s[8:11], s33 offen offset:0
    s_add_u32 s33, s31, 0x69000
    buffer_load_dwordx4 a[60:63], v2, s[8:11], s33 offen offset:0
    s_add_u32 s33, s31, 0x70000
    buffer_load_dwordx4 a[64:67], v2, s[8:11], s33 offen offset:0
    s_add_u32 s33, s31, 0x77000
    buffer_load_dwordx4 a[68:71], v2, s[8:11], s33 offen offset:0
    s_add_u32 s33, s31, 0x7e000
    buffer_load_dwordx4 a[72:75], v2, s[8:11], s33 offen offset:0
    s_add_u32 s33, s31, 0x85000
    buffer_load_dwordx4 a[76:79], v2, s[8:11], s33 offen offset:0
    s_add_u32 s33, s31, 0x8c000
    buffer_load_dwordx4 a[80:83], v2, s[8:11], s33 offen offset:0
    s_add_u32 s33, s31, 0x93000
    buffer_load_dwordx4 a[84:87], v2, s[8:11], s33 offen offset:0
    s_add_u32 s33, s31, 0x9a000
    buffer_load_dwordx4 a[88:91], v2, s[8:11], s33 offen offset:0
    s_add_u32 s33, s31, 0xa1000
    buffer_load_dwordx4 a[92:95], v2, s[8:11], s33 offen offset:0
    s_waitcnt vmcnt(24)
    ds_write_b128 v18, v[100:103] offset:0
    ds_write_b128 v19, v[104:107] offset:0
    ds_write_b128 v18, v[108:111] offset:256
    ds_write_b128 v19, v[112:115] offset:256
    ds_write_b128 v18, v[116:119] offset:512
    ds_write_b128 v19, v[120:123] offset:512
    ds_write_b128 v18, v[124:127] offset:768
    ds_write_b128 v18, v[128:131] offset:32768
    ds_write_b128 v19, v[132:135] offset:32768
    ds_write_b128 v18, v[136:139] offset:33024
    ds_write_b128 v19, v[140:143] offset:33024
    ds_write_b128 v18, v[144:147] offset:33280
    ds_write_b128 v19, v[148:151] offset:33280
    ds_write_b128 v18, v[152:155] offset:33536
    s_add_u32 s34, s30, 896
    buffer_load_dwordx4 v[100:103], v14, s[4:7], s34 offen offset:0
    buffer_load_dwordx4 v[104:107], v14, s[4:7], s34 offen offset:128
    buffer_load_dwordx4 v[108:111], v14, s[4:7], s34 offen offset:256
    buffer_load_dwordx4 v[112:115], v14, s[4:7], s34 offen offset:384
    buffer_load_dwordx4 v[116:119], v14, s[4:7], s34 offen offset:512
    buffer_load_dwordx4 v[120:123], v14, s[4:7], s34 offen offset:640
    buffer_load_dwordx4 v[124:127], v14, s[4:7], s34 offen offset:768
    s_add_u32 s34, s30, 115584
    buffer_load_dwordx4 v[128:131], v14, s[4:7], s34 offen offset:0
    buffer_load_dwordx4 v[132:135], v14, s[4:7], s34 offen offset:128
    buffer_load_dwordx4 v[136:139], v14, s[4:7], s34 offen offset:256
    buffer_load_dwordx4 v[140:143], v14, s[4:7], s34 offen offset:384
    buffer_load_dwordx4 v[144:147], v14, s[4:7], s34 offen offset:512
    buffer_load_dwordx4 v[148:151], v14, s[4:7], s34 offen offset:640
    buffer_load_dwordx4 v[152:155], v14, s[4:7], s34 offen offset:768
    s_waitcnt lgkmcnt(0)
    s_barrier
    ds_read_b128 v[68:71], v5 offset:0
    ds_read_b128 v[72:75], v5 offset:16384
    ds_read_b128 v[76:79], v5 offset:32768
    ds_read_b128 v[80:83], v5 offset:49152
    ds_read_b128 v[84:87], v6 offset:0
    ds_read_b128 v[88:91], v6 offset:16384
    ds_read_b128 v[92:95], v6 offset:32768
    ds_read_b128 v[96:99], v6 offset:49152
    s_waitcnt vmcnt(37)
    s_waitcnt lgkmcnt(4)
    v_mfma_f32_16x16x32_bf16 v[20:23], a[0:3], v[68:71], 0
    v_mfma_f32_16x16x32_bf16 v[24:27], a[0:3], v[72:75], 0
    v_mfma_f32_16x16x32_bf16 v[28:31], a[0:3], v[76:79], 0
    v_mfma_f32_16x16x32_bf16 v[32:35], a[0:3], v[80:83], 0
    s_add_u32 s33, s31, 0xa8000
    buffer_load_dwordx4 a[0:3], v2, s[8:11], s33 offen offset:0
    ds_read_b128 v[68:71], v7 offset:0
    ds_read_b128 v[72:75], v7 offset:16384
    ds_read_b128 v[76:79], v7 offset:32768
    ds_read_b128 v[80:83], v7 offset:49152
    s_waitcnt vmcnt(37)
    s_waitcnt lgkmcnt(4)
    v_mfma_f32_16x16x32_bf16 v[20:23], a[4:7], v[84:87], v[20:23]
    v_mfma_f32_16x16x32_bf16 v[24:27], a[4:7], v[88:91], v[24:27]
    v_mfma_f32_16x16x32_bf16 v[28:31], a[4:7], v[92:95], v[28:31]
    v_mfma_f32_16x16x32_bf16 v[32:35], a[4:7], v[96:99], v[32:35]
    s_add_u32 s33, s31, 0xaf000
    buffer_load_dwordx4 a[4:7], v2, s[8:11], s33 offen offset:0
    ds_read_b128 v[84:87], v8 offset:0
    ds_read_b128 v[88:91], v8 offset:16384
    ds_read_b128 v[92:95], v8 offset:32768
    ds_read_b128 v[96:99], v8 offset:49152
    s_waitcnt vmcnt(37)
    s_waitcnt lgkmcnt(4)
    v_mfma_f32_16x16x32_bf16 v[20:23], a[8:11], v[68:71], v[20:23]
    v_mfma_f32_16x16x32_bf16 v[24:27], a[8:11], v[72:75], v[24:27]
    v_mfma_f32_16x16x32_bf16 v[28:31], a[8:11], v[76:79], v[28:31]
    v_mfma_f32_16x16x32_bf16 v[32:35], a[8:11], v[80:83], v[32:35]
    s_add_u32 s33, s31, 0xb6000
    buffer_load_dwordx4 a[8:11], v2, s[8:11], s33 offen offset:0
    ds_read_b128 v[68:71], v5 offset:256
    ds_read_b128 v[72:75], v5 offset:16640
    ds_read_b128 v[76:79], v5 offset:33024
    ds_read_b128 v[80:83], v5 offset:49408
    s_waitcnt vmcnt(37)
    s_waitcnt lgkmcnt(4)
    v_mfma_f32_16x16x32_bf16 v[20:23], a[12:15], v[84:87], v[20:23]
    v_mfma_f32_16x16x32_bf16 v[24:27], a[12:15], v[88:91], v[24:27]
    v_mfma_f32_16x16x32_bf16 v[28:31], a[12:15], v[92:95], v[28:31]
    v_mfma_f32_16x16x32_bf16 v[32:35], a[12:15], v[96:99], v[32:35]
    s_add_u32 s33, s31, 0xbd000
    buffer_load_dwordx4 a[12:15], v2, s[8:11], s33 offen offset:0
    ds_read_b128 v[84:87], v6 offset:256
    ds_read_b128 v[88:91], v6 offset:16640
    ds_read_b128 v[92:95], v6 offset:33024
    ds_read_b128 v[96:99], v6 offset:49408
    s_waitcnt vmcnt(37)
    s_waitcnt lgkmcnt(4)
    v_mfma_f32_16x16x32_bf16 v[20:23], a[16:19], v[68:71], v[20:23]
    v_mfma_f32_16x16x32_bf16 v[24:27], a[16:19], v[72:75], v[24:27]
    v_mfma_f32_16x16x32_bf16 v[28:31], a[16:19], v[76:79], v[28:31]
    v_mfma_f32_16x16x32_bf16 v[32:35], a[16:19], v[80:83], v[32:35]
    s_add_u32 s33, s31, 0xc4000
    buffer_load_dwordx4 a[16:19], v2, s[8:11], s33 offen offset:0
    ds_read_b128 v[68:71], v7 offset:256
    ds_read_b128 v[72:75], v7 offset:16640
    ds_read_b128 v[76:79], v7 offset:33024
    ds_read_b128 v[80:83], v7 offset:49408
    s_waitcnt vmcnt(37)
    s_waitcnt lgkmcnt(4)
    v_mfma_f32_16x16x32_bf16 v[20:23], a[20:23], v[84:87], v[20:23]
    v_mfma_f32_16x16x32_bf16 v[24:27], a[20:23], v[88:91], v[24:27]
    v_mfma_f32_16x16x32_bf16 v[28:31], a[20:23], v[92:95], v[28:31]
    v_mfma_f32_16x16x32_bf16 v[32:35], a[20:23], v[96:99], v[32:35]
    s_add_u32 s33, s31, 0xcb000
    buffer_load_dwordx4 a[20:23], v2, s[8:11], s33 offen offset:0
    ds_read_b128 v[84:87], v8 offset:256
    ds_read_b128 v[88:91], v8 offset:16640
    ds_read_b128 v[92:95], v8 offset:33024
    ds_read_b128 v[96:99], v8 offset:49408
    s_waitcnt vmcnt(37)
    s_waitcnt lgkmcnt(4)
    v_mfma_f32_16x16x32_bf16 v[20:23], a[24:27], v[68:71], v[20:23]
    v_mfma_f32_16x16x32_bf16 v[24:27], a[24:27], v[72:75], v[24:27]
    v_mfma_f32_16x16x32_bf16 v[28:31], a[24:27], v[76:79], v[28:31]
    v_mfma_f32_16x16x32_bf16 v[32:35], a[24:27], v[80:83], v[32:35]
    s_add_u32 s33, s31, 0xd2000
    buffer_load_dwordx4 a[24:27], v2, s[8:11], s33 offen offset:0
    ds_read_b128 v[68:71], v5 offset:512
    ds_read_b128 v[72:75], v5 offset:16896
    ds_read_b128 v[76:79], v5 offset:33280
    ds_read_b128 v[80:83], v5 offset:49664
    s_waitcnt vmcnt(37)
    s_waitcnt lgkmcnt(4)
    v_mfma_f32_16x16x32_bf16 v[20:23], a[28:31], v[84:87], v[20:23]
    v_mfma_f32_16x16x32_bf16 v[24:27], a[28:31], v[88:91], v[24:27]
    v_mfma_f32_16x16x32_bf16 v[28:31], a[28:31], v[92:95], v[28:31]
    v_mfma_f32_16x16x32_bf16 v[32:35], a[28:31], v[96:99], v[32:35]
    s_add_u32 s33, s31, 0xd9000
    buffer_load_dwordx4 a[28:31], v2, s[8:11], s33 offen offset:0
    ds_read_b128 v[84:87], v6 offset:512
    ds_read_b128 v[88:91], v6 offset:16896
    ds_read_b128 v[92:95], v6 offset:33280
    ds_read_b128 v[96:99], v6 offset:49664
    s_waitcnt vmcnt(37)
    s_waitcnt lgkmcnt(4)
    v_mfma_f32_16x16x32_bf16 v[20:23], a[32:35], v[68:71], v[20:23]
    v_mfma_f32_16x16x32_bf16 v[24:27], a[32:35], v[72:75], v[24:27]
    v_mfma_f32_16x16x32_bf16 v[28:31], a[32:35], v[76:79], v[28:31]
    v_mfma_f32_16x16x32_bf16 v[32:35], a[32:35], v[80:83], v[32:35]
    s_add_u32 s33, s31, 0xe0000
    buffer_load_dwordx4 a[32:35], v2, s[8:11], s33 offen offset:0
    ds_read_b128 v[68:71], v7 offset:512
    ds_read_b128 v[72:75], v7 offset:16896
    ds_read_b128 v[76:79], v7 offset:33280
    ds_read_b128 v[80:83], v7 offset:49664
    s_waitcnt vmcnt(37)
    s_waitcnt lgkmcnt(4)
    v_mfma_f32_16x16x32_bf16 v[20:23], a[36:39], v[84:87], v[20:23]
    v_mfma_f32_16x16x32_bf16 v[24:27], a[36:39], v[88:91], v[24:27]
    v_mfma_f32_16x16x32_bf16 v[28:31], a[36:39], v[92:95], v[28:31]
    v_mfma_f32_16x16x32_bf16 v[32:35], a[36:39], v[96:99], v[32:35]
    s_add_u32 s33, s31, 0xe7000
    buffer_load_dwordx4 a[36:39], v2, s[8:11], s33 offen offset:0
    ds_read_b128 v[84:87], v8 offset:512
    ds_read_b128 v[88:91], v8 offset:16896
    ds_read_b128 v[92:95], v8 offset:33280
    ds_read_b128 v[96:99], v8 offset:49664
    s_waitcnt vmcnt(37)
    s_waitcnt lgkmcnt(4)
    v_mfma_f32_16x16x32_bf16 v[20:23], a[40:43], v[68:71], v[20:23]
    v_mfma_f32_16x16x32_bf16 v[24:27], a[40:43], v[72:75], v[24:27]
    v_mfma_f32_16x16x32_bf16 v[28:31], a[40:43], v[76:79], v[28:31]
    v_mfma_f32_16x16x32_bf16 v[32:35], a[40:43], v[80:83], v[32:35]
    s_add_u32 s33, s31, 0xee000
    buffer_load_dwordx4 a[40:43], v2, s[8:11], s33 offen offset:0
    ds_read_b128 v[68:71], v5 offset:768
    ds_read_b128 v[72:75], v5 offset:17152
    ds_read_b128 v[76:79], v5 offset:33536
    ds_read_b128 v[80:83], v5 offset:49920
    s_waitcnt vmcnt(37)
    s_waitcnt lgkmcnt(4)
    v_mfma_f32_16x16x32_bf16 v[20:23], a[44:47], v[84:87], v[20:23]
    v_mfma_f32_16x16x32_bf16 v[24:27], a[44:47], v[88:91], v[24:27]
    v_mfma_f32_16x16x32_bf16 v[28:31], a[44:47], v[92:95], v[28:31]
    v_mfma_f32_16x16x32_bf16 v[32:35], a[44:47], v[96:99], v[32:35]
    s_add_u32 s33, s31, 0xf5000
    buffer_load_dwordx4 a[44:47], v2, s[8:11], s33 offen offset:0
    ds_read_b128 v[84:87], v6 offset:768
    ds_read_b128 v[88:91], v6 offset:17152
    ds_read_b128 v[92:95], v6 offset:33536
    ds_read_b128 v[96:99], v6 offset:49920
    s_waitcnt vmcnt(37)
    s_waitcnt lgkmcnt(4)
    v_mfma_f32_16x16x32_bf16 v[20:23], a[48:51], v[68:71], v[20:23]
    v_mfma_f32_16x16x32_bf16 v[24:27], a[48:51], v[72:75], v[24:27]
    v_mfma_f32_16x16x32_bf16 v[28:31], a[48:51], v[76:79], v[28:31]
    v_mfma_f32_16x16x32_bf16 v[32:35], a[48:51], v[80:83], v[32:35]
    s_add_u32 s33, s31, 0xfc000
    buffer_load_dwordx4 a[48:51], v2, s[8:11], s33 offen offset:0
    s_waitcnt vmcnt(37)
    s_waitcnt lgkmcnt(0)
    v_mfma_f32_16x16x32_bf16 v[20:23], a[52:55], v[84:87], v[20:23]
    v_mfma_f32_16x16x32_bf16 v[24:27], a[52:55], v[88:91], v[24:27]
    v_mfma_f32_16x16x32_bf16 v[28:31], a[52:55], v[92:95], v[28:31]
    v_mfma_f32_16x16x32_bf16 v[32:35], a[52:55], v[96:99], v[32:35]
    s_add_u32 s33, s31, 0x103000
    buffer_load_dwordx4 a[52:55], v2, s[8:11], s33 offen offset:0
    s_waitcnt vmcnt(14)
    ds_write_b128 v158, v[100:103] offset:0
    ds_write_b128 v159, v[104:107] offset:0
    ds_write_b128 v158, v[108:111] offset:256
    ds_write_b128 v159, v[112:115] offset:256
    ds_write_b128 v158, v[116:119] offset:512
    ds_write_b128 v159, v[120:123] offset:512
    ds_write_b128 v158, v[124:127] offset:768
    ds_write_b128 v158, v[128:131] offset:32768
    ds_write_b128 v159, v[132:135] offset:32768
    ds_write_b128 v158, v[136:139] offset:33024
    ds_write_b128 v159, v[140:143] offset:33024
    ds_write_b128 v158, v[144:147] offset:33280
    ds_write_b128 v159, v[148:151] offset:33280
    ds_write_b128 v158, v[152:155] offset:33536
    s_add_u32 s34, s30, 1792
    buffer_load_dwordx4 v[100:103], v14, s[4:7], s34 offen offset:0
    buffer_load_dwordx4 v[104:107], v14, s[4:7], s34 offen offset:128
    buffer_load_dwordx4 v[108:111], v14, s[4:7], s34 offen offset:256
    buffer_load_dwordx4 v[112:115], v14, s[4:7], s34 offen offset:384
    buffer_load_dwordx4 v[116:119], v14, s[4:7], s34 offen offset:512
    buffer_load_dwordx4 v[120:123], v14, s[4:7], s34 offen offset:640
    buffer_load_dwordx4 v[124:127], v14, s[4:7], s34 offen offset:768
    s_add_u32 s34, s30, 116480
    buffer_load_dwordx4 v[128:131], v14, s[4:7], s34 offen offset:0
    buffer_load_dwordx4 v[132:135], v14, s[4:7], s34 offen offset:128
    buffer_load_dwordx4 v[136:139], v14, s[4:7], s34 offen offset:256
    buffer_load_dwordx4 v[140:143], v14, s[4:7], s34 offen offset:384
    buffer_load_dwordx4 v[144:147], v14, s[4:7], s34 offen offset:512
    buffer_load_dwordx4 v[148:151], v14, s[4:7], s34 offen offset:640
    buffer_load_dwordx4 v[152:155], v14, s[4:7], s34 offen offset:768
    s_waitcnt lgkmcnt(0)
    s_barrier
    ds_read_b128 v[68:71], v10 offset:0
    ds_read_b128 v[72:75], v10 offset:16384
    ds_read_b128 v[76:79], v10 offset:32768
    ds_read_b128 v[80:83], v10 offset:49152
    ds_read_b128 v[84:87], v11 offset:0
    ds_read_b128 v[88:91], v11 offset:16384
    ds_read_b128 v[92:95], v11 offset:32768
    ds_read_b128 v[96:99], v11 offset:49152
    s_waitcnt lgkmcnt(4)
    v_mfma_f32_16x16x32_bf16 v[20:23], a[56:59], v[68:71], v[20:23]
    v_mfma_f32_16x16x32_bf16 v[24:27], a[56:59], v[72:75], v[24:27]
    v_mfma_f32_16x16x32_bf16 v[28:31], a[56:59], v[76:79], v[28:31]
    v_mfma_f32_16x16x32_bf16 v[32:35], a[56:59], v[80:83], v[32:35]
    s_add_u32 s33, s31, 0x10a000
    buffer_load_dwordx4 a[56:59], v2, s[8:11], s33 offen offset:0
    ds_read_b128 v[68:71], v12 offset:0
    ds_read_b128 v[72:75], v12 offset:16384
    ds_read_b128 v[76:79], v12 offset:32768
    ds_read_b128 v[80:83], v12 offset:49152
    s_waitcnt lgkmcnt(4)
    v_mfma_f32_16x16x32_bf16 v[20:23], a[60:63], v[84:87], v[20:23]
    v_mfma_f32_16x16x32_bf16 v[24:27], a[60:63], v[88:91], v[24:27]
    v_mfma_f32_16x16x32_bf16 v[28:31], a[60:63], v[92:95], v[28:31]
    v_mfma_f32_16x16x32_bf16 v[32:35], a[60:63], v[96:99], v[32:35]
    s_add_u32 s33, s31, 0x111000
    buffer_load_dwordx4 a[60:63], v2, s[8:11], s33 offen offset:0
    ds_read_b128 v[84:87], v13 offset:0
    ds_read_b128 v[88:91], v13 offset:16384
    ds_read_b128 v[92:95], v13 offset:32768
    ds_read_b128 v[96:99], v13 offset:49152
    s_waitcnt lgkmcnt(4)
    v_mfma_f32_16x16x32_bf16 v[20:23], a[64:67], v[68:71], v[20:23]
    v_mfma_f32_16x16x32_bf16 v[24:27], a[64:67], v[72:75], v[24:27]
    v_mfma_f32_16x16x32_bf16 v[28:31], a[64:67], v[76:79], v[28:31]
    v_mfma_f32_16x16x32_bf16 v[32:35], a[64:67], v[80:83], v[32:35]
    s_add_u32 s33, s31, 0x118000
    buffer_load_dwordx4 a[64:67], v2, s[8:11], s33 offen offset:0
    ds_read_b128 v[68:71], v10 offset:256
    ds_read_b128 v[72:75], v10 offset:16640
    ds_read_b128 v[76:79], v10 offset:33024
    ds_read_b128 v[80:83], v10 offset:49408
    s_waitcnt lgkmcnt(4)
    v_mfma_f32_16x16x32_bf16 v[20:23], a[68:71], v[84:87], v[20:23]
    v_mfma_f32_16x16x32_bf16 v[24:27], a[68:71], v[88:91], v[24:27]
    v_mfma_f32_16x16x32_bf16 v[28:31], a[68:71], v[92:95], v[28:31]
    v_mfma_f32_16x16x32_bf16 v[32:35], a[68:71], v[96:99], v[32:35]
    s_add_u32 s33, s31, 0x11f000
    buffer_load_dwordx4 a[68:71], v2, s[8:11], s33 offen offset:0
    ds_read_b128 v[84:87], v11 offset:256
    ds_read_b128 v[88:91], v11 offset:16640
    ds_read_b128 v[92:95], v11 offset:33024
    ds_read_b128 v[96:99], v11 offset:49408
    s_waitcnt lgkmcnt(4)
    v_mfma_f32_16x16x32_bf16 v[20:23], a[72:75], v[68:71], v[20:23]
    v_mfma_f32_16x16x32_bf16 v[24:27], a[72:75], v[72:75], v[24:27]
    v_mfma_f32_16x16x32_bf16 v[28:31], a[72:75], v[76:79], v[28:31]
    v_mfma_f32_16x16x32_bf16 v[32:35], a[72:75], v[80:83], v[32:35]
    s_add_u32 s33, s31, 0x126000
    buffer_load_dwordx4 a[72:75], v2, s[8:11], s33 offen offset:0
    ds_read_b128 v[68:71], v12 offset:256
    ds_read_b128 v[72:75], v12 offset:16640
    ds_read_b128 v[76:79], v12 offset:33024
    ds_read_b128 v[80:83], v12 offset:49408
    s_waitcnt lgkmcnt(4)
    v_mfma_f32_16x16x32_bf16 v[20:23], a[76:79], v[84:87], v[20:23]
    v_mfma_f32_16x16x32_bf16 v[24:27], a[76:79], v[88:91], v[24:27]
    v_mfma_f32_16x16x32_bf16 v[28:31], a[76:79], v[92:95], v[28:31]
    v_mfma_f32_16x16x32_bf16 v[32:35], a[76:79], v[96:99], v[32:35]
    s_add_u32 s33, s31, 0x12d000
    buffer_load_dwordx4 a[76:79], v2, s[8:11], s33 offen offset:0
    ds_read_b128 v[84:87], v13 offset:256
    ds_read_b128 v[88:91], v13 offset:16640
    ds_read_b128 v[92:95], v13 offset:33024
    ds_read_b128 v[96:99], v13 offset:49408
    s_waitcnt lgkmcnt(4)
    v_mfma_f32_16x16x32_bf16 v[20:23], a[80:83], v[68:71], v[20:23]
    v_mfma_f32_16x16x32_bf16 v[24:27], a[80:83], v[72:75], v[24:27]
    v_mfma_f32_16x16x32_bf16 v[28:31], a[80:83], v[76:79], v[28:31]
    v_mfma_f32_16x16x32_bf16 v[32:35], a[80:83], v[80:83], v[32:35]
    s_add_u32 s33, s31, 0x134000
    buffer_load_dwordx4 a[80:83], v2, s[8:11], s33 offen offset:0
    ds_read_b128 v[68:71], v10 offset:512
    ds_read_b128 v[72:75], v10 offset:16896
    ds_read_b128 v[76:79], v10 offset:33280
    ds_read_b128 v[80:83], v10 offset:49664
    s_waitcnt lgkmcnt(4)
    v_mfma_f32_16x16x32_bf16 v[20:23], a[84:87], v[84:87], v[20:23]
    v_mfma_f32_16x16x32_bf16 v[24:27], a[84:87], v[88:91], v[24:27]
    v_mfma_f32_16x16x32_bf16 v[28:31], a[84:87], v[92:95], v[28:31]
    v_mfma_f32_16x16x32_bf16 v[32:35], a[84:87], v[96:99], v[32:35]
    s_add_u32 s33, s31, 0x13b000
    buffer_load_dwordx4 a[84:87], v2, s[8:11], s33 offen offset:0
    ds_read_b128 v[84:87], v11 offset:512
    ds_read_b128 v[88:91], v11 offset:16896
    ds_read_b128 v[92:95], v11 offset:33280
    ds_read_b128 v[96:99], v11 offset:49664
    s_waitcnt lgkmcnt(4)
    v_mfma_f32_16x16x32_bf16 v[20:23], a[88:91], v[68:71], v[20:23]
    v_mfma_f32_16x16x32_bf16 v[24:27], a[88:91], v[72:75], v[24:27]
    v_mfma_f32_16x16x32_bf16 v[28:31], a[88:91], v[76:79], v[28:31]
    v_mfma_f32_16x16x32_bf16 v[32:35], a[88:91], v[80:83], v[32:35]
    s_add_u32 s33, s31, 0x142000
    buffer_load_dwordx4 a[88:91], v2, s[8:11], s33 offen offset:0
    ds_read_b128 v[68:71], v12 offset:512
    ds_read_b128 v[72:75], v12 offset:16896
    ds_read_b128 v[76:79], v12 offset:33280
    ds_read_b128 v[80:83], v12 offset:49664
    s_waitcnt lgkmcnt(4)
    v_mfma_f32_16x16x32_bf16 v[20:23], a[92:95], v[84:87], v[20:23]
    v_mfma_f32_16x16x32_bf16 v[24:27], a[92:95], v[88:91], v[24:27]
    v_mfma_f32_16x16x32_bf16 v[28:31], a[92:95], v[92:95], v[28:31]
    v_mfma_f32_16x16x32_bf16 v[32:35], a[92:95], v[96:99], v[32:35]
    s_add_u32 s33, s31, 0x149000
    buffer_load_dwordx4 a[92:95], v2, s[8:11], s33 offen offset:0
    ds_read_b128 v[84:87], v13 offset:512
    ds_read_b128 v[88:91], v13 offset:16896
    ds_read_b128 v[92:95], v13 offset:33280
    ds_read_b128 v[96:99], v13 offset:49664
    s_waitcnt vmcnt(37)
    s_waitcnt lgkmcnt(4)
    v_mfma_f32_16x16x32_bf16 v[20:23], a[0:3], v[68:71], v[20:23]
    v_mfma_f32_16x16x32_bf16 v[24:27], a[0:3], v[72:75], v[24:27]
    v_mfma_f32_16x16x32_bf16 v[28:31], a[0:3], v[76:79], v[28:31]
    v_mfma_f32_16x16x32_bf16 v[32:35], a[0:3], v[80:83], v[32:35]
    s_add_u32 s33, s31, 0x150000
    buffer_load_dwordx4 a[0:3], v2, s[8:11], s33 offen offset:0
    ds_read_b128 v[68:71], v10 offset:768
    ds_read_b128 v[72:75], v10 offset:17152
    ds_read_b128 v[76:79], v10 offset:33536
    ds_read_b128 v[80:83], v10 offset:49920
    s_waitcnt vmcnt(37)
    s_waitcnt lgkmcnt(4)
    v_mfma_f32_16x16x32_bf16 v[20:23], a[4:7], v[84:87], v[20:23]
    v_mfma_f32_16x16x32_bf16 v[24:27], a[4:7], v[88:91], v[24:27]
    v_mfma_f32_16x16x32_bf16 v[28:31], a[4:7], v[92:95], v[28:31]
    v_mfma_f32_16x16x32_bf16 v[32:35], a[4:7], v[96:99], v[32:35]
    s_add_u32 s33, s31, 0x157000
    buffer_load_dwordx4 a[4:7], v2, s[8:11], s33 offen offset:0
    ds_read_b128 v[84:87], v11 offset:768
    ds_read_b128 v[88:91], v11 offset:17152
    ds_read_b128 v[92:95], v11 offset:33536
    ds_read_b128 v[96:99], v11 offset:49920
    s_waitcnt vmcnt(37)
    s_waitcnt lgkmcnt(4)
    v_mfma_f32_16x16x32_bf16 v[20:23], a[8:11], v[68:71], v[20:23]
    v_mfma_f32_16x16x32_bf16 v[24:27], a[8:11], v[72:75], v[24:27]
    v_mfma_f32_16x16x32_bf16 v[28:31], a[8:11], v[76:79], v[28:31]
    v_mfma_f32_16x16x32_bf16 v[32:35], a[8:11], v[80:83], v[32:35]
    s_add_u32 s33, s31, 0x15e000
    buffer_load_dwordx4 a[8:11], v2, s[8:11], s33 offen offset:0
    s_waitcnt vmcnt(37)
    s_waitcnt lgkmcnt(0)
    v_mfma_f32_16x16x32_bf16 v[20:23], a[12:15], v[84:87], v[20:23]
    v_mfma_f32_16x16x32_bf16 v[24:27], a[12:15], v[88:91], v[24:27]
    v_mfma_f32_16x16x32_bf16 v[28:31], a[12:15], v[92:95], v[28:31]
    v_mfma_f32_16x16x32_bf16 v[32:35], a[12:15], v[96:99], v[32:35]
    s_add_u32 s33, s31, 0x165000
    buffer_load_dwordx4 a[12:15], v2, s[8:11], s33 offen offset:0
    s_waitcnt vmcnt(14)
    ds_write_b128 v18, v[100:103] offset:0
    ds_write_b128 v19, v[104:107] offset:0
    ds_write_b128 v18, v[108:111] offset:256
    ds_write_b128 v19, v[112:115] offset:256
    ds_write_b128 v18, v[116:119] offset:512
    ds_write_b128 v19, v[120:123] offset:512
    ds_write_b128 v18, v[124:127] offset:768
    ds_write_b128 v18, v[128:131] offset:32768
    ds_write_b128 v19, v[132:135] offset:32768
    ds_write_b128 v18, v[136:139] offset:33024
    ds_write_b128 v19, v[140:143] offset:33024
    ds_write_b128 v18, v[144:147] offset:33280
    ds_write_b128 v19, v[148:151] offset:33280
    ds_write_b128 v18, v[152:155] offset:33536
    s_add_u32 s34, s30, 2688
    buffer_load_dwordx4 v[100:103], v14, s[4:7], s34 offen offset:0
    buffer_load_dwordx4 v[104:107], v14, s[4:7], s34 offen offset:128
    buffer_load_dwordx4 v[108:111], v14, s[4:7], s34 offen offset:256
    buffer_load_dwordx4 v[112:115], v14, s[4:7], s34 offen offset:384
    buffer_load_dwordx4 v[116:119], v14, s[4:7], s34 offen offset:512
    buffer_load_dwordx4 v[120:123], v14, s[4:7], s34 offen offset:640
    buffer_load_dwordx4 v[124:127], v14, s[4:7], s34 offen offset:768
    s_add_u32 s34, s30, 117376
    buffer_load_dwordx4 v[128:131], v14, s[4:7], s34 offen offset:0
    buffer_load_dwordx4 v[132:135], v14, s[4:7], s34 offen offset:128
    buffer_load_dwordx4 v[136:139], v14, s[4:7], s34 offen offset:256
    buffer_load_dwordx4 v[140:143], v14, s[4:7], s34 offen offset:384
    buffer_load_dwordx4 v[144:147], v14, s[4:7], s34 offen offset:512
    buffer_load_dwordx4 v[148:151], v14, s[4:7], s34 offen offset:640
    buffer_load_dwordx4 v[152:155], v14, s[4:7], s34 offen offset:768
    s_waitcnt lgkmcnt(0)
    s_barrier
    ds_read_b128 v[68:71], v5 offset:0
    ds_read_b128 v[72:75], v5 offset:16384
    ds_read_b128 v[76:79], v5 offset:32768
    ds_read_b128 v[80:83], v5 offset:49152
    ds_read_b128 v[84:87], v6 offset:0
    ds_read_b128 v[88:91], v6 offset:16384
    ds_read_b128 v[92:95], v6 offset:32768
    ds_read_b128 v[96:99], v6 offset:49152
    s_waitcnt lgkmcnt(4)
    v_mfma_f32_16x16x32_bf16 v[20:23], a[16:19], v[68:71], v[20:23]
    v_mfma_f32_16x16x32_bf16 v[24:27], a[16:19], v[72:75], v[24:27]
    v_mfma_f32_16x16x32_bf16 v[28:31], a[16:19], v[76:79], v[28:31]
    v_mfma_f32_16x16x32_bf16 v[32:35], a[16:19], v[80:83], v[32:35]
    s_add_u32 s33, s31, 0x16c000
    buffer_load_dwordx4 a[16:19], v2, s[8:11], s33 offen offset:0
    ds_read_b128 v[68:71], v7 offset:0
    ds_read_b128 v[72:75], v7 offset:16384
    ds_read_b128 v[76:79], v7 offset:32768
    ds_read_b128 v[80:83], v7 offset:49152
    s_waitcnt lgkmcnt(4)
    v_mfma_f32_16x16x32_bf16 v[20:23], a[20:23], v[84:87], v[20:23]
    v_mfma_f32_16x16x32_bf16 v[24:27], a[20:23], v[88:91], v[24:27]
    v_mfma_f32_16x16x32_bf16 v[28:31], a[20:23], v[92:95], v[28:31]
    v_mfma_f32_16x16x32_bf16 v[32:35], a[20:23], v[96:99], v[32:35]
    s_add_u32 s33, s31, 0x173000
    buffer_load_dwordx4 a[20:23], v2, s[8:11], s33 offen offset:0
    ds_read_b128 v[84:87], v8 offset:0
    ds_read_b128 v[88:91], v8 offset:16384
    ds_read_b128 v[92:95], v8 offset:32768
    ds_read_b128 v[96:99], v8 offset:49152
    s_waitcnt lgkmcnt(4)
    v_mfma_f32_16x16x32_bf16 v[20:23], a[24:27], v[68:71], v[20:23]
    v_mfma_f32_16x16x32_bf16 v[24:27], a[24:27], v[72:75], v[24:27]
    v_mfma_f32_16x16x32_bf16 v[28:31], a[24:27], v[76:79], v[28:31]
    v_mfma_f32_16x16x32_bf16 v[32:35], a[24:27], v[80:83], v[32:35]
    s_add_u32 s33, s31, 0x17a000
    buffer_load_dwordx4 a[24:27], v2, s[8:11], s33 offen offset:0
    ds_read_b128 v[68:71], v5 offset:256
    ds_read_b128 v[72:75], v5 offset:16640
    ds_read_b128 v[76:79], v5 offset:33024
    ds_read_b128 v[80:83], v5 offset:49408
    s_waitcnt lgkmcnt(4)
    v_mfma_f32_16x16x32_bf16 v[20:23], a[28:31], v[84:87], v[20:23]
    v_mfma_f32_16x16x32_bf16 v[24:27], a[28:31], v[88:91], v[24:27]
    v_mfma_f32_16x16x32_bf16 v[28:31], a[28:31], v[92:95], v[28:31]
    v_mfma_f32_16x16x32_bf16 v[32:35], a[28:31], v[96:99], v[32:35]
    s_add_u32 s33, s31, 0x181000
    buffer_load_dwordx4 a[28:31], v2, s[8:11], s33 offen offset:0
    ds_read_b128 v[84:87], v6 offset:256
    ds_read_b128 v[88:91], v6 offset:16640
    ds_read_b128 v[92:95], v6 offset:33024
    ds_read_b128 v[96:99], v6 offset:49408
    s_waitcnt lgkmcnt(4)
    v_mfma_f32_16x16x32_bf16 v[20:23], a[32:35], v[68:71], v[20:23]
    v_mfma_f32_16x16x32_bf16 v[24:27], a[32:35], v[72:75], v[24:27]
    v_mfma_f32_16x16x32_bf16 v[28:31], a[32:35], v[76:79], v[28:31]
    v_mfma_f32_16x16x32_bf16 v[32:35], a[32:35], v[80:83], v[32:35]
    ds_read_b128 v[68:71], v7 offset:256
    ds_read_b128 v[72:75], v7 offset:16640
    ds_read_b128 v[76:79], v7 offset:33024
    ds_read_b128 v[80:83], v7 offset:49408
    s_waitcnt lgkmcnt(4)
    v_mfma_f32_16x16x32_bf16 v[20:23], a[36:39], v[84:87], v[20:23]
    v_mfma_f32_16x16x32_bf16 v[24:27], a[36:39], v[88:91], v[24:27]
    v_mfma_f32_16x16x32_bf16 v[28:31], a[36:39], v[92:95], v[28:31]
    v_mfma_f32_16x16x32_bf16 v[32:35], a[36:39], v[96:99], v[32:35]
    ds_read_b128 v[84:87], v8 offset:256
    ds_read_b128 v[88:91], v8 offset:16640
    ds_read_b128 v[92:95], v8 offset:33024
    ds_read_b128 v[96:99], v8 offset:49408
    s_waitcnt lgkmcnt(4)
    v_mfma_f32_16x16x32_bf16 v[20:23], a[40:43], v[68:71], v[20:23]
    v_mfma_f32_16x16x32_bf16 v[24:27], a[40:43], v[72:75], v[24:27]
    v_mfma_f32_16x16x32_bf16 v[28:31], a[40:43], v[76:79], v[28:31]
    v_mfma_f32_16x16x32_bf16 v[32:35], a[40:43], v[80:83], v[32:35]
    ds_read_b128 v[68:71], v5 offset:512
    ds_read_b128 v[72:75], v5 offset:16896
    ds_read_b128 v[76:79], v5 offset:33280
    ds_read_b128 v[80:83], v5 offset:49664
    s_waitcnt lgkmcnt(4)
    v_mfma_f32_16x16x32_bf16 v[20:23], a[44:47], v[84:87], v[20:23]
    v_mfma_f32_16x16x32_bf16 v[24:27], a[44:47], v[88:91], v[24:27]
    v_mfma_f32_16x16x32_bf16 v[28:31], a[44:47], v[92:95], v[28:31]
    v_mfma_f32_16x16x32_bf16 v[32:35], a[44:47], v[96:99], v[32:35]
    ds_read_b128 v[84:87], v6 offset:512
    ds_read_b128 v[88:91], v6 offset:16896
    ds_read_b128 v[92:95], v6 offset:33280
    ds_read_b128 v[96:99], v6 offset:49664
    s_waitcnt lgkmcnt(4)
    v_mfma_f32_16x16x32_bf16 v[20:23], a[48:51], v[68:71], v[20:23]
    v_mfma_f32_16x16x32_bf16 v[24:27], a[48:51], v[72:75], v[24:27]
    v_mfma_f32_16x16x32_bf16 v[28:31], a[48:51], v[76:79], v[28:31]
    v_mfma_f32_16x16x32_bf16 v[32:35], a[48:51], v[80:83], v[32:35]
    ds_read_b128 v[68:71], v7 offset:512
    ds_read_b128 v[72:75], v7 offset:16896
    ds_read_b128 v[76:79], v7 offset:33280
    ds_read_b128 v[80:83], v7 offset:49664
    s_waitcnt lgkmcnt(4)
    v_mfma_f32_16x16x32_bf16 v[20:23], a[52:55], v[84:87], v[20:23]
    v_mfma_f32_16x16x32_bf16 v[24:27], a[52:55], v[88:91], v[24:27]
    v_mfma_f32_16x16x32_bf16 v[28:31], a[52:55], v[92:95], v[28:31]
    v_mfma_f32_16x16x32_bf16 v[32:35], a[52:55], v[96:99], v[32:35]
    ds_read_b128 v[84:87], v8 offset:512
    ds_read_b128 v[88:91], v8 offset:16896
    ds_read_b128 v[92:95], v8 offset:33280
    ds_read_b128 v[96:99], v8 offset:49664
    s_waitcnt vmcnt(31)
    s_waitcnt lgkmcnt(4)
    v_mfma_f32_16x16x32_bf16 v[20:23], a[56:59], v[68:71], v[20:23]
    v_mfma_f32_16x16x32_bf16 v[24:27], a[56:59], v[72:75], v[24:27]
    v_mfma_f32_16x16x32_bf16 v[28:31], a[56:59], v[76:79], v[28:31]
    v_mfma_f32_16x16x32_bf16 v[32:35], a[56:59], v[80:83], v[32:35]
    ds_read_b128 v[68:71], v5 offset:768
    ds_read_b128 v[72:75], v5 offset:17152
    ds_read_b128 v[76:79], v5 offset:33536
    ds_read_b128 v[80:83], v5 offset:49920
    s_waitcnt vmcnt(30)
    s_waitcnt lgkmcnt(4)
    v_mfma_f32_16x16x32_bf16 v[20:23], a[60:63], v[84:87], v[20:23]
    v_mfma_f32_16x16x32_bf16 v[24:27], a[60:63], v[88:91], v[24:27]
    v_mfma_f32_16x16x32_bf16 v[28:31], a[60:63], v[92:95], v[28:31]
    v_mfma_f32_16x16x32_bf16 v[32:35], a[60:63], v[96:99], v[32:35]
    ds_read_b128 v[84:87], v6 offset:768
    ds_read_b128 v[88:91], v6 offset:17152
    ds_read_b128 v[92:95], v6 offset:33536
    ds_read_b128 v[96:99], v6 offset:49920
    s_waitcnt vmcnt(29)
    s_waitcnt lgkmcnt(4)
    v_mfma_f32_16x16x32_bf16 v[20:23], a[64:67], v[68:71], v[20:23]
    v_mfma_f32_16x16x32_bf16 v[24:27], a[64:67], v[72:75], v[24:27]
    v_mfma_f32_16x16x32_bf16 v[28:31], a[64:67], v[76:79], v[28:31]
    v_mfma_f32_16x16x32_bf16 v[32:35], a[64:67], v[80:83], v[32:35]
    s_waitcnt vmcnt(28)
    s_waitcnt lgkmcnt(0)
    v_mfma_f32_16x16x32_bf16 v[20:23], a[68:71], v[84:87], v[20:23]
    v_mfma_f32_16x16x32_bf16 v[24:27], a[68:71], v[88:91], v[24:27]
    v_mfma_f32_16x16x32_bf16 v[28:31], a[68:71], v[92:95], v[28:31]
    v_mfma_f32_16x16x32_bf16 v[32:35], a[68:71], v[96:99], v[32:35]
    s_waitcnt vmcnt(4)
    ds_write_b128 v158, v[100:103] offset:0
    ds_write_b128 v159, v[104:107] offset:0
    ds_write_b128 v158, v[108:111] offset:256
    ds_write_b128 v159, v[112:115] offset:256
    ds_write_b128 v158, v[116:119] offset:512
    ds_write_b128 v159, v[120:123] offset:512
    ds_write_b128 v158, v[124:127] offset:768
    ds_write_b128 v158, v[128:131] offset:32768
    ds_write_b128 v159, v[132:135] offset:32768
    ds_write_b128 v158, v[136:139] offset:33024
    ds_write_b128 v159, v[140:143] offset:33024
    ds_write_b128 v158, v[144:147] offset:33280
    ds_write_b128 v159, v[148:151] offset:33280
    ds_write_b128 v158, v[152:155] offset:33536
    s_waitcnt lgkmcnt(0)
    s_barrier
    ds_read_b128 v[68:71], v10 offset:0
    ds_read_b128 v[72:75], v10 offset:16384
    ds_read_b128 v[76:79], v10 offset:32768
    ds_read_b128 v[80:83], v10 offset:49152
    ds_read_b128 v[84:87], v11 offset:0
    ds_read_b128 v[88:91], v11 offset:16384
    ds_read_b128 v[92:95], v11 offset:32768
    ds_read_b128 v[96:99], v11 offset:49152
    s_waitcnt lgkmcnt(4)
    v_mfma_f32_16x16x32_bf16 v[20:23], a[72:75], v[68:71], v[20:23]
    v_mfma_f32_16x16x32_bf16 v[24:27], a[72:75], v[72:75], v[24:27]
    v_mfma_f32_16x16x32_bf16 v[28:31], a[72:75], v[76:79], v[28:31]
    v_mfma_f32_16x16x32_bf16 v[32:35], a[72:75], v[80:83], v[32:35]
    ds_read_b128 v[68:71], v12 offset:0
    ds_read_b128 v[72:75], v12 offset:16384
    ds_read_b128 v[76:79], v12 offset:32768
    ds_read_b128 v[80:83], v12 offset:49152
    s_waitcnt lgkmcnt(4)
    v_mfma_f32_16x16x32_bf16 v[20:23], a[76:79], v[84:87], v[20:23]
    v_mfma_f32_16x16x32_bf16 v[24:27], a[76:79], v[88:91], v[24:27]
    v_mfma_f32_16x16x32_bf16 v[28:31], a[76:79], v[92:95], v[28:31]
    v_mfma_f32_16x16x32_bf16 v[32:35], a[76:79], v[96:99], v[32:35]
    ds_read_b128 v[84:87], v13 offset:0
    ds_read_b128 v[88:91], v13 offset:16384
    ds_read_b128 v[92:95], v13 offset:32768
    ds_read_b128 v[96:99], v13 offset:49152
    s_waitcnt lgkmcnt(4)
    v_mfma_f32_16x16x32_bf16 v[20:23], a[80:83], v[68:71], v[20:23]
    v_mfma_f32_16x16x32_bf16 v[24:27], a[80:83], v[72:75], v[24:27]
    v_mfma_f32_16x16x32_bf16 v[28:31], a[80:83], v[76:79], v[28:31]
    v_mfma_f32_16x16x32_bf16 v[32:35], a[80:83], v[80:83], v[32:35]
    ds_read_b128 v[68:71], v10 offset:256
    ds_read_b128 v[72:75], v10 offset:16640
    ds_read_b128 v[76:79], v10 offset:33024
    ds_read_b128 v[80:83], v10 offset:49408
    s_waitcnt lgkmcnt(4)
    v_mfma_f32_16x16x32_bf16 v[20:23], a[84:87], v[84:87], v[20:23]
    v_mfma_f32_16x16x32_bf16 v[24:27], a[84:87], v[88:91], v[24:27]
    v_mfma_f32_16x16x32_bf16 v[28:31], a[84:87], v[92:95], v[28:31]
    v_mfma_f32_16x16x32_bf16 v[32:35], a[84:87], v[96:99], v[32:35]
    ds_read_b128 v[84:87], v11 offset:256
    ds_read_b128 v[88:91], v11 offset:16640
    ds_read_b128 v[92:95], v11 offset:33024
    ds_read_b128 v[96:99], v11 offset:49408
    s_waitcnt lgkmcnt(4)
    v_mfma_f32_16x16x32_bf16 v[20:23], a[88:91], v[68:71], v[20:23]
    v_mfma_f32_16x16x32_bf16 v[24:27], a[88:91], v[72:75], v[24:27]
    v_mfma_f32_16x16x32_bf16 v[28:31], a[88:91], v[76:79], v[28:31]
    v_mfma_f32_16x16x32_bf16 v[32:35], a[88:91], v[80:83], v[32:35]
    ds_read_b128 v[68:71], v12 offset:256
    ds_read_b128 v[72:75], v12 offset:16640
    ds_read_b128 v[76:79], v12 offset:33024
    ds_read_b128 v[80:83], v12 offset:49408
    s_waitcnt lgkmcnt(4)
    v_mfma_f32_16x16x32_bf16 v[20:23], a[92:95], v[84:87], v[20:23]
    v_mfma_f32_16x16x32_bf16 v[24:27], a[92:95], v[88:91], v[24:27]
    v_mfma_f32_16x16x32_bf16 v[28:31], a[92:95], v[92:95], v[28:31]
    v_mfma_f32_16x16x32_bf16 v[32:35], a[92:95], v[96:99], v[32:35]
    ds_read_b128 v[84:87], v13 offset:256
    ds_read_b128 v[88:91], v13 offset:16640
    ds_read_b128 v[92:95], v13 offset:33024
    ds_read_b128 v[96:99], v13 offset:49408
    s_waitcnt lgkmcnt(4)
    v_mfma_f32_16x16x32_bf16 v[20:23], a[0:3], v[68:71], v[20:23]
    v_mfma_f32_16x16x32_bf16 v[24:27], a[0:3], v[72:75], v[24:27]
    v_mfma_f32_16x16x32_bf16 v[28:31], a[0:3], v[76:79], v[28:31]
    v_mfma_f32_16x16x32_bf16 v[32:35], a[0:3], v[80:83], v[32:35]
    ds_read_b128 v[68:71], v10 offset:512
    ds_read_b128 v[72:75], v10 offset:16896
    ds_read_b128 v[76:79], v10 offset:33280
    ds_read_b128 v[80:83], v10 offset:49664
    s_waitcnt lgkmcnt(4)
    v_mfma_f32_16x16x32_bf16 v[20:23], a[4:7], v[84:87], v[20:23]
    v_mfma_f32_16x16x32_bf16 v[24:27], a[4:7], v[88:91], v[24:27]
    v_mfma_f32_16x16x32_bf16 v[28:31], a[4:7], v[92:95], v[28:31]
    v_mfma_f32_16x16x32_bf16 v[32:35], a[4:7], v[96:99], v[32:35]
    ds_read_b128 v[84:87], v11 offset:512
    ds_read_b128 v[88:91], v11 offset:16896
    ds_read_b128 v[92:95], v11 offset:33280
    ds_read_b128 v[96:99], v11 offset:49664
    s_waitcnt lgkmcnt(4)
    v_mfma_f32_16x16x32_bf16 v[20:23], a[8:11], v[68:71], v[20:23]
    v_mfma_f32_16x16x32_bf16 v[24:27], a[8:11], v[72:75], v[24:27]
    v_mfma_f32_16x16x32_bf16 v[28:31], a[8:11], v[76:79], v[28:31]
    v_mfma_f32_16x16x32_bf16 v[32:35], a[8:11], v[80:83], v[32:35]
    ds_read_b128 v[68:71], v12 offset:512
    ds_read_b128 v[72:75], v12 offset:16896
    ds_read_b128 v[76:79], v12 offset:33280
    ds_read_b128 v[80:83], v12 offset:49664
    s_waitcnt lgkmcnt(4)
    v_mfma_f32_16x16x32_bf16 v[20:23], a[12:15], v[84:87], v[20:23]
    v_mfma_f32_16x16x32_bf16 v[24:27], a[12:15], v[88:91], v[24:27]
    v_mfma_f32_16x16x32_bf16 v[28:31], a[12:15], v[92:95], v[28:31]
    v_mfma_f32_16x16x32_bf16 v[32:35], a[12:15], v[96:99], v[32:35]
    ds_read_b128 v[84:87], v13 offset:512
    ds_read_b128 v[88:91], v13 offset:16896
    ds_read_b128 v[92:95], v13 offset:33280
    ds_read_b128 v[96:99], v13 offset:49664
    s_waitcnt vmcnt(3)
    s_waitcnt lgkmcnt(4)
    v_mfma_f32_16x16x32_bf16 v[20:23], a[16:19], v[68:71], v[20:23]
    v_mfma_f32_16x16x32_bf16 v[24:27], a[16:19], v[72:75], v[24:27]
    v_mfma_f32_16x16x32_bf16 v[28:31], a[16:19], v[76:79], v[28:31]
    v_mfma_f32_16x16x32_bf16 v[32:35], a[16:19], v[80:83], v[32:35]
    ds_read_b128 v[68:71], v10 offset:768
    ds_read_b128 v[72:75], v10 offset:17152
    ds_read_b128 v[76:79], v10 offset:33536
    ds_read_b128 v[80:83], v10 offset:49920
    s_waitcnt vmcnt(2)
    s_waitcnt lgkmcnt(4)
    v_mfma_f32_16x16x32_bf16 v[20:23], a[20:23], v[84:87], v[20:23]
    v_mfma_f32_16x16x32_bf16 v[24:27], a[20:23], v[88:91], v[24:27]
    v_mfma_f32_16x16x32_bf16 v[28:31], a[20:23], v[92:95], v[28:31]
    v_mfma_f32_16x16x32_bf16 v[32:35], a[20:23], v[96:99], v[32:35]
    ds_read_b128 v[84:87], v11 offset:768
    ds_read_b128 v[88:91], v11 offset:17152
    ds_read_b128 v[92:95], v11 offset:33536
    ds_read_b128 v[96:99], v11 offset:49920
    s_waitcnt vmcnt(1)
    s_waitcnt lgkmcnt(4)
    v_mfma_f32_16x16x32_bf16 v[20:23], a[24:27], v[68:71], v[20:23]
    v_mfma_f32_16x16x32_bf16 v[24:27], a[24:27], v[72:75], v[24:27]
    v_mfma_f32_16x16x32_bf16 v[28:31], a[24:27], v[76:79], v[28:31]
    v_mfma_f32_16x16x32_bf16 v[32:35], a[24:27], v[80:83], v[32:35]
    s_waitcnt vmcnt(0)
    s_waitcnt lgkmcnt(0)
    v_mfma_f32_16x16x32_bf16 v[20:23], a[28:31], v[84:87], v[20:23]
    v_mfma_f32_16x16x32_bf16 v[24:27], a[28:31], v[88:91], v[24:27]
    v_mfma_f32_16x16x32_bf16 v[28:31], a[28:31], v[92:95], v[28:31]
    v_mfma_f32_16x16x32_bf16 v[32:35], a[28:31], v[96:99], v[32:35]
    v_lshlrev_b32 v12, 3, v4
    s_lshl_b32 s36, s29, 5
    buffer_load_dwordx2 v[36:37], v12, s[12:15], s36 offen
    v_mul_u32_u24 v13, 896, v3
    v_lshl_add_u32 v13, v4, 3, v13
    s_mul_i32 s37, s28, 57344
    s_add_u32 s37, s37, s36
    s_add_u32 s38, s37, 0
    buffer_load_dwordx2 v[38:39], v13, s[16:19], s38 offen
    s_add_u32 s39, s37, 14336
    buffer_load_dwordx2 v[40:41], v13, s[16:19], s39 offen
    s_add_u32 s40, s37, 28672
    buffer_load_dwordx2 v[42:43], v13, s[16:19], s40 offen
    s_add_u32 s41, s37, 43008
    buffer_load_dwordx2 v[44:45], v13, s[16:19], s41 offen
    s_nop 7
    s_waitcnt vmcnt(0)
    v_cvt_pk_bf16_f32 v160, v20, v21
    v_lshlrev_b32 v161, 16, v160
    v_and_b32 v162, 0xffff0000, v160
    v_lshlrev_b32 v163, 16, v36
    v_and_b32 v164, 0xffff0000, v36
    v_add_f32 v161, v161, v163
    v_add_f32 v162, v162, v164
    v_cvt_pk_bf16_f32 v160, v161, v162
    v_lshlrev_b32 v161, 16, v160
    v_and_b32 v162, 0xffff0000, v160
    v_lshlrev_b32 v163, 16, v38
    v_and_b32 v164, 0xffff0000, v38
    v_add_f32 v161, v161, v163
    v_add_f32 v162, v162, v164
    v_cvt_pk_bf16_f32 v38, v161, v162
    v_cvt_pk_bf16_f32 v160, v22, v23
    v_lshlrev_b32 v161, 16, v160
    v_and_b32 v162, 0xffff0000, v160
    v_lshlrev_b32 v163, 16, v37
    v_and_b32 v164, 0xffff0000, v37
    v_add_f32 v161, v161, v163
    v_add_f32 v162, v162, v164
    v_cvt_pk_bf16_f32 v160, v161, v162
    v_lshlrev_b32 v161, 16, v160
    v_and_b32 v162, 0xffff0000, v160
    v_lshlrev_b32 v163, 16, v39
    v_and_b32 v164, 0xffff0000, v39
    v_add_f32 v161, v161, v163
    v_add_f32 v162, v162, v164
    v_cvt_pk_bf16_f32 v39, v161, v162
    buffer_store_dwordx2 v[38:39], v13, s[20:23], s38 offen
    v_cvt_pk_bf16_f32 v160, v24, v25
    v_lshlrev_b32 v161, 16, v160
    v_and_b32 v162, 0xffff0000, v160
    v_lshlrev_b32 v163, 16, v36
    v_and_b32 v164, 0xffff0000, v36
    v_add_f32 v161, v161, v163
    v_add_f32 v162, v162, v164
    v_cvt_pk_bf16_f32 v160, v161, v162
    v_lshlrev_b32 v161, 16, v160
    v_and_b32 v162, 0xffff0000, v160
    v_lshlrev_b32 v163, 16, v40
    v_and_b32 v164, 0xffff0000, v40
    v_add_f32 v161, v161, v163
    v_add_f32 v162, v162, v164
    v_cvt_pk_bf16_f32 v40, v161, v162
    v_cvt_pk_bf16_f32 v160, v26, v27
    v_lshlrev_b32 v161, 16, v160
    v_and_b32 v162, 0xffff0000, v160
    v_lshlrev_b32 v163, 16, v37
    v_and_b32 v164, 0xffff0000, v37
    v_add_f32 v161, v161, v163
    v_add_f32 v162, v162, v164
    v_cvt_pk_bf16_f32 v160, v161, v162
    v_lshlrev_b32 v161, 16, v160
    v_and_b32 v162, 0xffff0000, v160
    v_lshlrev_b32 v163, 16, v41
    v_and_b32 v164, 0xffff0000, v41
    v_add_f32 v161, v161, v163
    v_add_f32 v162, v162, v164
    v_cvt_pk_bf16_f32 v41, v161, v162
    buffer_store_dwordx2 v[40:41], v13, s[20:23], s39 offen
    v_cvt_pk_bf16_f32 v160, v28, v29
    v_lshlrev_b32 v161, 16, v160
    v_and_b32 v162, 0xffff0000, v160
    v_lshlrev_b32 v163, 16, v36
    v_and_b32 v164, 0xffff0000, v36
    v_add_f32 v161, v161, v163
    v_add_f32 v162, v162, v164
    v_cvt_pk_bf16_f32 v160, v161, v162
    v_lshlrev_b32 v161, 16, v160
    v_and_b32 v162, 0xffff0000, v160
    v_lshlrev_b32 v163, 16, v42
    v_and_b32 v164, 0xffff0000, v42
    v_add_f32 v161, v161, v163
    v_add_f32 v162, v162, v164
    v_cvt_pk_bf16_f32 v42, v161, v162
    v_cvt_pk_bf16_f32 v160, v30, v31
    v_lshlrev_b32 v161, 16, v160
    v_and_b32 v162, 0xffff0000, v160
    v_lshlrev_b32 v163, 16, v37
    v_and_b32 v164, 0xffff0000, v37
    v_add_f32 v161, v161, v163
    v_add_f32 v162, v162, v164
    v_cvt_pk_bf16_f32 v160, v161, v162
    v_lshlrev_b32 v161, 16, v160
    v_and_b32 v162, 0xffff0000, v160
    v_lshlrev_b32 v163, 16, v43
    v_and_b32 v164, 0xffff0000, v43
    v_add_f32 v161, v161, v163
    v_add_f32 v162, v162, v164
    v_cvt_pk_bf16_f32 v43, v161, v162
    buffer_store_dwordx2 v[42:43], v13, s[20:23], s40 offen
    v_cvt_pk_bf16_f32 v160, v32, v33
    v_lshlrev_b32 v161, 16, v160
    v_and_b32 v162, 0xffff0000, v160
    v_lshlrev_b32 v163, 16, v36
    v_and_b32 v164, 0xffff0000, v36
    v_add_f32 v161, v161, v163
    v_add_f32 v162, v162, v164
    v_cvt_pk_bf16_f32 v160, v161, v162
    v_lshlrev_b32 v161, 16, v160
    v_and_b32 v162, 0xffff0000, v160
    v_lshlrev_b32 v163, 16, v44
    v_and_b32 v164, 0xffff0000, v44
    v_add_f32 v161, v161, v163
    v_add_f32 v162, v162, v164
    v_cvt_pk_bf16_f32 v44, v161, v162
    v_cvt_pk_bf16_f32 v160, v34, v35
    v_lshlrev_b32 v161, 16, v160
    v_and_b32 v162, 0xffff0000, v160
    v_lshlrev_b32 v163, 16, v37
    v_and_b32 v164, 0xffff0000, v37
    v_add_f32 v161, v161, v163
    v_add_f32 v162, v162, v164
    v_cvt_pk_bf16_f32 v160, v161, v162
    v_lshlrev_b32 v161, 16, v160
    v_and_b32 v162, 0xffff0000, v160
    v_lshlrev_b32 v163, 16, v45
    v_and_b32 v164, 0xffff0000, v45
    v_add_f32 v161, v161, v163
    v_add_f32 v162, v162, v164
    v_cvt_pk_bf16_f32 v45, v161, v162
    buffer_store_dwordx2 v[44:45], v13, s[20:23], s41 offen
k4l2_kernel_done:
    s_endpgm
.section .rodata,"a"
.p2align 6
.amdhsa_kernel prep_kernel
  .amdhsa_next_free_vgpr 32
  .amdhsa_next_free_sgpr 48
  .amdhsa_accum_offset 32
  .amdhsa_group_segment_fixed_size 0
  .amdhsa_kernarg_size 96
  .amdhsa_user_sgpr_count 2
  .amdhsa_user_sgpr_kernarg_segment_ptr 1
  .amdhsa_system_sgpr_workgroup_id_x 1
.end_amdhsa_kernel
.p2align 6
.amdhsa_kernel k1l1_kernel
  .amdhsa_next_free_vgpr 424
  .amdhsa_next_free_sgpr 96
  .amdhsa_accum_offset 208
  .amdhsa_group_segment_fixed_size 0
  .amdhsa_kernarg_size 96
  .amdhsa_user_sgpr_count 2
  .amdhsa_user_sgpr_kernarg_segment_ptr 1
  .amdhsa_system_sgpr_workgroup_id_x 1
.end_amdhsa_kernel
.p2align 6
.amdhsa_kernel krl1_kernel
  .amdhsa_next_free_vgpr 80
  .amdhsa_next_free_sgpr 32
  .amdhsa_accum_offset 80
  .amdhsa_group_segment_fixed_size 0
  .amdhsa_kernarg_size 96
  .amdhsa_user_sgpr_count 2
  .amdhsa_user_sgpr_kernarg_segment_ptr 1
  .amdhsa_system_sgpr_workgroup_id_x 1
.end_amdhsa_kernel
.p2align 6
.amdhsa_kernel k2l1_kernel
  .amdhsa_next_free_vgpr 344
  .amdhsa_next_free_sgpr 96
  .amdhsa_accum_offset 216
  .amdhsa_group_segment_fixed_size 0
  .amdhsa_kernarg_size 96
  .amdhsa_user_sgpr_count 2
  .amdhsa_user_sgpr_kernarg_segment_ptr 1
  .amdhsa_system_sgpr_workgroup_id_x 1
.end_amdhsa_kernel
.p2align 6
.amdhsa_kernel k3l1_kernel
  .amdhsa_next_free_vgpr 384
  .amdhsa_next_free_sgpr 96
  .amdhsa_accum_offset 160
  .amdhsa_group_segment_fixed_size 0
  .amdhsa_kernarg_size 96
  .amdhsa_user_sgpr_count 2
  .amdhsa_user_sgpr_kernarg_segment_ptr 1
  .amdhsa_system_sgpr_workgroup_id_x 1
.end_amdhsa_kernel
.p2align 6
.amdhsa_kernel k4l1_kernel
  .amdhsa_next_free_vgpr 320
  .amdhsa_next_free_sgpr 96
  .amdhsa_accum_offset 224
  .amdhsa_group_segment_fixed_size 0
  .amdhsa_kernarg_size 96
  .amdhsa_user_sgpr_count 2
  .amdhsa_user_sgpr_kernarg_segment_ptr 1
  .amdhsa_system_sgpr_workgroup_id_x 1
.end_amdhsa_kernel
.p2align 6
.amdhsa_kernel k1l2_kernel
  .amdhsa_next_free_vgpr 424
  .amdhsa_next_free_sgpr 96
  .amdhsa_accum_offset 208
  .amdhsa_group_segment_fixed_size 0
  .amdhsa_kernarg_size 96
  .amdhsa_user_sgpr_count 2
  .amdhsa_user_sgpr_kernarg_segment_ptr 1
  .amdhsa_system_sgpr_workgroup_id_x 1
.end_amdhsa_kernel
.p2align 6
.amdhsa_kernel krl2_kernel
  .amdhsa_next_free_vgpr 80
  .amdhsa_next_free_sgpr 32
  .amdhsa_accum_offset 80
  .amdhsa_group_segment_fixed_size 0
  .amdhsa_kernarg_size 96
  .amdhsa_user_sgpr_count 2
  .amdhsa_user_sgpr_kernarg_segment_ptr 1
  .amdhsa_system_sgpr_workgroup_id_x 1
.end_amdhsa_kernel
.p2align 6
.amdhsa_kernel k2l2_kernel
  .amdhsa_next_free_vgpr 344
  .amdhsa_next_free_sgpr 96
  .amdhsa_accum_offset 216
  .amdhsa_group_segment_fixed_size 0
  .amdhsa_kernarg_size 96
  .amdhsa_user_sgpr_count 2
  .amdhsa_user_sgpr_kernarg_segment_ptr 1
  .amdhsa_system_sgpr_workgroup_id_x 1
.end_amdhsa_kernel
.p2align 6
.amdhsa_kernel k3l2_kernel
  .amdhsa_next_free_vgpr 384
  .amdhsa_next_free_sgpr 96
  .amdhsa_accum_offset 160
  .amdhsa_group_segment_fixed_size 0
  .amdhsa_kernarg_size 96
  .amdhsa_user_sgpr_count 2
  .amdhsa_user_sgpr_kernarg_segment_ptr 1
  .amdhsa_system_sgpr_workgroup_id_x 1
.end_amdhsa_kernel
.p2align 6
.amdhsa_kernel k4l2_kernel
  .amdhsa_next_free_vgpr 320
  .amdhsa_next_free_sgpr 96
  .amdhsa_accum_offset 224
  .amdhsa_group_segment_fixed_size 0
  .amdhsa_kernarg_size 96
  .amdhsa_user_sgpr_count 2
  .amdhsa_user_sgpr_kernarg_segment_ptr 1
  .amdhsa_system_sgpr_workgroup_id_x 1
.end_amdhsa_kernel
```
